```python
import torch

def _softmax(x, axis=-1):
    return torch.softmax(x, dim=axis)
def _gelu(x):
    return torch.nn.functional.gelu(x, approximate="tanh")
def _silu(x):
    return torch.nn.functional.silu(x)
def _sigmoid(x):
    return torch.sigmoid(x)
def _layernorm(x, axis=-1, eps=1e-5):
    m = x.mean(dim=axis, keepdim=True)
    v = x.var(dim=axis, keepdim=True, unbiased=False)
    return (x - m) / torch.sqrt(v + eps)
def _scatter_add(tgt, idx, src, axis=0):
    return tgt.clone().index_add_(axis, idx, src)
def _segment_sum(src, seg, n):
    out = torch.zeros((n,) + src.shape[1:], dtype=src.dtype)
    return out.index_add_(0, seg, src)
def _pad(x, pw):
    flat = tuple(v for pair in reversed(pw) for v in pair)
    return torch.nn.functional.pad(x, flat)

kernel_name = 'recurrent_scan__compressed_kv_cla__mixer_s_mlp__prompt'

def setup_inputs():

    _w = (lambda a: (lambda t: t.to(torch.bfloat16) if t.is_floating_point() else t)(torch.as_tensor(a)))
    def _A_setup():
        B, H, Sq, Sk, D, M = 1, 32, 2048, 2048, 128, 512
        Dc = 4 * D
        return {
            "x": _w((lambda *s: torch.randn(*s, dtype=torch.bfloat16) * 0.05)(B, Sq, M)),
            "c_kv": _w((lambda *s: torch.randn(*s, dtype=torch.bfloat16) * 0.2)(B, Sk, Dc)),
            "w_q": _w((lambda *s: torch.randn(*s, dtype=torch.bfloat16) * 3.2)(M, H, D) * (M ** -0.5)),
            "w_uk": _w((lambda *s: torch.randn(*s, dtype=torch.bfloat16) * 3.2)(Dc, H, D) * (Dc ** -0.5)),
            "w_uv": _w((lambda *s: torch.randn(*s, dtype=torch.bfloat16) * 0.2)(Dc, H, D) * (Dc ** -0.5)),
            "w_o": _w((lambda *s: torch.randn(*s, dtype=torch.bfloat16) * 0.2)(H, D, M) * ((H * D) ** -0.5)),
        }
    _A_in = _A_setup()

    def _B_setup():
        B, S, D, F = 1, 2048, 512, 1792
        return {
            "x":  _w((lambda *s: torch.randn(*s, dtype=torch.bfloat16) * 0.05)(B, S, D)),
            "w1": _w((lambda *s: torch.randn(*s, dtype=torch.bfloat16) * 1.6)(D, D) * (D ** -0.5)),
            "w2": _w((lambda *s: torch.randn(*s, dtype=torch.bfloat16) * 1.6)(D, D) * (D ** -0.5)),
            "w3": _w((lambda *s: torch.randn(*s, dtype=torch.bfloat16) * 1.6)(D, F) * (D ** -0.5)),
            "w4": _w((lambda *s: torch.randn(*s, dtype=torch.bfloat16) * 1.6)(F, D) * (F ** -0.5)),
        }
    _B_in = _B_setup()

    return {
        "A_x": _A_in["x"],
        "A_c_kv": _A_in["c_kv"],
        "A_w_q": _A_in["w_q"],
        "A_w_uk": _A_in["w_uk"],
        "A_w_uv": _A_in["w_uv"],
        "A_w_o": _A_in["w_o"],
        "B_x": _B_in["x"],
        "B_w1": _B_in["w1"],
        "B_w2": _B_in["w2"],
        "B_w3": _B_in["w3"],
        "B_w4": _B_in["w4"],
    }

def reference(A_x, A_c_kv, A_w_q, A_w_uk, A_w_uv, A_w_o, B_x, B_w1, B_w2, B_w3, B_w4):
    def _A_ref(x, c_kv, w_q, w_uk, w_uv, w_o):
        B, Sq, M = x.shape[0], x.shape[1], x.shape[2]
        Sk = c_kv.shape[1]
        H, D = w_q.shape[1], w_q.shape[2]
        q = torch.einsum("bqm,mhd->bhqd", x, w_q)
        k = torch.einsum("bkc,chd->bhkd", c_kv, w_uk)
        v = torch.einsum("bkc,chd->bhkd", c_kv, w_uv)
        scores = torch.einsum("bhqd,bhkd->bhqk", q, k) * (D ** -0.5)
        off = Sk - Sq
        qi = torch.arange(Sq)[:, None]
        kj = torch.arange(Sk)[None, :]
        cmask = kj <= (qi + off)
        scores = torch.where(cmask[None, None], scores, -1e9)
        p = _softmax(scores, axis=-1)
        ctx = torch.einsum("bhqk,bhkd->bhqd", p, v)
        return torch.einsum("bhqd,hdm->bqm", ctx, w_o)

    def _B_ref(x, w1, w2, w3, w4):
        B, S, D = x.shape
        h = _gelu(_layernorm(x, axis=-1) @ w1)
        c = D // 4
        g0 = _pad(h[:, :, 0*c:1*c], ((0, 0), (1, 0), (0, 0)))[:, :S, :]
        g1 = _pad(h[:, :, 1*c:2*c], ((0, 0), (0, 1), (0, 0)))[:, 1:, :]
        g2 = _pad(h[:, :, 2*c:3*c], ((0, 0), (2, 0), (0, 0)))[:, :S, :]
        g3 = _pad(h[:, :, 3*c:   ], ((0, 0), (0, 2), (0, 0)))[:, 2:, :]
        hs = torch.concatenate([g0, g1, g2, g3], axis=-1) @ w2
        x1 = x + hs
        h2 = _gelu(_layernorm(x1, axis=-1) @ w3) @ w4
        return x1 + h2

    x = A_x
    xn = _layernorm(x, axis=-1)
    s = _A_ref(xn, A_c_kv, A_w_q, A_w_uk, A_w_uv, A_w_o)
    g = _silu(_B_ref(xn, B_w1, B_w2, B_w3, B_w4))
    return x + s * g
```

```asm
; @launch kernel=kv_kernel grid=(256,1,1) block=(512,1,1) lds=163840
; @launch kernel=at_kernel grid=(256,1,1) block=(512,1,1) lds=163840
; @launch kernel=fin_kernel grid=(256,1,1) block=(512,1,1) lds=163840
.amdgcn_target "amdgcn-amd-amdhsa--gfx950"
.text
.globl kv_kernel
.p2align 8
.type kv_kernel,@function
kv_kernel:
  s_cmp_ge_u32 s2, 256
  s_cbranch_scc1 kv_kernel_done
  s_load_dwordx2 s[44:45], s[0:1], 0
  s_load_dwordx2 s[46:47], s[0:1], 8
  s_load_dwordx2 s[48:49], s[0:1], 24
  s_load_dwordx2 s[50:51], s[0:1], 32
  s_load_dwordx2 s[4:5], s[0:1], 104
  s_load_dwordx2 s[52:53], s[0:1], 96
  s_load_dwordx2 s[6:7], s[0:1], 56
  s_load_dwordx2 s[40:41], s[0:1], 64
  s_load_dwordx2 s[42:43], s[0:1], 16
  v_and_b32 v1, 63, v0
  v_lshrrev_b32 v14, 6, v0
  s_nop 0
  v_readfirstlane_b32 s54, v14
  s_and_b32 s57, s2, 7
  s_lshl_b32 s57, s57, 2
  s_bfe_u32 s58, s2, 0x20003
  s_add_u32 s55, s57, s58
  s_lshr_b32 s57, s2, 5
  s_lshl_b32 s57, s57, 3
  s_add_u32 s56, s57, s54
  s_waitcnt lgkmcnt(0)
  s_mov_b32 s24, s44
  s_mov_b32 s25, s45
  s_mov_b32 s26, 2097152
  s_mov_b32 s27, 0x20000
  s_mov_b32 s8, s46
  s_mov_b32 s9, s47
  s_mov_b32 s10, 2097152
  s_mov_b32 s11, 0x20000
  s_mov_b32 s12, s48
  s_mov_b32 s13, s49
  s_mov_b32 s14, 4194304
  s_mov_b32 s15, 0x20000
  s_mov_b32 s16, s50
  s_mov_b32 s17, s51
  s_mov_b32 s18, 4194304
  s_mov_b32 s19, 0x20000
  s_mov_b32 s20, s4
  s_mov_b32 s21, s5
  s_mov_b32 s22, 33554432
  s_mov_b32 s23, 0x20000
  s_add_u32 s28, s4, 33554432
  s_addc_u32 s29, s5, 0
  s_mov_b32 s30, 12582912
  s_mov_b32 s31, 0x20000
  s_mov_b32 s32, s52
  s_mov_b32 s33, s53
  s_mov_b32 s34, 256
  s_mov_b32 s35, 0x20000
  s_lshl_b32 s57, s2, 3
  s_add_u32 s57, s57, s54
  s_lshl_b32 s58, s57, 10
  v_lshrrev_b32 v14, 2, v1
  v_lshlrev_b32 v14, 6, v14
  v_and_b32 v15, 3, v1
  v_lshl_add_u32 v14, v15, 3, v14
  buffer_load_dwordx2 v[240:241], v14, s[24:27], s58 offen
  buffer_load_dwordx2 v[242:243], v14, s[24:27], s58 offen offset:32
  v_lshrrev_b32 v244, 2, v1
  v_lshlrev_b32 v244, 10, v244
  v_lshl_add_u32 v244, v15, 8, v244
  s_lshr_b32 s64, s57, 4
  s_lshl_b32 s64, s64, 14
  s_and_b32 s57, s57, 15
  s_lshl_b32 s57, s57, 4
  s_add_u32 s64, s64, s57
  s_mov_b32 s65, s58
  v_lshrrev_b32 v14, 4, v1
  v_lshlrev_b32 v15, 2, v14
  v_and_b32 v2, 15, v1
  v_xor_b32 v2, v2, v15
  v_lshlrev_b32 v2, 4, v2
  v_lshl_add_u32 v2, v14, 13, v2
  s_lshl_b32 s57, s54, 16
  s_lshl_b32 s59, s55, 8
  s_add_u32 s59, s59, s57
  s_lshl_b32 s62, s54, 11
  v_and_b32 v3, 7, v1
  v_xor_b32 v3, v3, v14
  v_xor_b32 v4, 4, v3
  v_lshrrev_b32 v15, 3, v1
  v_lshlrev_b32 v15, 10, v15
  v_lshl_add_u32 v3, v3, 4, v15
  v_lshl_add_u32 v4, v4, 4, v15
  s_lshl_b32 s60, s56, 15
  s_mul_i32 s61, s54, 12288
  s_add_u32 s61, s61, 65536
  v_lshlrev_b32 v5, 4, v1
  s_lshr_b32 s66, s2, 5
  s_mul_i32 s66, s66, 1
  s_bfe_u32 s57, s2, 0x20003
  s_mul_i32 s57, s57, 2
  s_add_u32 s66, s66, s57
  s_add_u32 s67, s66, 0
  s_and_b32 s67, s67, 7
  s_lshl_b32 s67, s67, 19
  s_add_u32 s67, s67, s59
  s_add_u32 m0, s62, 0
  s_add_u32 s57, s67, 0
  buffer_load_dwordx4 v2, s[12:15], s57 offen lds
  s_add_u32 m0, s62, 1024
  s_add_u32 s57, s67, 32768
  buffer_load_dwordx4 v2, s[12:15], s57 offen lds
  s_add_u32 s67, s66, 0
  s_and_b32 s67, s67, 7
  s_lshl_b32 s67, s67, 7
  s_add_u32 s67, s67, s60
  s_add_u32 m0, s61, 0
  s_add_u32 s57, s67, 0
  buffer_load_dwordx4 v3, s[8:11], s57 offen lds
  s_add_u32 m0, s61, 1024
  s_add_u32 s57, s67, 8192
  buffer_load_dwordx4 v4, s[8:11], s57 offen lds
  s_add_u32 m0, s61, 2048
  s_add_u32 s57, s67, 16384
  buffer_load_dwordx4 v3, s[8:11], s57 offen lds
  s_add_u32 m0, s61, 3072
  s_add_u32 s57, s67, 24576
  buffer_load_dwordx4 v4, s[8:11], s57 offen lds
  v_bfe_u32 v14, v1, 2, 2
  v_lshrrev_b32 v15, 5, v1
  v_lshl_add_u32 v15, v15, 3, v14
  v_lshlrev_b32 v15, 8, v15
  v_bfe_u32 v6, v1, 4, 1
  v_lshl_add_u32 v15, v6, 5, v15
  v_and_b32 v6, 3, v1
  v_lshl_add_u32 v15, v6, 3, v15
  v_xor_b32 v6, 0, v14
  v_lshl_add_u32 v6, v6, 6, v15
  v_xor_b32 v7, 1, v14
  v_lshl_add_u32 v7, v7, 6, v15
  v_xor_b32 v8, 2, v14
  v_lshl_add_u32 v8, v8, 6, v15
  v_xor_b32 v9, 3, v14
  v_lshl_add_u32 v9, v9, 6, v15
  v_bfe_u32 v14, v1, 1, 3
  v_lshrrev_b32 v15, 5, v1
  v_xor_b32 v14, v14, v15
  v_lshlrev_b32 v14, 4, v14
  v_and_b32 v15, 31, v1
  v_lshl_add_u32 v14, v15, 7, v14
  v_xor_b32 v10, 0, v14
  v_add_u32 v10, s61, v10
  v_xor_b32 v11, 32, v14
  v_add_u32 v11, s61, v11
  v_xor_b32 v12, 64, v14
  v_add_u32 v12, s61, v12
  v_xor_b32 v13, 96, v14
  v_add_u32 v13, s61, v13
  s_lshl_b32 s63, s55, 6
  s_add_u32 s63, s63, s56
  s_lshl_b32 s63, s63, 14
  s_and_b32 s57, s2, 7
  s_lshl_b32 s57, s57, 2
  s_bfe_u32 s58, s2, 0x20003
  s_add_u32 s44, s57, s58
  s_lshr_b32 s51, s2, 5
  s_lshr_b32 s50, s54, 2
  s_and_b32 s57, s54, 3
  s_lshl_b32 s52, s44, 2
  s_add_u32 s52, s52, s57
  s_lshl_b32 s45, s54, 15
  s_lshl_b32 s57, s51, 7
  s_add_u32 s45, s45, s57
  s_lshl_b32 s46, s52, 14
  s_lshl_b32 s57, s50, 10
  s_add_u32 s47, s46, s57
  s_lshl_b32 s57, s51, 11
  s_add_u32 s46, s47, s57
  s_mov_b32 s48, 0xbdd2d3e8
  v_lshrrev_b32 v14, 3, v1
  v_mul_u32_u24 v14, 12288, v14
  v_and_b32 v15, 7, v1
  v_lshl_add_u32 v14, v15, 7, v14
  v_add_u32 v15, s54, v1
  v_and_b32 v15, 7, v15
  v_lshl_add_u32 v14, v15, 4, v14
  v_add_u32 v244, 73728, v14
  s_waitcnt vmcnt(7)
  v_lshlrev_b32 v48, 16, v240
  v_and_b32 v49, 0xffff0000, v240
  v_lshlrev_b32 v50, 16, v241
  v_and_b32 v51, 0xffff0000, v241
  s_waitcnt vmcnt(6)
  v_lshlrev_b32 v52, 16, v242
  v_and_b32 v53, 0xffff0000, v242
  v_lshlrev_b32 v54, 16, v243
  v_and_b32 v55, 0xffff0000, v243
  v_add_f32 v64, v48, v49
  v_add_f32 v64, v64, v50
  v_add_f32 v64, v64, v51
  v_add_f32 v64, v64, v52
  v_add_f32 v64, v64, v53
  v_add_f32 v64, v64, v54
  v_add_f32 v64, v64, v55
  s_nop 1
  v_add_f32 v64, v64, v64 quad_perm:[1,0,3,2] row_mask:0xf bank_mask:0xf
  s_nop 1
  v_add_f32 v64, v64, v64 quad_perm:[2,3,0,1] row_mask:0xf bank_mask:0xf
  s_nop 1
  v_add_f32 v64, v64, v64 row_half_mirror row_mask:0xf bank_mask:0xf
  s_nop 1
  v_add_f32 v64, v64, v64 row_mirror row_mask:0xf bank_mask:0xf
  v_mov_b32 v65, v64
  s_nop 1
  v_permlane16_swap_b32 v65, v64
  v_add_f32 v64, v64, v65
  v_mov_b32 v65, v64
  s_nop 1
  v_permlane32_swap_b32 v65, v64
  v_add_f32 v64, v64, v65
  v_mul_f32 v64, 0x3b000000, v64
  v_sub_f32 v56, v48, v64
  v_sub_f32 v57, v49, v64
  v_sub_f32 v58, v50, v64
  v_sub_f32 v59, v51, v64
  v_sub_f32 v60, v52, v64
  v_sub_f32 v61, v53, v64
  v_sub_f32 v62, v54, v64
  v_sub_f32 v63, v55, v64
  v_mul_f32 v64, v56, v56
  v_fmac_f32 v64, v57, v57
  v_fmac_f32 v64, v58, v58
  v_fmac_f32 v64, v59, v59
  v_fmac_f32 v64, v60, v60
  v_fmac_f32 v64, v61, v61
  v_fmac_f32 v64, v62, v62
  v_fmac_f32 v64, v63, v63
  s_nop 1
  v_add_f32 v64, v64, v64 quad_perm:[1,0,3,2] row_mask:0xf bank_mask:0xf
  s_nop 1
  v_add_f32 v64, v64, v64 quad_perm:[2,3,0,1] row_mask:0xf bank_mask:0xf
  s_nop 1
  v_add_f32 v64, v64, v64 row_half_mirror row_mask:0xf bank_mask:0xf
  s_nop 1
  v_add_f32 v64, v64, v64 row_mirror row_mask:0xf bank_mask:0xf
  v_mov_b32 v65, v64
  s_nop 1
  v_permlane16_swap_b32 v65, v64
  v_add_f32 v64, v64, v65
  v_mov_b32 v65, v64
  s_nop 1
  v_permlane32_swap_b32 v65, v64
  v_add_f32 v64, v64, v65
  v_mov_b32 v65, 0x3727c5ac
  v_fmac_f32 v65, 0x3b000000, v64
  v_rsq_f32 v65, v65
  s_nop 0
  v_mul_f32 v56, v56, v65
  v_mul_f32 v57, v57, v65
  v_mul_f32 v58, v58, v65
  v_mul_f32 v59, v59, v65
  v_mul_f32 v60, v60, v65
  v_mul_f32 v61, v61, v65
  v_mul_f32 v62, v62, v65
  v_mul_f32 v63, v63, v65
  v_cvt_pk_bf16_f32 v248, v56, v57
  v_cvt_pk_bf16_f32 v249, v58, v59
  v_cvt_pk_bf16_f32 v250, v60, v61
  v_cvt_pk_bf16_f32 v251, v62, v63
  ds_write_b128 v244, v[248:251]
  v_lshlrev_b32 v48, 16, v248
  v_and_b32 v49, 0xffff0000, v248
  v_lshlrev_b32 v50, 16, v249
  v_and_b32 v51, 0xffff0000, v249
  v_lshlrev_b32 v52, 16, v250
  v_and_b32 v53, 0xffff0000, v250
  v_lshlrev_b32 v54, 16, v251
  v_and_b32 v55, 0xffff0000, v251
  v_add_f32 v64, v48, v49
  v_add_f32 v64, v64, v50
  v_add_f32 v64, v64, v51
  v_add_f32 v64, v64, v52
  v_add_f32 v64, v64, v53
  v_add_f32 v64, v64, v54
  v_add_f32 v64, v64, v55
  s_nop 1
  v_add_f32 v64, v64, v64 quad_perm:[1,0,3,2] row_mask:0xf bank_mask:0xf
  s_nop 1
  v_add_f32 v64, v64, v64 quad_perm:[2,3,0,1] row_mask:0xf bank_mask:0xf
  s_nop 1
  v_add_f32 v64, v64, v64 row_half_mirror row_mask:0xf bank_mask:0xf
  s_nop 1
  v_add_f32 v64, v64, v64 row_mirror row_mask:0xf bank_mask:0xf
  v_mov_b32 v65, v64
  s_nop 1
  v_permlane16_swap_b32 v65, v64
  v_add_f32 v64, v64, v65
  v_mov_b32 v65, v64
  s_nop 1
  v_permlane32_swap_b32 v65, v64
  v_add_f32 v64, v64, v65
  v_mul_f32 v64, 0x3b000000, v64
  v_sub_f32 v56, v48, v64
  v_sub_f32 v57, v49, v64
  v_sub_f32 v58, v50, v64
  v_sub_f32 v59, v51, v64
  v_sub_f32 v60, v52, v64
  v_sub_f32 v61, v53, v64
  v_sub_f32 v62, v54, v64
  v_sub_f32 v63, v55, v64
  v_mul_f32 v64, v56, v56
  v_fmac_f32 v64, v57, v57
  v_fmac_f32 v64, v58, v58
  v_fmac_f32 v64, v59, v59
  v_fmac_f32 v64, v60, v60
  v_fmac_f32 v64, v61, v61
  v_fmac_f32 v64, v62, v62
  v_fmac_f32 v64, v63, v63
  s_nop 1
  v_add_f32 v64, v64, v64 quad_perm:[1,0,3,2] row_mask:0xf bank_mask:0xf
  s_nop 1
  v_add_f32 v64, v64, v64 quad_perm:[2,3,0,1] row_mask:0xf bank_mask:0xf
  s_nop 1
  v_add_f32 v64, v64, v64 row_half_mirror row_mask:0xf bank_mask:0xf
  s_nop 1
  v_add_f32 v64, v64, v64 row_mirror row_mask:0xf bank_mask:0xf
  v_mov_b32 v65, v64
  s_nop 1
  v_permlane16_swap_b32 v65, v64
  v_add_f32 v64, v64, v65
  v_mov_b32 v65, v64
  s_nop 1
  v_permlane32_swap_b32 v65, v64
  v_add_f32 v64, v64, v65
  v_mov_b32 v65, 0x3727c5ac
  v_fmac_f32 v65, 0x3b000000, v64
  v_rsq_f32 v65, v65
  s_nop 0
  v_mul_f32 v56, v56, v65
  v_mul_f32 v57, v57, v65
  v_mul_f32 v58, v58, v65
  v_mul_f32 v59, v59, v65
  v_mul_f32 v60, v60, v65
  v_mul_f32 v61, v61, v65
  v_mul_f32 v62, v62, v65
  v_mul_f32 v63, v63, v65
  v_cvt_pk_bf16_f32 v252, v56, v57
  v_cvt_pk_bf16_f32 v253, v58, v59
  v_cvt_pk_bf16_f32 v254, v60, v61
  v_cvt_pk_bf16_f32 v255, v62, v63
  ds_write_b128 v244, v[252:255] offset:1024
  s_add_u32 s67, s66, 1
  s_and_b32 s67, s67, 7
  s_lshl_b32 s67, s67, 19
  s_add_u32 s67, s67, s59
  s_add_u32 m0, s62, 16384
  s_add_u32 s57, s67, 0
  buffer_load_dwordx4 v2, s[12:15], s57 offen lds
  s_add_u32 m0, s62, 17408
  s_add_u32 s57, s67, 32768
  buffer_load_dwordx4 v2, s[12:15], s57 offen lds
  s_add_u32 s67, s66, 1
  s_and_b32 s67, s67, 7
  s_lshl_b32 s67, s67, 7
  s_add_u32 s67, s67, s60
  s_add_u32 m0, s61, 4096
  s_add_u32 s57, s67, 0
  buffer_load_dwordx4 v3, s[8:11], s57 offen lds
  s_add_u32 m0, s61, 5120
  s_add_u32 s57, s67, 8192
  buffer_load_dwordx4 v4, s[8:11], s57 offen lds
  s_add_u32 m0, s61, 6144
  s_add_u32 s57, s67, 16384
  buffer_load_dwordx4 v3, s[8:11], s57 offen lds
  s_add_u32 m0, s61, 7168
  s_add_u32 s57, s67, 24576
  buffer_load_dwordx4 v4, s[8:11], s57 offen lds
  v_lshrrev_b32 v14, 3, v1
  v_add_u32 v15, v14, v1
  v_and_b32 v15, 7, v15
  v_lshlrev_b32 v15, 4, v15
  v_lshl_add_u32 v15, v14, 7, v15
  s_add_u32 s57, s61, 8192
  v_add_u32 v15, s57, v15
  s_waitcnt lgkmcnt(0)
  v_lshrrev_b32 v244, 2, v14
  v_lshlrev_b32 v244, 10, v244
  v_and_b32 v14, 3, v14
  v_lshl_add_u32 v244, v14, 8, v244
  v_and_b32 v14, 7, v1
  v_lshl_add_u32 v244, v14, 4, v244
  s_lshr_b32 s64, s2, 1
  s_lshl_b32 s64, s64, 14
  s_and_b32 s57, s2, 1
  s_lshl_b32 s57, s57, 7
  s_add_u32 s64, s64, s57
  s_lshl_b32 s57, s54, 11
  s_add_u32 s64, s64, s57
  s_waitcnt vmcnt(6)
  s_barrier
  ds_read_b128 v[248:251], v15
  ds_read_b128 v[252:255], v15 offset:1024
  ds_read_b128 v[112:115], v10 offset:0
  ds_read_b128 v[116:119], v11 offset:0
  ds_read_b128 v[120:123], v12 offset:0
  ds_read_b128 v[124:127], v13 offset:0
  ds_read_b64_tr_b16 v[16:17], v6 offset:0
  ds_read_b64_tr_b16 v[18:19], v6 offset:1024
  ds_read_b64_tr_b16 v[20:21], v7 offset:0
  ds_read_b64_tr_b16 v[22:23], v7 offset:1024
  ds_read_b64_tr_b16 v[24:25], v8 offset:0
  ds_read_b64_tr_b16 v[26:27], v8 offset:1024
  ds_read_b64_tr_b16 v[28:29], v9 offset:0
  ds_read_b64_tr_b16 v[30:31], v9 offset:1024
  s_waitcnt lgkmcnt(6)
  v_mfma_f32_32x32x16_bf16 v[48:63], v[16:19], v[112:115], 0
  ds_read_b64_tr_b16 v[32:33], v6 offset:4096
  ds_read_b64_tr_b16 v[34:35], v6 offset:5120
  ds_read_b64_tr_b16 v[36:37], v7 offset:4096
  s_waitcnt lgkmcnt(7)
  v_mfma_f32_32x32x16_bf16 v[64:79], v[20:23], v[112:115], 0
  ds_read_b64_tr_b16 v[38:39], v7 offset:5120
  ds_read_b64_tr_b16 v[40:41], v8 offset:4096
  ds_read_b64_tr_b16 v[42:43], v8 offset:5120
  s_waitcnt lgkmcnt(8)
  v_mfma_f32_32x32x16_bf16 v[80:95], v[24:27], v[112:115], 0
  ds_read_b64_tr_b16 v[44:45], v9 offset:4096
  ds_read_b64_tr_b16 v[46:47], v9 offset:5120
  buffer_store_dwordx4 v[248:251], v244, s[28:31], s64 offen sc1
  s_add_u32 s58, s64, 2097152
  buffer_store_dwordx4 v[252:255], v244, s[28:31], s58 offen sc1
  s_waitcnt lgkmcnt(8)
  v_mfma_f32_32x32x16_bf16 v[96:111], v[28:31], v[112:115], 0
  s_waitcnt vmcnt(2)
  s_waitcnt lgkmcnt(6)
  v_mfma_f32_32x32x16_bf16 v[48:63], v[32:35], v[116:119], v[48:63]
  ds_read_b64_tr_b16 v[16:17], v6 offset:8192
  ds_read_b64_tr_b16 v[18:19], v6 offset:9216
  ds_read_b64_tr_b16 v[20:21], v7 offset:8192
  ds_read_b64_tr_b16 v[22:23], v7 offset:9216
  s_add_u32 s67, s66, 2
  s_and_b32 s67, s67, 7
  s_lshl_b32 s67, s67, 19
  s_add_u32 s67, s67, s59
  s_add_u32 m0, s62, 32768
  s_add_u32 s57, s67, 0
  buffer_load_dwordx4 v2, s[12:15], s57 offen lds
  s_add_u32 m0, s62, 33792
  s_add_u32 s57, s67, 32768
  buffer_load_dwordx4 v2, s[12:15], s57 offen lds
  s_waitcnt lgkmcnt(8)
  v_mfma_f32_32x32x16_bf16 v[64:79], v[36:39], v[116:119], v[64:79]
  ds_read_b64_tr_b16 v[24:25], v8 offset:8192
  ds_read_b64_tr_b16 v[26:27], v8 offset:9216
  ds_read_b64_tr_b16 v[28:29], v9 offset:8192
  ds_read_b64_tr_b16 v[30:31], v9 offset:9216
  s_waitcnt lgkmcnt(10)
  v_mfma_f32_32x32x16_bf16 v[80:95], v[40:43], v[116:119], v[80:95]
  ds_read_b128 v[128:131], v10 offset:4096
  ds_read_b128 v[132:135], v11 offset:4096
  s_add_u32 s67, s66, 2
  s_and_b32 s67, s67, 7
  s_lshl_b32 s67, s67, 7
  s_add_u32 s67, s67, s60
  s_add_u32 m0, s61, 8192
  s_add_u32 s57, s67, 0
  buffer_load_dwordx4 v3, s[8:11], s57 offen lds
  s_add_u32 m0, s61, 9216
  s_add_u32 s57, s67, 8192
  buffer_load_dwordx4 v4, s[8:11], s57 offen lds
  s_add_u32 m0, s61, 10240
  s_add_u32 s57, s67, 16384
  buffer_load_dwordx4 v3, s[8:11], s57 offen lds
  s_add_u32 m0, s61, 11264
  s_add_u32 s57, s67, 24576
  buffer_load_dwordx4 v4, s[8:11], s57 offen lds
  s_waitcnt lgkmcnt(10)
  v_mfma_f32_32x32x16_bf16 v[96:111], v[44:47], v[116:119], v[96:111]
  s_waitcnt lgkmcnt(8)
  v_mfma_f32_32x32x16_bf16 v[48:63], v[16:19], v[120:123], v[48:63]
  ds_read_b64_tr_b16 v[32:33], v6 offset:12288
  ds_read_b64_tr_b16 v[34:35], v6 offset:13312
  ds_read_b64_tr_b16 v[36:37], v7 offset:12288
  ds_read_b64_tr_b16 v[38:39], v7 offset:13312
  s_waitcnt lgkmcnt(10)
  v_mfma_f32_32x32x16_bf16 v[64:79], v[20:23], v[120:123], v[64:79]
  ds_read_b64_tr_b16 v[40:41], v8 offset:12288
  ds_read_b64_tr_b16 v[42:43], v8 offset:13312
  ds_read_b64_tr_b16 v[44:45], v9 offset:12288
  ds_read_b64_tr_b16 v[46:47], v9 offset:13312
  s_add_u32 s67, s66, 3
  s_and_b32 s67, s67, 7
  s_lshl_b32 s67, s67, 19
  s_add_u32 s67, s67, s59
  s_add_u32 m0, s62, 49152
  s_add_u32 s57, s67, 0
  buffer_load_dwordx4 v2, s[12:15], s57 offen lds
  s_add_u32 m0, s62, 50176
  s_add_u32 s57, s67, 32768
  buffer_load_dwordx4 v2, s[12:15], s57 offen lds
  s_waitcnt lgkmcnt(12)
  v_mfma_f32_32x32x16_bf16 v[80:95], v[24:27], v[120:123], v[80:95]
  ds_read_b128 v[136:139], v12 offset:4096
  ds_read_b128 v[140:143], v13 offset:4096
  s_waitcnt lgkmcnt(12)
  v_mfma_f32_32x32x16_bf16 v[96:111], v[28:31], v[120:123], v[96:111]
  s_add_u32 s67, s66, 3
  s_and_b32 s67, s67, 7
  s_lshl_b32 s67, s67, 7
  s_add_u32 s67, s67, s60
  s_add_u32 m0, s61, 0
  s_add_u32 s57, s67, 0
  buffer_load_dwordx4 v3, s[8:11], s57 offen lds
  s_add_u32 m0, s61, 1024
  s_add_u32 s57, s67, 8192
  buffer_load_dwordx4 v4, s[8:11], s57 offen lds
  s_add_u32 m0, s61, 2048
  s_add_u32 s57, s67, 16384
  buffer_load_dwordx4 v3, s[8:11], s57 offen lds
  s_add_u32 m0, s61, 3072
  s_add_u32 s57, s67, 24576
  buffer_load_dwordx4 v4, s[8:11], s57 offen lds
  s_waitcnt lgkmcnt(0)
  s_barrier
  v_mfma_f32_32x32x16_bf16 v[48:63], v[32:35], v[124:127], v[48:63]
  ds_read_b64_tr_b16 v[16:17], v6 offset:16384
  ds_read_b64_tr_b16 v[18:19], v6 offset:17408
  ds_read_b64_tr_b16 v[20:21], v7 offset:16384
  v_mfma_f32_32x32x16_bf16 v[64:79], v[36:39], v[124:127], v[64:79]
  ds_read_b64_tr_b16 v[22:23], v7 offset:17408
  ds_read_b64_tr_b16 v[24:25], v8 offset:16384
  ds_read_b64_tr_b16 v[26:27], v8 offset:17408
  v_mfma_f32_32x32x16_bf16 v[80:95], v[40:43], v[124:127], v[80:95]
  ds_read_b64_tr_b16 v[28:29], v9 offset:16384
  ds_read_b64_tr_b16 v[30:31], v9 offset:17408
  s_add_u32 s67, s66, 4
  s_and_b32 s67, s67, 7
  s_lshl_b32 s67, s67, 19
  s_add_u32 s67, s67, s59
  s_add_u32 m0, s62, 0
  s_add_u32 s57, s67, 0
  buffer_load_dwordx4 v2, s[12:15], s57 offen lds
  s_add_u32 m0, s62, 1024
  s_add_u32 s57, s67, 32768
  buffer_load_dwordx4 v2, s[12:15], s57 offen lds
  v_mfma_f32_32x32x16_bf16 v[96:111], v[44:47], v[124:127], v[96:111]
  s_waitcnt lgkmcnt(6)
  v_mfma_f32_32x32x16_bf16 v[48:63], v[16:19], v[128:131], v[48:63]
  ds_read_b64_tr_b16 v[32:33], v6 offset:20480
  ds_read_b64_tr_b16 v[34:35], v6 offset:21504
  ds_read_b64_tr_b16 v[36:37], v7 offset:20480
  s_add_u32 s67, s66, 4
  s_and_b32 s67, s67, 7
  s_lshl_b32 s67, s67, 7
  s_add_u32 s67, s67, s60
  s_add_u32 m0, s61, 4096
  s_add_u32 s57, s67, 0
  buffer_load_dwordx4 v3, s[8:11], s57 offen lds
  s_add_u32 m0, s61, 5120
  s_add_u32 s57, s67, 8192
  buffer_load_dwordx4 v4, s[8:11], s57 offen lds
  s_add_u32 m0, s61, 6144
  s_add_u32 s57, s67, 16384
  buffer_load_dwordx4 v3, s[8:11], s57 offen lds
  s_add_u32 m0, s61, 7168
  s_add_u32 s57, s67, 24576
  buffer_load_dwordx4 v4, s[8:11], s57 offen lds
  s_waitcnt lgkmcnt(7)
  v_mfma_f32_32x32x16_bf16 v[64:79], v[20:23], v[128:131], v[64:79]
  ds_read_b64_tr_b16 v[38:39], v7 offset:21504
  ds_read_b64_tr_b16 v[40:41], v8 offset:20480
  ds_read_b64_tr_b16 v[42:43], v8 offset:21504
  s_waitcnt lgkmcnt(8)
  v_mfma_f32_32x32x16_bf16 v[80:95], v[24:27], v[128:131], v[80:95]
  ds_read_b64_tr_b16 v[44:45], v9 offset:20480
  ds_read_b64_tr_b16 v[46:47], v9 offset:21504
  s_waitcnt lgkmcnt(8)
  v_mfma_f32_32x32x16_bf16 v[96:111], v[28:31], v[128:131], v[96:111]
  s_waitcnt vmcnt(12)
  s_waitcnt lgkmcnt(6)
  v_mfma_f32_32x32x16_bf16 v[48:63], v[32:35], v[132:135], v[48:63]
  ds_read_b64_tr_b16 v[16:17], v6 offset:24576
  ds_read_b64_tr_b16 v[18:19], v6 offset:25600
  ds_read_b64_tr_b16 v[20:21], v7 offset:24576
  ds_read_b64_tr_b16 v[22:23], v7 offset:25600
  s_waitcnt lgkmcnt(8)
  v_mfma_f32_32x32x16_bf16 v[64:79], v[36:39], v[132:135], v[64:79]
  ds_read_b64_tr_b16 v[24:25], v8 offset:24576
  ds_read_b64_tr_b16 v[26:27], v8 offset:25600
  ds_read_b64_tr_b16 v[28:29], v9 offset:24576
  ds_read_b64_tr_b16 v[30:31], v9 offset:25600
  s_waitcnt lgkmcnt(10)
  v_mfma_f32_32x32x16_bf16 v[80:95], v[40:43], v[132:135], v[80:95]
  ds_read_b128 v[144:147], v10 offset:8192
  ds_read_b128 v[148:151], v11 offset:8192
  s_waitcnt lgkmcnt(10)
  v_mfma_f32_32x32x16_bf16 v[96:111], v[44:47], v[132:135], v[96:111]
  s_waitcnt lgkmcnt(8)
  v_mfma_f32_32x32x16_bf16 v[48:63], v[16:19], v[136:139], v[48:63]
  ds_read_b64_tr_b16 v[32:33], v6 offset:28672
  ds_read_b64_tr_b16 v[34:35], v6 offset:29696
  ds_read_b64_tr_b16 v[36:37], v7 offset:28672
  ds_read_b64_tr_b16 v[38:39], v7 offset:29696
  s_waitcnt lgkmcnt(10)
  v_mfma_f32_32x32x16_bf16 v[64:79], v[20:23], v[136:139], v[64:79]
  ds_read_b64_tr_b16 v[40:41], v8 offset:28672
  ds_read_b64_tr_b16 v[42:43], v8 offset:29696
  ds_read_b64_tr_b16 v[44:45], v9 offset:28672
  ds_read_b64_tr_b16 v[46:47], v9 offset:29696
  s_waitcnt lgkmcnt(12)
  v_mfma_f32_32x32x16_bf16 v[80:95], v[24:27], v[136:139], v[80:95]
  ds_read_b128 v[152:155], v12 offset:8192
  ds_read_b128 v[156:159], v13 offset:8192
  s_waitcnt lgkmcnt(12)
  v_mfma_f32_32x32x16_bf16 v[96:111], v[28:31], v[136:139], v[96:111]
  s_waitcnt lgkmcnt(0)
  s_barrier
  v_mfma_f32_32x32x16_bf16 v[48:63], v[32:35], v[140:143], v[48:63]
  ds_read_b64_tr_b16 v[16:17], v6 offset:32768
  ds_read_b64_tr_b16 v[18:19], v6 offset:33792
  ds_read_b64_tr_b16 v[20:21], v7 offset:32768
  v_mfma_f32_32x32x16_bf16 v[64:79], v[36:39], v[140:143], v[64:79]
  ds_read_b64_tr_b16 v[22:23], v7 offset:33792
  ds_read_b64_tr_b16 v[24:25], v8 offset:32768
  ds_read_b64_tr_b16 v[26:27], v8 offset:33792
  v_mfma_f32_32x32x16_bf16 v[80:95], v[40:43], v[140:143], v[80:95]
  ds_read_b64_tr_b16 v[28:29], v9 offset:32768
  ds_read_b64_tr_b16 v[30:31], v9 offset:33792
  s_add_u32 s67, s66, 5
  s_and_b32 s67, s67, 7
  s_lshl_b32 s67, s67, 19
  s_add_u32 s67, s67, s59
  s_add_u32 m0, s62, 16384
  s_add_u32 s57, s67, 0
  buffer_load_dwordx4 v2, s[12:15], s57 offen lds
  s_add_u32 m0, s62, 17408
  s_add_u32 s57, s67, 32768
  buffer_load_dwordx4 v2, s[12:15], s57 offen lds
  v_mfma_f32_32x32x16_bf16 v[96:111], v[44:47], v[140:143], v[96:111]
  s_waitcnt lgkmcnt(6)
  v_mfma_f32_32x32x16_bf16 v[48:63], v[16:19], v[144:147], v[48:63]
  ds_read_b64_tr_b16 v[32:33], v6 offset:36864
  ds_read_b64_tr_b16 v[34:35], v6 offset:37888
  ds_read_b64_tr_b16 v[36:37], v7 offset:36864
  s_add_u32 s67, s66, 5
  s_and_b32 s67, s67, 7
  s_lshl_b32 s67, s67, 7
  s_add_u32 s67, s67, s60
  s_add_u32 m0, s61, 8192
  s_add_u32 s57, s67, 0
  buffer_load_dwordx4 v3, s[8:11], s57 offen lds
  s_add_u32 m0, s61, 9216
  s_add_u32 s57, s67, 8192
  buffer_load_dwordx4 v4, s[8:11], s57 offen lds
  s_add_u32 m0, s61, 10240
  s_add_u32 s57, s67, 16384
  buffer_load_dwordx4 v3, s[8:11], s57 offen lds
  s_add_u32 m0, s61, 11264
  s_add_u32 s57, s67, 24576
  buffer_load_dwordx4 v4, s[8:11], s57 offen lds
  s_waitcnt lgkmcnt(7)
  v_mfma_f32_32x32x16_bf16 v[64:79], v[20:23], v[144:147], v[64:79]
  ds_read_b64_tr_b16 v[38:39], v7 offset:37888
  ds_read_b64_tr_b16 v[40:41], v8 offset:36864
  ds_read_b64_tr_b16 v[42:43], v8 offset:37888
  s_cmp_lg_u32 s54, 0
  s_cbranch_scc1 kv_kernel_sig1
  s_lshr_b32 s57, s2, 3
  s_lshl_b32 s57, s57, 3
  v_mov_b32 v14, 0x40000000
  v_mov_b32 v15, s57
  v_cmp_eq_u32 vcc, 0, v1
  s_nop 1
  v_cndmask_b32 v14, v14, v15, vcc
  v_mov_b32 v15, 1
  buffer_atomic_add v15, v14, s[32:35], 0 offen sc1
kv_kernel_sig1:
  s_waitcnt lgkmcnt(8)
  v_mfma_f32_32x32x16_bf16 v[80:95], v[24:27], v[144:147], v[80:95]
  ds_read_b64_tr_b16 v[44:45], v9 offset:36864
  ds_read_b64_tr_b16 v[46:47], v9 offset:37888
  s_waitcnt lgkmcnt(8)
  v_mfma_f32_32x32x16_bf16 v[96:111], v[28:31], v[144:147], v[96:111]
  s_waitcnt vmcnt(12)
  s_waitcnt lgkmcnt(6)
  v_mfma_f32_32x32x16_bf16 v[48:63], v[32:35], v[148:151], v[48:63]
  ds_read_b64_tr_b16 v[16:17], v6 offset:40960
  ds_read_b64_tr_b16 v[18:19], v6 offset:41984
  ds_read_b64_tr_b16 v[20:21], v7 offset:40960
  ds_read_b64_tr_b16 v[22:23], v7 offset:41984
  s_waitcnt lgkmcnt(8)
  v_mfma_f32_32x32x16_bf16 v[64:79], v[36:39], v[148:151], v[64:79]
  ds_read_b64_tr_b16 v[24:25], v8 offset:40960
  ds_read_b64_tr_b16 v[26:27], v8 offset:41984
  ds_read_b64_tr_b16 v[28:29], v9 offset:40960
  ds_read_b64_tr_b16 v[30:31], v9 offset:41984
  s_mov_b32 s36, s6
  s_mov_b32 s37, s7
  s_mov_b32 s38, 524288
  s_mov_b32 s39, 0x20000
  s_add_u32 s58, s65, 0
  v_add_u32 v14, s58, v5
  buffer_load_dwordx4 v[252:255], v14, s[36:39], 0 offen
  s_waitcnt lgkmcnt(10)
  v_mfma_f32_32x32x16_bf16 v[80:95], v[40:43], v[148:151], v[80:95]
  ds_read_b128 v[160:163], v10 offset:0
  ds_read_b128 v[164:167], v11 offset:0
  s_waitcnt lgkmcnt(10)
  v_mfma_f32_32x32x16_bf16 v[96:111], v[44:47], v[148:151], v[96:111]
  s_waitcnt lgkmcnt(8)
  v_mfma_f32_32x32x16_bf16 v[48:63], v[16:19], v[152:155], v[48:63]
  ds_read_b64_tr_b16 v[32:33], v6 offset:45056
  ds_read_b64_tr_b16 v[34:35], v6 offset:46080
  ds_read_b64_tr_b16 v[36:37], v7 offset:45056
  ds_read_b64_tr_b16 v[38:39], v7 offset:46080
  s_waitcnt lgkmcnt(10)
  v_mfma_f32_32x32x16_bf16 v[64:79], v[20:23], v[152:155], v[64:79]
  ds_read_b64_tr_b16 v[40:41], v8 offset:45056
  ds_read_b64_tr_b16 v[42:43], v8 offset:46080
  ds_read_b64_tr_b16 v[44:45], v9 offset:45056
  ds_read_b64_tr_b16 v[46:47], v9 offset:46080
  s_waitcnt lgkmcnt(12)
  v_mfma_f32_32x32x16_bf16 v[80:95], v[24:27], v[152:155], v[80:95]
  ds_read_b128 v[168:171], v12 offset:0
  ds_read_b128 v[172:175], v13 offset:0
  s_waitcnt lgkmcnt(12)
  v_mfma_f32_32x32x16_bf16 v[96:111], v[28:31], v[152:155], v[96:111]
  s_waitcnt lgkmcnt(0)
  s_barrier
  v_mfma_f32_32x32x16_bf16 v[48:63], v[32:35], v[156:159], v[48:63]
  ds_read_b64_tr_b16 v[16:17], v6 offset:49152
  ds_read_b64_tr_b16 v[18:19], v6 offset:50176
  ds_read_b64_tr_b16 v[20:21], v7 offset:49152
  v_mfma_f32_32x32x16_bf16 v[64:79], v[36:39], v[156:159], v[64:79]
  ds_read_b64_tr_b16 v[22:23], v7 offset:50176
  ds_read_b64_tr_b16 v[24:25], v8 offset:49152
  ds_read_b64_tr_b16 v[26:27], v8 offset:50176
  v_mfma_f32_32x32x16_bf16 v[80:95], v[40:43], v[156:159], v[80:95]
  ds_read_b64_tr_b16 v[28:29], v9 offset:49152
  ds_read_b64_tr_b16 v[30:31], v9 offset:50176
  s_add_u32 s67, s66, 6
  s_and_b32 s67, s67, 7
  s_lshl_b32 s67, s67, 19
  s_add_u32 s67, s67, s59
  s_add_u32 m0, s62, 32768
  s_add_u32 s57, s67, 0
  buffer_load_dwordx4 v2, s[12:15], s57 offen lds
  s_add_u32 m0, s62, 33792
  s_add_u32 s57, s67, 32768
  buffer_load_dwordx4 v2, s[12:15], s57 offen lds
  v_mfma_f32_32x32x16_bf16 v[96:111], v[44:47], v[156:159], v[96:111]
  s_waitcnt lgkmcnt(6)
  v_mfma_f32_32x32x16_bf16 v[48:63], v[16:19], v[160:163], v[48:63]
  ds_read_b64_tr_b16 v[32:33], v6 offset:53248
  ds_read_b64_tr_b16 v[34:35], v6 offset:54272
  ds_read_b64_tr_b16 v[36:37], v7 offset:53248
  s_add_u32 s67, s66, 6
  s_and_b32 s67, s67, 7
  s_lshl_b32 s67, s67, 7
  s_add_u32 s67, s67, s60
  s_add_u32 m0, s61, 0
  s_add_u32 s57, s67, 0
  buffer_load_dwordx4 v3, s[8:11], s57 offen lds
  s_add_u32 m0, s61, 1024
  s_add_u32 s57, s67, 8192
  buffer_load_dwordx4 v4, s[8:11], s57 offen lds
  s_add_u32 m0, s61, 2048
  s_add_u32 s57, s67, 16384
  buffer_load_dwordx4 v3, s[8:11], s57 offen lds
  s_add_u32 m0, s61, 3072
  s_add_u32 s57, s67, 24576
  buffer_load_dwordx4 v4, s[8:11], s57 offen lds
  s_waitcnt lgkmcnt(7)
  v_mfma_f32_32x32x16_bf16 v[64:79], v[20:23], v[160:163], v[64:79]
  ds_read_b64_tr_b16 v[38:39], v7 offset:54272
  ds_read_b64_tr_b16 v[40:41], v8 offset:53248
  ds_read_b64_tr_b16 v[42:43], v8 offset:54272
  s_waitcnt lgkmcnt(8)
  v_mfma_f32_32x32x16_bf16 v[80:95], v[24:27], v[160:163], v[80:95]
  ds_read_b64_tr_b16 v[44:45], v9 offset:53248
  ds_read_b64_tr_b16 v[46:47], v9 offset:54272
  s_waitcnt lgkmcnt(8)
  v_mfma_f32_32x32x16_bf16 v[96:111], v[28:31], v[160:163], v[96:111]
  s_waitcnt vmcnt(13)
  s_waitcnt lgkmcnt(6)
  v_mfma_f32_32x32x16_bf16 v[48:63], v[32:35], v[164:167], v[48:63]
  ds_read_b64_tr_b16 v[16:17], v6 offset:57344
  ds_read_b64_tr_b16 v[18:19], v6 offset:58368
  ds_read_b64_tr_b16 v[20:21], v7 offset:57344
  ds_read_b64_tr_b16 v[22:23], v7 offset:58368
  s_waitcnt lgkmcnt(8)
  v_mfma_f32_32x32x16_bf16 v[64:79], v[36:39], v[164:167], v[64:79]
  ds_read_b64_tr_b16 v[24:25], v8 offset:57344
  ds_read_b64_tr_b16 v[26:27], v8 offset:58368
  ds_read_b64_tr_b16 v[28:29], v9 offset:57344
  ds_read_b64_tr_b16 v[30:31], v9 offset:58368
  s_mov_b32 s36, s40
  s_mov_b32 s37, s41
  s_mov_b32 s38, 524288
  s_mov_b32 s39, 0x20000
  s_add_u32 s58, s65, 0
  v_add_u32 v14, s58, v5
  buffer_load_dwordx4 v[252:255], v14, s[36:39], 0 offen
  s_waitcnt lgkmcnt(10)
  v_mfma_f32_32x32x16_bf16 v[80:95], v[40:43], v[164:167], v[80:95]
  ds_read_b128 v[176:179], v10 offset:4096
  ds_read_b128 v[180:183], v11 offset:4096
  s_waitcnt lgkmcnt(10)
  v_mfma_f32_32x32x16_bf16 v[96:111], v[44:47], v[164:167], v[96:111]
  s_waitcnt lgkmcnt(8)
  v_mfma_f32_32x32x16_bf16 v[48:63], v[16:19], v[168:171], v[48:63]
  ds_read_b64_tr_b16 v[32:33], v6 offset:61440
  ds_read_b64_tr_b16 v[34:35], v6 offset:62464
  ds_read_b64_tr_b16 v[36:37], v7 offset:61440
  ds_read_b64_tr_b16 v[38:39], v7 offset:62464
  s_waitcnt lgkmcnt(10)
  v_mfma_f32_32x32x16_bf16 v[64:79], v[20:23], v[168:171], v[64:79]
  ds_read_b64_tr_b16 v[40:41], v8 offset:61440
  ds_read_b64_tr_b16 v[42:43], v8 offset:62464
  ds_read_b64_tr_b16 v[44:45], v9 offset:61440
  ds_read_b64_tr_b16 v[46:47], v9 offset:62464
  s_waitcnt lgkmcnt(12)
  v_mfma_f32_32x32x16_bf16 v[80:95], v[24:27], v[168:171], v[80:95]
  ds_read_b128 v[184:187], v12 offset:4096
  ds_read_b128 v[188:191], v13 offset:4096
  s_waitcnt lgkmcnt(12)
  v_mfma_f32_32x32x16_bf16 v[96:111], v[28:31], v[168:171], v[96:111]
  s_waitcnt lgkmcnt(0)
  s_barrier
  v_mfma_f32_32x32x16_bf16 v[48:63], v[32:35], v[172:175], v[48:63]
  ds_read_b64_tr_b16 v[16:17], v6 offset:0
  ds_read_b64_tr_b16 v[18:19], v6 offset:1024
  ds_read_b64_tr_b16 v[20:21], v7 offset:0
  v_mfma_f32_32x32x16_bf16 v[64:79], v[36:39], v[172:175], v[64:79]
  ds_read_b64_tr_b16 v[22:23], v7 offset:1024
  ds_read_b64_tr_b16 v[24:25], v8 offset:0
  ds_read_b64_tr_b16 v[26:27], v8 offset:1024
  v_mfma_f32_32x32x16_bf16 v[80:95], v[40:43], v[172:175], v[80:95]
  ds_read_b64_tr_b16 v[28:29], v9 offset:0
  ds_read_b64_tr_b16 v[30:31], v9 offset:1024
  s_add_u32 s67, s66, 7
  s_and_b32 s67, s67, 7
  s_lshl_b32 s67, s67, 19
  s_add_u32 s67, s67, s59
  s_add_u32 m0, s62, 49152
  s_add_u32 s57, s67, 0
  buffer_load_dwordx4 v2, s[12:15], s57 offen lds
  s_add_u32 m0, s62, 50176
  s_add_u32 s57, s67, 32768
  buffer_load_dwordx4 v2, s[12:15], s57 offen lds
  v_mfma_f32_32x32x16_bf16 v[96:111], v[44:47], v[172:175], v[96:111]
  s_waitcnt lgkmcnt(6)
  v_mfma_f32_32x32x16_bf16 v[48:63], v[16:19], v[176:179], v[48:63]
  ds_read_b64_tr_b16 v[32:33], v6 offset:4096
  ds_read_b64_tr_b16 v[34:35], v6 offset:5120
  ds_read_b64_tr_b16 v[36:37], v7 offset:4096
  s_add_u32 s67, s66, 7
  s_and_b32 s67, s67, 7
  s_lshl_b32 s67, s67, 7
  s_add_u32 s67, s67, s60
  s_add_u32 m0, s61, 4096
  s_add_u32 s57, s67, 0
  buffer_load_dwordx4 v3, s[8:11], s57 offen lds
  s_add_u32 m0, s61, 5120
  s_add_u32 s57, s67, 8192
  buffer_load_dwordx4 v4, s[8:11], s57 offen lds
  s_add_u32 m0, s61, 6144
  s_add_u32 s57, s67, 16384
  buffer_load_dwordx4 v3, s[8:11], s57 offen lds
  s_add_u32 m0, s61, 7168
  s_add_u32 s57, s67, 24576
  buffer_load_dwordx4 v4, s[8:11], s57 offen lds
  s_waitcnt lgkmcnt(7)
  v_mfma_f32_32x32x16_bf16 v[64:79], v[20:23], v[176:179], v[64:79]
  ds_read_b64_tr_b16 v[38:39], v7 offset:5120
  ds_read_b64_tr_b16 v[40:41], v8 offset:4096
  ds_read_b64_tr_b16 v[42:43], v8 offset:5120
  s_waitcnt lgkmcnt(8)
  v_mfma_f32_32x32x16_bf16 v[80:95], v[24:27], v[176:179], v[80:95]
  ds_read_b64_tr_b16 v[44:45], v9 offset:4096
  ds_read_b64_tr_b16 v[46:47], v9 offset:5120
  s_waitcnt lgkmcnt(8)
  v_mfma_f32_32x32x16_bf16 v[96:111], v[28:31], v[176:179], v[96:111]
  s_waitcnt vmcnt(14)
  s_waitcnt lgkmcnt(6)
  v_mfma_f32_32x32x16_bf16 v[48:63], v[32:35], v[180:183], v[48:63]
  ds_read_b64_tr_b16 v[16:17], v6 offset:8192
  ds_read_b64_tr_b16 v[18:19], v6 offset:9216
  ds_read_b64_tr_b16 v[20:21], v7 offset:8192
  ds_read_b64_tr_b16 v[22:23], v7 offset:9216
  s_waitcnt lgkmcnt(8)
  v_mfma_f32_32x32x16_bf16 v[64:79], v[36:39], v[180:183], v[64:79]
  ds_read_b64_tr_b16 v[24:25], v8 offset:8192
  ds_read_b64_tr_b16 v[26:27], v8 offset:9216
  ds_read_b64_tr_b16 v[28:29], v9 offset:8192
  ds_read_b64_tr_b16 v[30:31], v9 offset:9216
  s_waitcnt lgkmcnt(10)
  v_mfma_f32_32x32x16_bf16 v[80:95], v[40:43], v[180:183], v[80:95]
  ds_read_b128 v[192:195], v10 offset:8192
  ds_read_b128 v[196:199], v11 offset:8192
  v_lshrrev_b32 v14, 3, v1
  v_bfe_u32 v15, v1, 1, 2
  v_bfe_u32 v3, v1, 4, 2
  v_xor_b32 v15, v15, v3
  v_lshlrev_b32 v15, 5, v15
  v_and_b32 v3, 1, v1
  v_lshl_add_u32 v15, v3, 4, v15
  v_lshl_add_u32 v3, v14, 10, v15
  s_mov_b32 s24, s6
  s_mov_b32 s25, s7
  s_mov_b32 s26, 524288
  s_mov_b32 s27, 0x20000
  s_waitcnt lgkmcnt(10)
  v_mfma_f32_32x32x16_bf16 v[96:111], v[44:47], v[180:183], v[96:111]
  s_waitcnt lgkmcnt(8)
  v_mfma_f32_32x32x16_bf16 v[48:63], v[16:19], v[184:187], v[48:63]
  ds_read_b64_tr_b16 v[32:33], v6 offset:12288
  ds_read_b64_tr_b16 v[34:35], v6 offset:13312
  ds_read_b64_tr_b16 v[36:37], v7 offset:12288
  ds_read_b64_tr_b16 v[38:39], v7 offset:13312
  s_waitcnt lgkmcnt(10)
  v_mfma_f32_32x32x16_bf16 v[64:79], v[20:23], v[184:187], v[64:79]
  ds_read_b64_tr_b16 v[40:41], v8 offset:12288
  ds_read_b64_tr_b16 v[42:43], v8 offset:13312
  ds_read_b64_tr_b16 v[44:45], v9 offset:12288
  ds_read_b64_tr_b16 v[46:47], v9 offset:13312
  s_cmp_lg_u32 s54, 0
  s_cbranch_scc1 kv_kernel_pol2
  s_lshl_b32 s57, s44, 3
  v_mov_b32 v14, s57
  buffer_load_dword v4, v14, s[32:35], 0 offen sc1
kv_kernel_pol2:
  s_waitcnt lgkmcnt(12)
  v_mfma_f32_32x32x16_bf16 v[80:95], v[24:27], v[184:187], v[80:95]
  ds_read_b128 v[200:203], v12 offset:8192
  ds_read_b128 v[204:207], v13 offset:8192
  s_waitcnt lgkmcnt(12)
  v_mfma_f32_32x32x16_bf16 v[96:111], v[28:31], v[184:187], v[96:111]
  s_waitcnt lgkmcnt(0)
  s_barrier
  v_mfma_f32_32x32x16_bf16 v[48:63], v[32:35], v[188:191], v[48:63]
  ds_read_b64_tr_b16 v[16:17], v6 offset:16384
  ds_read_b64_tr_b16 v[18:19], v6 offset:17408
  ds_read_b64_tr_b16 v[20:21], v7 offset:16384
  v_mfma_f32_32x32x16_bf16 v[64:79], v[36:39], v[188:191], v[64:79]
  ds_read_b64_tr_b16 v[22:23], v7 offset:17408
  ds_read_b64_tr_b16 v[24:25], v8 offset:16384
  ds_read_b64_tr_b16 v[26:27], v8 offset:17408
  v_mfma_f32_32x32x16_bf16 v[80:95], v[40:43], v[188:191], v[80:95]
  ds_read_b64_tr_b16 v[28:29], v9 offset:16384
  ds_read_b64_tr_b16 v[30:31], v9 offset:17408
  s_add_u32 s67, s66, 0
  s_and_b32 s67, s67, 7
  s_lshl_b32 s67, s67, 19
  s_add_u32 s67, s67, s59
  s_add_u32 m0, s62, 0
  s_add_u32 s57, s67, 0
  buffer_load_dwordx4 v2, s[16:19], s57 offen lds
  s_add_u32 m0, s62, 1024
  s_add_u32 s57, s67, 32768
  buffer_load_dwordx4 v2, s[16:19], s57 offen lds
  v_mfma_f32_32x32x16_bf16 v[96:111], v[44:47], v[188:191], v[96:111]
  s_waitcnt lgkmcnt(6)
  v_mfma_f32_32x32x16_bf16 v[48:63], v[16:19], v[192:195], v[48:63]
  ds_read_b64_tr_b16 v[32:33], v6 offset:20480
  ds_read_b64_tr_b16 v[34:35], v6 offset:21504
  ds_read_b64_tr_b16 v[36:37], v7 offset:20480
  s_waitcnt lgkmcnt(7)
  v_mfma_f32_32x32x16_bf16 v[64:79], v[20:23], v[192:195], v[64:79]
  ds_read_b64_tr_b16 v[38:39], v7 offset:21504
  ds_read_b64_tr_b16 v[40:41], v8 offset:20480
  ds_read_b64_tr_b16 v[42:43], v8 offset:21504
  s_add_u32 m0, s61, 8192
  s_add_u32 s57, s45, 0
  buffer_load_dwordx4 v3, s[24:27], s57 offen lds
  s_waitcnt lgkmcnt(8)
  v_mfma_f32_32x32x16_bf16 v[80:95], v[24:27], v[192:195], v[80:95]
  ds_read_b64_tr_b16 v[44:45], v9 offset:20480
  ds_read_b64_tr_b16 v[46:47], v9 offset:21504
  s_add_u32 m0, s61, 9216
  s_add_u32 s57, s45, 8192
  buffer_load_dwordx4 v3, s[24:27], s57 offen lds
  s_waitcnt lgkmcnt(8)
  v_mfma_f32_32x32x16_bf16 v[96:111], v[28:31], v[192:195], v[96:111]
  s_waitcnt vmcnt(11)
  s_waitcnt lgkmcnt(6)
  v_mfma_f32_32x32x16_bf16 v[48:63], v[32:35], v[196:199], v[48:63]
  ds_read_b64_tr_b16 v[16:17], v6 offset:24576
  ds_read_b64_tr_b16 v[18:19], v6 offset:25600
  ds_read_b64_tr_b16 v[20:21], v7 offset:24576
  ds_read_b64_tr_b16 v[22:23], v7 offset:25600
  s_waitcnt lgkmcnt(8)
  v_mfma_f32_32x32x16_bf16 v[64:79], v[36:39], v[196:199], v[64:79]
  ds_read_b64_tr_b16 v[24:25], v8 offset:24576
  ds_read_b64_tr_b16 v[26:27], v8 offset:25600
  ds_read_b64_tr_b16 v[28:29], v9 offset:24576
  ds_read_b64_tr_b16 v[30:31], v9 offset:25600
  s_add_u32 m0, s61, 10240
  s_add_u32 s57, s45, 16384
  buffer_load_dwordx4 v3, s[24:27], s57 offen lds
  s_waitcnt lgkmcnt(10)
  v_mfma_f32_32x32x16_bf16 v[80:95], v[40:43], v[196:199], v[80:95]
  ds_read_b128 v[208:211], v10 offset:0
  ds_read_b128 v[212:215], v11 offset:0
  s_add_u32 m0, s61, 11264
  s_add_u32 s57, s45, 24576
  buffer_load_dwordx4 v3, s[24:27], s57 offen lds
  s_waitcnt lgkmcnt(10)
  v_mfma_f32_32x32x16_bf16 v[96:111], v[44:47], v[196:199], v[96:111]
  s_waitcnt lgkmcnt(8)
  v_mfma_f32_32x32x16_bf16 v[48:63], v[16:19], v[200:203], v[48:63]
  ds_read_b64_tr_b16 v[32:33], v6 offset:28672
  ds_read_b64_tr_b16 v[34:35], v6 offset:29696
  ds_read_b64_tr_b16 v[36:37], v7 offset:28672
  ds_read_b64_tr_b16 v[38:39], v7 offset:29696
  s_waitcnt lgkmcnt(10)
  v_mfma_f32_32x32x16_bf16 v[64:79], v[20:23], v[200:203], v[64:79]
  ds_read_b64_tr_b16 v[40:41], v8 offset:28672
  ds_read_b64_tr_b16 v[42:43], v8 offset:29696
  ds_read_b64_tr_b16 v[44:45], v9 offset:28672
  ds_read_b64_tr_b16 v[46:47], v9 offset:29696
  s_waitcnt lgkmcnt(12)
  v_mfma_f32_32x32x16_bf16 v[80:95], v[24:27], v[200:203], v[80:95]
  ds_read_b128 v[216:219], v12 offset:0
  ds_read_b128 v[220:223], v13 offset:0
  s_waitcnt lgkmcnt(12)
  v_mfma_f32_32x32x16_bf16 v[96:111], v[28:31], v[200:203], v[96:111]
  s_waitcnt lgkmcnt(0)
  s_cmp_lg_u32 s54, 0
  s_cbranch_scc1 kv_kernel_chk3
  s_waitcnt vmcnt(6)
  v_and_b32 v4, 255, v4
  v_cmp_le_u32 vcc, 8, v4
  s_cmp_eq_u64 vcc, -1
  s_cbranch_scc1 kv_kernel_chk3
  s_mov_b32 s49, 16384
kv_kernel_spin4:
  s_lshl_b32 s57, s44, 3
  v_mov_b32 v14, s57
  buffer_load_dword v4, v14, s[32:35], 0 offen sc1
  s_waitcnt vmcnt(0)
  v_and_b32 v4, 255, v4
  v_cmp_le_u32 vcc, 8, v4
  s_cmp_eq_u64 vcc, -1
  s_cbranch_scc1 kv_kernel_chk3
  s_sub_u32 s49, s49, 1
  s_cmp_eq_u32 s49, 0
  s_cbranch_scc0 kv_kernel_spin4
kv_kernel_chk3:
  s_barrier
  v_mfma_f32_32x32x16_bf16 v[48:63], v[32:35], v[204:207], v[48:63]
  ds_read_b64_tr_b16 v[16:17], v6 offset:32768
  ds_read_b64_tr_b16 v[18:19], v6 offset:33792
  ds_read_b64_tr_b16 v[20:21], v7 offset:32768
  v_mfma_f32_32x32x16_bf16 v[64:79], v[36:39], v[204:207], v[64:79]
  ds_read_b64_tr_b16 v[22:23], v7 offset:33792
  ds_read_b64_tr_b16 v[24:25], v8 offset:32768
  ds_read_b64_tr_b16 v[26:27], v8 offset:33792
  v_mfma_f32_32x32x16_bf16 v[80:95], v[40:43], v[204:207], v[80:95]
  ds_read_b64_tr_b16 v[28:29], v9 offset:32768
  ds_read_b64_tr_b16 v[30:31], v9 offset:33792
  s_add_u32 s67, s66, 1
  s_and_b32 s67, s67, 7
  s_lshl_b32 s67, s67, 19
  s_add_u32 s67, s67, s59
  s_add_u32 m0, s62, 16384
  s_add_u32 s57, s67, 0
  buffer_load_dwordx4 v2, s[16:19], s57 offen lds
  s_add_u32 m0, s62, 17408
  s_add_u32 s57, s67, 32768
  buffer_load_dwordx4 v2, s[16:19], s57 offen lds
  v_mfma_f32_32x32x16_bf16 v[96:111], v[44:47], v[204:207], v[96:111]
  s_waitcnt lgkmcnt(6)
  v_mfma_f32_32x32x16_bf16 v[48:63], v[16:19], v[208:211], v[48:63]
  ds_read_b64_tr_b16 v[32:33], v6 offset:36864
  ds_read_b64_tr_b16 v[34:35], v6 offset:37888
  ds_read_b64_tr_b16 v[36:37], v7 offset:36864
  s_waitcnt lgkmcnt(7)
  v_mfma_f32_32x32x16_bf16 v[64:79], v[20:23], v[208:211], v[64:79]
  ds_read_b64_tr_b16 v[38:39], v7 offset:37888
  ds_read_b64_tr_b16 v[40:41], v8 offset:36864
  ds_read_b64_tr_b16 v[42:43], v8 offset:37888
  s_add_u32 m0, s61, 0
  s_add_u32 s57, s45, 262144
  buffer_load_dwordx4 v3, s[24:27], s57 offen lds
  s_waitcnt lgkmcnt(8)
  v_mfma_f32_32x32x16_bf16 v[80:95], v[24:27], v[208:211], v[80:95]
  ds_read_b64_tr_b16 v[44:45], v9 offset:36864
  ds_read_b64_tr_b16 v[46:47], v9 offset:37888
  s_add_u32 m0, s61, 1024
  s_add_u32 s57, s45, 270336
  buffer_load_dwordx4 v3, s[24:27], s57 offen lds
  s_waitcnt lgkmcnt(8)
  v_mfma_f32_32x32x16_bf16 v[96:111], v[28:31], v[208:211], v[96:111]
  s_waitcnt vmcnt(10)
  s_waitcnt lgkmcnt(6)
  v_mfma_f32_32x32x16_bf16 v[48:63], v[32:35], v[212:215], v[48:63]
  ds_read_b64_tr_b16 v[16:17], v6 offset:40960
  ds_read_b64_tr_b16 v[18:19], v6 offset:41984
  ds_read_b64_tr_b16 v[20:21], v7 offset:40960
  ds_read_b64_tr_b16 v[22:23], v7 offset:41984
  s_waitcnt lgkmcnt(8)
  v_mfma_f32_32x32x16_bf16 v[64:79], v[36:39], v[212:215], v[64:79]
  ds_read_b64_tr_b16 v[24:25], v8 offset:40960
  ds_read_b64_tr_b16 v[26:27], v8 offset:41984
  ds_read_b64_tr_b16 v[28:29], v9 offset:40960
  ds_read_b64_tr_b16 v[30:31], v9 offset:41984
  s_add_u32 m0, s61, 2048
  s_add_u32 s57, s45, 278528
  buffer_load_dwordx4 v3, s[24:27], s57 offen lds
  s_waitcnt lgkmcnt(10)
  v_mfma_f32_32x32x16_bf16 v[80:95], v[40:43], v[212:215], v[80:95]
  ds_read_b128 v[224:227], v10 offset:4096
  ds_read_b128 v[228:231], v11 offset:4096
  s_add_u32 m0, s61, 3072
  s_add_u32 s57, s45, 286720
  buffer_load_dwordx4 v3, s[24:27], s57 offen lds
  s_waitcnt lgkmcnt(10)
  v_mfma_f32_32x32x16_bf16 v[96:111], v[44:47], v[212:215], v[96:111]
  s_waitcnt lgkmcnt(8)
  v_mfma_f32_32x32x16_bf16 v[48:63], v[16:19], v[216:219], v[48:63]
  ds_read_b64_tr_b16 v[32:33], v6 offset:45056
  ds_read_b64_tr_b16 v[34:35], v6 offset:46080
  ds_read_b64_tr_b16 v[36:37], v7 offset:45056
  ds_read_b64_tr_b16 v[38:39], v7 offset:46080
  s_waitcnt lgkmcnt(10)
  v_mfma_f32_32x32x16_bf16 v[64:79], v[20:23], v[216:219], v[64:79]
  ds_read_b64_tr_b16 v[40:41], v8 offset:45056
  ds_read_b64_tr_b16 v[42:43], v8 offset:46080
  ds_read_b64_tr_b16 v[44:45], v9 offset:45056
  ds_read_b64_tr_b16 v[46:47], v9 offset:46080
  s_add_u32 s57, s47, 2097152
  buffer_load_dwordx4 v[240:243], v5, s[28:31], s57 offen offset:0 sc1
  s_waitcnt lgkmcnt(12)
  v_mfma_f32_32x32x16_bf16 v[80:95], v[24:27], v[216:219], v[80:95]
  ds_read_b128 v[232:235], v12 offset:4096
  ds_read_b128 v[236:239], v13 offset:4096
  s_waitcnt lgkmcnt(12)
  v_mfma_f32_32x32x16_bf16 v[96:111], v[28:31], v[216:219], v[96:111]
  s_add_u32 s57, s47, 2097152
  buffer_load_dwordx4 v[244:247], v5, s[28:31], s57 offen offset:2048 sc1
  s_waitcnt lgkmcnt(0)
  s_barrier
  v_mfma_f32_32x32x16_bf16 v[48:63], v[32:35], v[220:223], v[48:63]
  ds_read_b64_tr_b16 v[16:17], v6 offset:49152
  ds_read_b64_tr_b16 v[18:19], v6 offset:50176
  ds_read_b64_tr_b16 v[20:21], v7 offset:49152
  v_mfma_f32_32x32x16_bf16 v[64:79], v[36:39], v[220:223], v[64:79]
  ds_read_b64_tr_b16 v[22:23], v7 offset:50176
  ds_read_b64_tr_b16 v[24:25], v8 offset:49152
  ds_read_b64_tr_b16 v[26:27], v8 offset:50176
  v_mfma_f32_32x32x16_bf16 v[80:95], v[40:43], v[220:223], v[80:95]
  ds_read_b64_tr_b16 v[28:29], v9 offset:49152
  ds_read_b64_tr_b16 v[30:31], v9 offset:50176
  s_add_u32 s67, s66, 2
  s_and_b32 s67, s67, 7
  s_lshl_b32 s67, s67, 19
  s_add_u32 s67, s67, s59
  s_add_u32 m0, s62, 32768
  s_add_u32 s57, s67, 0
  buffer_load_dwordx4 v2, s[16:19], s57 offen lds
  s_add_u32 m0, s62, 33792
  s_add_u32 s57, s67, 32768
  buffer_load_dwordx4 v2, s[16:19], s57 offen lds
  v_mfma_f32_32x32x16_bf16 v[96:111], v[44:47], v[220:223], v[96:111]
  s_waitcnt lgkmcnt(6)
  v_mfma_f32_32x32x16_bf16 v[48:63], v[16:19], v[224:227], v[48:63]
  ds_read_b64_tr_b16 v[32:33], v6 offset:53248
  ds_read_b64_tr_b16 v[34:35], v6 offset:54272
  ds_read_b64_tr_b16 v[36:37], v7 offset:53248
  s_waitcnt lgkmcnt(7)
  v_mfma_f32_32x32x16_bf16 v[64:79], v[20:23], v[224:227], v[64:79]
  ds_read_b64_tr_b16 v[38:39], v7 offset:54272
  ds_read_b64_tr_b16 v[40:41], v8 offset:53248
  ds_read_b64_tr_b16 v[42:43], v8 offset:54272
  s_add_u32 s57, s47, 2105344
  buffer_load_dwordx4 v[248:251], v5, s[28:31], s57 offen offset:0 sc1
  s_waitcnt lgkmcnt(8)
  v_mfma_f32_32x32x16_bf16 v[80:95], v[24:27], v[224:227], v[80:95]
  ds_read_b64_tr_b16 v[44:45], v9 offset:53248
  ds_read_b64_tr_b16 v[46:47], v9 offset:54272
  s_waitcnt lgkmcnt(8)
  v_mfma_f32_32x32x16_bf16 v[96:111], v[28:31], v[224:227], v[96:111]
  s_add_u32 s57, s47, 2105344
  buffer_load_dwordx4 v[252:255], v5, s[28:31], s57 offen offset:2048 sc1
  s_waitcnt lgkmcnt(6)
  v_mfma_f32_32x32x16_bf16 v[48:63], v[32:35], v[228:231], v[48:63]
  ds_read_b64_tr_b16 v[16:17], v6 offset:57344
  ds_read_b64_tr_b16 v[18:19], v6 offset:58368
  ds_read_b64_tr_b16 v[20:21], v7 offset:57344
  v_bfe_u32 v14, v1, 2, 2
  v_lshrrev_b32 v15, 4, v1
  v_lshl_add_u32 v14, v15, 2, v14
  v_bfe_u32 v15, v14, 1, 2
  s_lshl_b32 s57, s50, 1
  v_xor_b32 v15, s57, v15
  v_lshlrev_b32 v14, 7, v14
  v_and_b32 v10, 3, v1
  v_lshl_add_u32 v14, v10, 3, v14
  s_mul_i32 s57, s50, 12288
  s_add_u32 s57, s57, 65536
  v_add_u32 v14, s57, v14
  v_xor_b32 v10, 0, v15
  v_lshl_add_u32 v10, v10, 5, v14
  v_xor_b32 v11, 1, v15
  v_lshl_add_u32 v11, v11, 5, v14
  v_xor_b32 v12, 2, v15
  v_lshl_add_u32 v12, v12, 5, v14
  v_xor_b32 v13, 3, v15
  v_lshl_add_u32 v13, v13, 5, v14
  s_waitcnt lgkmcnt(7)
  v_mfma_f32_32x32x16_bf16 v[64:79], v[36:39], v[228:231], v[64:79]
  ds_read_b64_tr_b16 v[22:23], v7 offset:58368
  ds_read_b64_tr_b16 v[24:25], v8 offset:57344
  ds_read_b64_tr_b16 v[26:27], v8 offset:58368
  s_waitcnt lgkmcnt(8)
  v_mfma_f32_32x32x16_bf16 v[80:95], v[40:43], v[228:231], v[80:95]
  ds_read_b64_tr_b16 v[28:29], v9 offset:57344
  ds_read_b64_tr_b16 v[30:31], v9 offset:58368
  s_waitcnt lgkmcnt(8)
  v_mfma_f32_32x32x16_bf16 v[96:111], v[44:47], v[228:231], v[96:111]
  s_waitcnt lgkmcnt(6)
  v_mfma_f32_32x32x16_bf16 v[48:63], v[16:19], v[232:235], v[48:63]
  ds_read_b64_tr_b16 v[32:33], v6 offset:61440
  ds_read_b64_tr_b16 v[34:35], v6 offset:62464
  ds_read_b64_tr_b16 v[36:37], v7 offset:61440
  s_waitcnt lgkmcnt(7)
  v_mfma_f32_32x32x16_bf16 v[64:79], v[20:23], v[232:235], v[64:79]
  ds_read_b64_tr_b16 v[38:39], v7 offset:62464
  ds_read_b64_tr_b16 v[40:41], v8 offset:61440
  ds_read_b64_tr_b16 v[42:43], v8 offset:62464
  s_waitcnt lgkmcnt(8)
  v_mfma_f32_32x32x16_bf16 v[80:95], v[24:27], v[232:235], v[80:95]
  ds_read_b64_tr_b16 v[44:45], v9 offset:61440
  ds_read_b64_tr_b16 v[46:47], v9 offset:62464
  s_waitcnt lgkmcnt(8)
  v_mfma_f32_32x32x16_bf16 v[96:111], v[28:31], v[232:235], v[96:111]
  s_waitcnt lgkmcnt(0)
  s_waitcnt vmcnt(6)
  s_barrier
  v_mfma_f32_32x32x16_bf16 v[48:63], v[32:35], v[236:239], v[48:63]
  ds_read_b64_tr_b16 v[16:17], v10 offset:8192
  ds_read_b64_tr_b16 v[18:19], v10 offset:10240
  ds_read_b64_tr_b16 v[20:21], v11 offset:8192
  v_mfma_f32_32x32x16_bf16 v[64:79], v[36:39], v[236:239], v[64:79]
  ds_read_b64_tr_b16 v[22:23], v11 offset:10240
  ds_read_b64_tr_b16 v[24:25], v12 offset:8192
  ds_read_b64_tr_b16 v[26:27], v12 offset:10240
  v_mfma_f32_32x32x16_bf16 v[80:95], v[40:43], v[236:239], v[80:95]
  ds_read_b64_tr_b16 v[28:29], v13 offset:8192
  ds_read_b64_tr_b16 v[30:31], v13 offset:10240
  s_add_u32 s67, s66, 3
  s_and_b32 s67, s67, 7
  s_lshl_b32 s67, s67, 19
  s_add_u32 s67, s67, s59
  s_add_u32 m0, s62, 49152
  s_add_u32 s57, s67, 0
  buffer_load_dwordx4 v2, s[16:19], s57 offen lds
  s_add_u32 m0, s62, 50176
  s_add_u32 s57, s67, 32768
  buffer_load_dwordx4 v2, s[16:19], s57 offen lds
  v_mfma_f32_32x32x16_bf16 v[96:111], v[44:47], v[236:239], v[96:111]
  v_cvt_pk_bf16_f32 v48, v48, v49
  v_cvt_pk_bf16_f32 v49, v50, v51
  v_cvt_pk_bf16_f32 v50, v52, v53
  v_cvt_pk_bf16_f32 v51, v54, v55
  v_cvt_pk_bf16_f32 v56, v56, v57
  v_cvt_pk_bf16_f32 v57, v58, v59
  v_cvt_pk_bf16_f32 v58, v60, v61
  v_cvt_pk_bf16_f32 v59, v62, v63
  v_cvt_pk_bf16_f32 v64, v64, v65
  v_cvt_pk_bf16_f32 v65, v66, v67
  v_cvt_pk_bf16_f32 v66, v68, v69
  v_cvt_pk_bf16_f32 v67, v70, v71
  v_cvt_pk_bf16_f32 v72, v72, v73
  v_cvt_pk_bf16_f32 v73, v74, v75
  v_cvt_pk_bf16_f32 v74, v76, v77
  v_cvt_pk_bf16_f32 v75, v78, v79
  s_add_u32 s57, s47, 2101248
  buffer_load_dwordx4 v[52:55], v5, s[28:31], s57 offen offset:0 sc1
  s_add_u32 s57, s47, 2101248
  buffer_load_dwordx4 v[60:63], v5, s[28:31], s57 offen offset:2048 sc1
  s_add_u32 s57, s47, 2109440
  buffer_load_dwordx4 v[68:71], v5, s[28:31], s57 offen offset:0 sc1
  s_add_u32 s57, s47, 2109440
  buffer_load_dwordx4 v[76:79], v5, s[28:31], s57 offen offset:2048 sc1
  v_cvt_pk_bf16_f32 v80, v80, v81
  v_cvt_pk_bf16_f32 v81, v82, v83
  v_cvt_pk_bf16_f32 v82, v84, v85
  v_cvt_pk_bf16_f32 v83, v86, v87
  v_cvt_pk_bf16_f32 v88, v88, v89
  v_cvt_pk_bf16_f32 v89, v90, v91
  v_cvt_pk_bf16_f32 v90, v92, v93
  v_cvt_pk_bf16_f32 v91, v94, v95
  v_cvt_pk_bf16_f32 v96, v96, v97
  v_cvt_pk_bf16_f32 v97, v98, v99
  v_cvt_pk_bf16_f32 v98, v100, v101
  v_cvt_pk_bf16_f32 v99, v102, v103
  v_cvt_pk_bf16_f32 v104, v104, v105
  v_cvt_pk_bf16_f32 v105, v106, v107
  v_cvt_pk_bf16_f32 v106, v108, v109
  v_cvt_pk_bf16_f32 v107, v110, v111
  ds_read_b64_tr_b16 v[32:33], v10 offset:32768
  ds_read_b64_tr_b16 v[34:35], v10 offset:34816
  ds_read_b64_tr_b16 v[36:37], v11 offset:32768
  ds_read_b64_tr_b16 v[38:39], v11 offset:34816
  ds_read_b64_tr_b16 v[40:41], v12 offset:32768
  ds_read_b64_tr_b16 v[42:43], v12 offset:34816
  s_waitcnt vmcnt(11) lgkmcnt(12)
  v_mfma_f32_16x16x32_bf16 v[84:87], v[16:19], v[240:243], 0
  ds_read_b64_tr_b16 v[44:45], v13 offset:32768
  ds_read_b64_tr_b16 v[46:47], v13 offset:34816
  s_waitcnt lgkmcnt(12)
  v_mfma_f32_16x16x32_bf16 v[92:95], v[20:23], v[240:243], 0
  ds_read_b64_tr_b16 v[16:17], v10 offset:0
  ds_read_b64_tr_b16 v[18:19], v10 offset:2048
  s_waitcnt lgkmcnt(12)
  v_mfma_f32_16x16x32_bf16 v[100:103], v[24:27], v[240:243], 0
  ds_read_b64_tr_b16 v[20:21], v11 offset:0
  ds_read_b64_tr_b16 v[22:23], v11 offset:2048
  s_add_u32 s57, s63, 0
  buffer_store_dwordx4 v[48:51], v5, s[20:23], s57 offen sc1
  s_waitcnt lgkmcnt(12)
  v_mfma_f32_16x16x32_bf16 v[108:111], v[28:31], v[240:243], 0
  ds_read_b64_tr_b16 v[24:25], v12 offset:0
  ds_read_b64_tr_b16 v[26:27], v12 offset:2048
  s_waitcnt vmcnt(11) lgkmcnt(12)
  v_mfma_f32_16x16x32_bf16 v[84:87], v[32:35], v[244:247], v[84:87]
  ds_read_b64_tr_b16 v[28:29], v13 offset:0
  ds_read_b64_tr_b16 v[30:31], v13 offset:2048
  s_waitcnt lgkmcnt(12)
  v_mfma_f32_16x16x32_bf16 v[92:95], v[36:39], v[244:247], v[92:95]
  ds_read_b64_tr_b16 v[32:33], v10 offset:24576
  ds_read_b64_tr_b16 v[34:35], v10 offset:26624
  s_waitcnt lgkmcnt(12)
  v_mfma_f32_16x16x32_bf16 v[100:103], v[40:43], v[244:247], v[100:103]
  ds_read_b64_tr_b16 v[36:37], v11 offset:24576
  ds_read_b64_tr_b16 v[38:39], v11 offset:26624
  s_waitcnt lgkmcnt(12)
  v_mfma_f32_16x16x32_bf16 v[108:111], v[44:47], v[244:247], v[108:111]
  ds_read_b64_tr_b16 v[40:41], v12 offset:24576
  ds_read_b64_tr_b16 v[42:43], v12 offset:26624
  s_waitcnt vmcnt(8) lgkmcnt(12)
  v_mfma_f32_16x16x32_bf16 v[84:87], v[16:19], v[248:251], v[84:87]
  ds_read_b64_tr_b16 v[44:45], v13 offset:24576
  ds_read_b64_tr_b16 v[46:47], v13 offset:26624
  s_waitcnt lgkmcnt(12)
  v_mfma_f32_16x16x32_bf16 v[92:95], v[20:23], v[248:251], v[92:95]
  v_add_u32 v10, 49152, v10
  v_add_u32 v11, 49152, v11
  v_add_u32 v12, 49152, v12
  v_add_u32 v13, 49152, v13
  ds_read_b64_tr_b16 v[16:17], v10 offset:8192
  ds_read_b64_tr_b16 v[18:19], v10 offset:10240
  s_add_u32 s57, s63, 1024
  buffer_store_dwordx4 v[56:59], v5, s[20:23], s57 offen sc1
  s_waitcnt lgkmcnt(12)
  v_mfma_f32_16x16x32_bf16 v[100:103], v[24:27], v[248:251], v[100:103]
  ds_read_b64_tr_b16 v[20:21], v11 offset:8192
  ds_read_b64_tr_b16 v[22:23], v11 offset:10240
  s_waitcnt lgkmcnt(12)
  v_mfma_f32_16x16x32_bf16 v[108:111], v[28:31], v[248:251], v[108:111]
  ds_read_b64_tr_b16 v[24:25], v12 offset:8192
  ds_read_b64_tr_b16 v[26:27], v12 offset:10240
  s_waitcnt vmcnt(8) lgkmcnt(12)
  v_mfma_f32_16x16x32_bf16 v[84:87], v[32:35], v[252:255], v[84:87]
  ds_read_b64_tr_b16 v[28:29], v13 offset:8192
  ds_read_b64_tr_b16 v[30:31], v13 offset:10240
  s_waitcnt lgkmcnt(12)
  v_mfma_f32_16x16x32_bf16 v[92:95], v[36:39], v[252:255], v[92:95]
  ds_read_b64_tr_b16 v[32:33], v10 offset:32768
  ds_read_b64_tr_b16 v[34:35], v10 offset:34816
  s_waitcnt lgkmcnt(12)
  v_mfma_f32_16x16x32_bf16 v[100:103], v[40:43], v[252:255], v[100:103]
  ds_read_b64_tr_b16 v[36:37], v11 offset:32768
  ds_read_b64_tr_b16 v[38:39], v11 offset:34816
  s_waitcnt lgkmcnt(12)
  v_mfma_f32_16x16x32_bf16 v[108:111], v[44:47], v[252:255], v[108:111]
  ds_read_b64_tr_b16 v[40:41], v12 offset:32768
  ds_read_b64_tr_b16 v[42:43], v12 offset:34816
  s_waitcnt vmcnt(5) lgkmcnt(12)
  v_mfma_f32_16x16x32_bf16 v[84:87], v[16:19], v[52:55], v[84:87]
  ds_read_b64_tr_b16 v[44:45], v13 offset:32768
  ds_read_b64_tr_b16 v[46:47], v13 offset:34816
  s_add_u32 s57, s63, 2048
  buffer_store_dwordx4 v[64:67], v5, s[20:23], s57 offen sc1
  s_waitcnt lgkmcnt(12)
  v_mfma_f32_16x16x32_bf16 v[92:95], v[20:23], v[52:55], v[92:95]
  ds_read_b64_tr_b16 v[16:17], v10 offset:0
  ds_read_b64_tr_b16 v[18:19], v10 offset:2048
  s_waitcnt lgkmcnt(12)
  v_mfma_f32_16x16x32_bf16 v[100:103], v[24:27], v[52:55], v[100:103]
  ds_read_b64_tr_b16 v[20:21], v11 offset:0
  ds_read_b64_tr_b16 v[22:23], v11 offset:2048
  s_waitcnt lgkmcnt(12)
  v_mfma_f32_16x16x32_bf16 v[108:111], v[28:31], v[52:55], v[108:111]
  ds_read_b64_tr_b16 v[24:25], v12 offset:0
  ds_read_b64_tr_b16 v[26:27], v12 offset:2048
  s_waitcnt vmcnt(5) lgkmcnt(12)
  v_mfma_f32_16x16x32_bf16 v[84:87], v[32:35], v[60:63], v[84:87]
  ds_read_b64_tr_b16 v[28:29], v13 offset:0
  ds_read_b64_tr_b16 v[30:31], v13 offset:2048
  s_waitcnt lgkmcnt(12)
  v_mfma_f32_16x16x32_bf16 v[92:95], v[36:39], v[60:63], v[92:95]
  ds_read_b64_tr_b16 v[32:33], v10 offset:24576
  ds_read_b64_tr_b16 v[34:35], v10 offset:26624
  s_waitcnt lgkmcnt(12)
  v_mfma_f32_16x16x32_bf16 v[100:103], v[40:43], v[60:63], v[100:103]
  ds_read_b64_tr_b16 v[36:37], v11 offset:24576
  ds_read_b64_tr_b16 v[38:39], v11 offset:26624
  s_waitcnt lgkmcnt(12)
  v_mfma_f32_16x16x32_bf16 v[108:111], v[44:47], v[60:63], v[108:111]
  ds_read_b64_tr_b16 v[40:41], v12 offset:24576
  ds_read_b64_tr_b16 v[42:43], v12 offset:26624
  s_add_u32 s57, s63, 3072
  buffer_store_dwordx4 v[72:75], v5, s[20:23], s57 offen sc1
  s_waitcnt vmcnt(5) lgkmcnt(12)
  v_mfma_f32_16x16x32_bf16 v[84:87], v[16:19], v[68:71], v[84:87]
  ds_read_b64_tr_b16 v[44:45], v13 offset:24576
  ds_read_b64_tr_b16 v[46:47], v13 offset:26624
  s_waitcnt lgkmcnt(12)
  v_mfma_f32_16x16x32_bf16 v[92:95], v[20:23], v[68:71], v[92:95]
  s_waitcnt lgkmcnt(10)
  v_mfma_f32_16x16x32_bf16 v[100:103], v[24:27], v[68:71], v[100:103]
  s_waitcnt lgkmcnt(8)
  v_mfma_f32_16x16x32_bf16 v[108:111], v[28:31], v[68:71], v[108:111]
  s_waitcnt vmcnt(4) lgkmcnt(6)
  v_mfma_f32_16x16x32_bf16 v[84:87], v[32:35], v[76:79], v[84:87]
  s_waitcnt lgkmcnt(4)
  v_mfma_f32_16x16x32_bf16 v[92:95], v[36:39], v[76:79], v[92:95]
  s_waitcnt lgkmcnt(2)
  v_mfma_f32_16x16x32_bf16 v[100:103], v[40:43], v[76:79], v[100:103]
  s_waitcnt lgkmcnt(0)
  v_mfma_f32_16x16x32_bf16 v[108:111], v[44:47], v[76:79], v[108:111]
  s_add_u32 s57, s61, 4096
  v_add_u32 v14, s57, v5
  s_nop 3
  ds_write_b128 v14, v[100:103]
  s_nop 0
  ds_write_b128 v14, v[108:111] offset:1024
  s_xor_b32 s57, s54, 4
  s_mul_i32 s57, s57, 12288
  s_add_u32 s57, s57, 69632
  v_add_u32 v15, s57, v5
  s_waitcnt lgkmcnt(0)
  s_barrier
  ds_read_b128 v[240:243], v15
  ds_read_b128 v[244:247], v15 offset:1024
  ds_read_b64_tr_b16 v[16:17], v6 offset:0
  ds_read_b64_tr_b16 v[18:19], v6 offset:1024
  ds_read_b64_tr_b16 v[20:21], v7 offset:0
  ds_read_b64_tr_b16 v[22:23], v7 offset:1024
  ds_read_b64_tr_b16 v[24:25], v8 offset:0
  ds_read_b64_tr_b16 v[26:27], v8 offset:1024
  ds_read_b64_tr_b16 v[28:29], v9 offset:0
  ds_read_b64_tr_b16 v[30:31], v9 offset:1024
  s_waitcnt lgkmcnt(9)
  v_add_f32 v84, v84, v240
  v_add_f32 v85, v85, v241
  v_add_f32 v86, v86, v242
  v_add_f32 v87, v87, v243
  s_waitcnt lgkmcnt(8)
  v_add_f32 v92, v92, v244
  v_add_f32 v93, v93, v245
  v_add_f32 v94, v94, v246
  v_add_f32 v95, v95, v247
  v_mov_b32 v15, 0xc0135761
  v_mul_f32 v248, v84, v84
  v_mul_f32 v249, v85, v85
  v_mul_f32 v250, v86, v86
  v_mul_f32 v251, v87, v87
  v_mul_f32 v252, v92, v92
  v_mul_f32 v253, v93, v93
  v_mul_f32 v254, v94, v94
  v_mul_f32 v255, v95, v95
  v_fma_f32 v248, v248, s48, v15
  v_fma_f32 v249, v249, s48, v15
  v_fma_f32 v250, v250, s48, v15
  v_fma_f32 v251, v251, s48, v15
  v_fma_f32 v252, v252, s48, v15
  v_fma_f32 v253, v253, s48, v15
  v_fma_f32 v254, v254, s48, v15
  v_fma_f32 v255, v255, s48, v15
  v_mul_f32 v248, v84, v248
  v_mul_f32 v249, v85, v249
  v_mul_f32 v250, v86, v250
  v_mul_f32 v251, v87, v251
  v_mul_f32 v252, v92, v252
  v_mul_f32 v253, v93, v253
  v_mul_f32 v254, v94, v254
  v_mul_f32 v255, v95, v255
  v_exp_f32 v248, v248
  v_exp_f32 v249, v249
  v_exp_f32 v250, v250
  v_exp_f32 v251, v251
  v_exp_f32 v252, v252
  v_exp_f32 v253, v253
  v_exp_f32 v254, v254
  v_exp_f32 v255, v255
  v_add_f32 v248, 1.0, v248
  v_add_f32 v249, 1.0, v249
  v_add_f32 v250, 1.0, v250
  v_add_f32 v251, 1.0, v251
  v_add_f32 v252, 1.0, v252
  v_add_f32 v253, 1.0, v253
  v_add_f32 v254, 1.0, v254
  v_add_f32 v255, 1.0, v255
  v_rcp_f32 v248, v248
  v_rcp_f32 v249, v249
  v_rcp_f32 v250, v250
  v_rcp_f32 v251, v251
  v_rcp_f32 v252, v252
  v_rcp_f32 v253, v253
  v_rcp_f32 v254, v254
  v_rcp_f32 v255, v255
  v_mul_f32 v84, v84, v248
  v_mul_f32 v85, v85, v249
  v_mul_f32 v86, v86, v250
  v_mul_f32 v87, v87, v251
  v_mul_f32 v92, v92, v252
  v_mul_f32 v93, v93, v253
  v_mul_f32 v94, v94, v254
  v_mul_f32 v95, v95, v255
  v_cvt_pk_bf16_f32 v52, v84, v85
  v_cvt_pk_bf16_f32 v53, v86, v87
  v_cvt_pk_bf16_f32 v54, v92, v93
  v_cvt_pk_bf16_f32 v55, v94, v95
  s_add_u32 s57, s46, 6291456
  buffer_store_dwordx4 v[52:55], v5, s[28:31], s57 offen sc1
  v_mov_b32 v240, v80
  v_mov_b32 v241, v81
  v_mov_b32 v242, v82
  v_mov_b32 v243, v83
  v_mov_b32 v244, v88
  v_mov_b32 v245, v89
  v_mov_b32 v246, v90
  v_mov_b32 v247, v91
  v_mov_b32 v248, v96
  v_mov_b32 v249, v97
  v_mov_b32 v250, v98
  v_mov_b32 v251, v99
  v_mov_b32 v252, v104
  v_mov_b32 v253, v105
  v_mov_b32 v254, v106
  v_mov_b32 v255, v107
  s_mov_b32 s24, s40
  s_mov_b32 s25, s41
  s_mov_b32 s26, 524288
  s_mov_b32 s27, 0x20000
  s_waitcnt lgkmcnt(6)
  v_mfma_f32_32x32x16_bf16 v[48:63], v[112:115], v[16:19], 0
  ds_read_b64_tr_b16 v[32:33], v6 offset:4096
  ds_read_b64_tr_b16 v[34:35], v6 offset:5120
  ds_read_b64_tr_b16 v[36:37], v7 offset:4096
  s_waitcnt lgkmcnt(7)
  v_mfma_f32_32x32x16_bf16 v[64:79], v[112:115], v[20:23], 0
  ds_read_b64_tr_b16 v[38:39], v7 offset:5120
  ds_read_b64_tr_b16 v[40:41], v8 offset:4096
  ds_read_b64_tr_b16 v[42:43], v8 offset:5120
  s_waitcnt lgkmcnt(8)
  v_mfma_f32_32x32x16_bf16 v[80:95], v[112:115], v[24:27], 0
  ds_read_b64_tr_b16 v[44:45], v9 offset:4096
  ds_read_b64_tr_b16 v[46:47], v9 offset:5120
  s_add_u32 s57, s63, 4096
  buffer_store_dwordx4 v[240:243], v5, s[20:23], s57 offen sc1
  s_waitcnt lgkmcnt(8)
  v_mfma_f32_32x32x16_bf16 v[96:111], v[112:115], v[28:31], 0
  s_waitcnt lgkmcnt(6)
  v_mfma_f32_32x32x16_bf16 v[48:63], v[116:119], v[32:35], v[48:63]
  ds_read_b64_tr_b16 v[16:17], v6 offset:8192
  ds_read_b64_tr_b16 v[18:19], v6 offset:9216
  ds_read_b64_tr_b16 v[20:21], v7 offset:8192
  s_waitcnt lgkmcnt(7)
  v_mfma_f32_32x32x16_bf16 v[64:79], v[116:119], v[36:39], v[64:79]
  ds_read_b64_tr_b16 v[22:23], v7 offset:9216
  ds_read_b64_tr_b16 v[24:25], v8 offset:8192
  ds_read_b64_tr_b16 v[26:27], v8 offset:9216
  s_add_u32 m0, s61, 8192
  s_add_u32 s57, s45, 0
  buffer_load_dwordx4 v3, s[24:27], s57 offen lds
  s_waitcnt lgkmcnt(8)
  v_mfma_f32_32x32x16_bf16 v[80:95], v[116:119], v[40:43], v[80:95]
  ds_read_b64_tr_b16 v[28:29], v9 offset:8192
  ds_read_b64_tr_b16 v[30:31], v9 offset:9216
  s_waitcnt lgkmcnt(8)
  v_mfma_f32_32x32x16_bf16 v[96:111], v[116:119], v[44:47], v[96:111]
  s_add_u32 m0, s61, 9216
  s_add_u32 s57, s45, 8192
  buffer_load_dwordx4 v3, s[24:27], s57 offen lds
  s_waitcnt lgkmcnt(6)
  v_mfma_f32_32x32x16_bf16 v[48:63], v[120:123], v[16:19], v[48:63]
  ds_read_b64_tr_b16 v[32:33], v6 offset:12288
  ds_read_b64_tr_b16 v[34:35], v6 offset:13312
  ds_read_b64_tr_b16 v[36:37], v7 offset:12288
  s_waitcnt lgkmcnt(7)
  v_mfma_f32_32x32x16_bf16 v[64:79], v[120:123], v[20:23], v[64:79]
  ds_read_b64_tr_b16 v[38:39], v7 offset:13312
  ds_read_b64_tr_b16 v[40:41], v8 offset:12288
  ds_read_b64_tr_b16 v[42:43], v8 offset:13312
  s_add_u32 m0, s61, 10240
  s_add_u32 s57, s45, 16384
  buffer_load_dwordx4 v3, s[24:27], s57 offen lds
  s_waitcnt lgkmcnt(8)
  v_mfma_f32_32x32x16_bf16 v[80:95], v[120:123], v[24:27], v[80:95]
  ds_read_b64_tr_b16 v[44:45], v9 offset:12288
  ds_read_b64_tr_b16 v[46:47], v9 offset:13312
  s_waitcnt lgkmcnt(8)
  v_mfma_f32_32x32x16_bf16 v[96:111], v[120:123], v[28:31], v[96:111]
  s_add_u32 m0, s61, 11264
  s_add_u32 s57, s45, 24576
  buffer_load_dwordx4 v3, s[24:27], s57 offen lds
  s_waitcnt lgkmcnt(0)
  s_waitcnt vmcnt(5)
  s_barrier
  v_mfma_f32_32x32x16_bf16 v[48:63], v[124:127], v[32:35], v[48:63]
  ds_read_b64_tr_b16 v[16:17], v6 offset:16384
  ds_read_b64_tr_b16 v[18:19], v6 offset:17408
  ds_read_b64_tr_b16 v[20:21], v7 offset:16384
  v_mfma_f32_32x32x16_bf16 v[64:79], v[124:127], v[36:39], v[64:79]
  ds_read_b64_tr_b16 v[22:23], v7 offset:17408
  ds_read_b64_tr_b16 v[24:25], v8 offset:16384
  ds_read_b64_tr_b16 v[26:27], v8 offset:17408
  v_mfma_f32_32x32x16_bf16 v[80:95], v[124:127], v[40:43], v[80:95]
  ds_read_b64_tr_b16 v[28:29], v9 offset:16384
  ds_read_b64_tr_b16 v[30:31], v9 offset:17408
  s_add_u32 s67, s66, 4
  s_and_b32 s67, s67, 7
  s_lshl_b32 s67, s67, 19
  s_add_u32 s67, s67, s59
  s_add_u32 m0, s62, 0
  s_add_u32 s57, s67, 0
  buffer_load_dwordx4 v2, s[16:19], s57 offen lds
  s_add_u32 m0, s62, 1024
  s_add_u32 s57, s67, 32768
  buffer_load_dwordx4 v2, s[16:19], s57 offen lds
  v_mfma_f32_32x32x16_bf16 v[96:111], v[124:127], v[44:47], v[96:111]
  s_waitcnt lgkmcnt(6)
  v_mfma_f32_32x32x16_bf16 v[48:63], v[128:131], v[16:19], v[48:63]
  ds_read_b64_tr_b16 v[32:33], v6 offset:20480
  ds_read_b64_tr_b16 v[34:35], v6 offset:21504
  ds_read_b64_tr_b16 v[36:37], v7 offset:20480
  s_waitcnt lgkmcnt(7)
  v_mfma_f32_32x32x16_bf16 v[64:79], v[128:131], v[20:23], v[64:79]
  ds_read_b64_tr_b16 v[38:39], v7 offset:21504
  ds_read_b64_tr_b16 v[40:41], v8 offset:20480
  ds_read_b64_tr_b16 v[42:43], v8 offset:21504
  v_add_u32 v10, 4294918144, v10
  v_add_u32 v11, 4294918144, v11
  v_add_u32 v12, 4294918144, v12
  v_add_u32 v13, 4294918144, v13
  s_cmp_lg_u32 s54, 0
  s_cbranch_scc1 kv_kernel_sig5
  s_mov_b32 s57, s44
  s_lshl_b32 s57, s57, 3
  v_mov_b32 v14, 0x40000000
  v_mov_b32 v15, s57
  v_cmp_eq_u32 vcc, 0, v1
  s_nop 1
  v_cndmask_b32 v14, v14, v15, vcc
  v_mov_b32 v15, 256
  buffer_atomic_add v15, v14, s[32:35], 0 offen sc1
kv_kernel_sig5:
  s_waitcnt lgkmcnt(8)
  v_mfma_f32_32x32x16_bf16 v[80:95], v[128:131], v[24:27], v[80:95]
  ds_read_b64_tr_b16 v[44:45], v9 offset:20480
  ds_read_b64_tr_b16 v[46:47], v9 offset:21504
  s_add_u32 s57, s63, 5120
  buffer_store_dwordx4 v[244:247], v5, s[20:23], s57 offen sc1
  s_waitcnt lgkmcnt(8)
  v_mfma_f32_32x32x16_bf16 v[96:111], v[128:131], v[28:31], v[96:111]
  s_waitcnt lgkmcnt(6)
  v_mfma_f32_32x32x16_bf16 v[48:63], v[132:135], v[32:35], v[48:63]
  ds_read_b64_tr_b16 v[16:17], v6 offset:24576
  ds_read_b64_tr_b16 v[18:19], v6 offset:25600
  ds_read_b64_tr_b16 v[20:21], v7 offset:24576
  s_waitcnt lgkmcnt(7)
  v_mfma_f32_32x32x16_bf16 v[64:79], v[132:135], v[36:39], v[64:79]
  ds_read_b64_tr_b16 v[22:23], v7 offset:25600
  ds_read_b64_tr_b16 v[24:25], v8 offset:24576
  ds_read_b64_tr_b16 v[26:27], v8 offset:25600
  s_add_u32 m0, s61, 0
  s_add_u32 s57, s45, 262144
  buffer_load_dwordx4 v3, s[24:27], s57 offen lds
  s_waitcnt lgkmcnt(8)
  v_mfma_f32_32x32x16_bf16 v[80:95], v[132:135], v[40:43], v[80:95]
  ds_read_b64_tr_b16 v[28:29], v9 offset:24576
  ds_read_b64_tr_b16 v[30:31], v9 offset:25600
  s_waitcnt lgkmcnt(8)
  v_mfma_f32_32x32x16_bf16 v[96:111], v[132:135], v[44:47], v[96:111]
  s_add_u32 m0, s61, 1024
  s_add_u32 s57, s45, 270336
  buffer_load_dwordx4 v3, s[24:27], s57 offen lds
  s_waitcnt lgkmcnt(6)
  v_mfma_f32_32x32x16_bf16 v[48:63], v[136:139], v[16:19], v[48:63]
  ds_read_b64_tr_b16 v[32:33], v6 offset:28672
  ds_read_b64_tr_b16 v[34:35], v6 offset:29696
  ds_read_b64_tr_b16 v[36:37], v7 offset:28672
  s_waitcnt lgkmcnt(7)
  v_mfma_f32_32x32x16_bf16 v[64:79], v[136:139], v[20:23], v[64:79]
  ds_read_b64_tr_b16 v[38:39], v7 offset:29696
  ds_read_b64_tr_b16 v[40:41], v8 offset:28672
  ds_read_b64_tr_b16 v[42:43], v8 offset:29696
  s_add_u32 m0, s61, 2048
  s_add_u32 s57, s45, 278528
  buffer_load_dwordx4 v3, s[24:27], s57 offen lds
  s_waitcnt lgkmcnt(8)
  v_mfma_f32_32x32x16_bf16 v[80:95], v[136:139], v[24:27], v[80:95]
  ds_read_b64_tr_b16 v[44:45], v9 offset:28672
  ds_read_b64_tr_b16 v[46:47], v9 offset:29696
  s_waitcnt lgkmcnt(8)
  v_mfma_f32_32x32x16_bf16 v[96:111], v[136:139], v[28:31], v[96:111]
  s_add_u32 m0, s61, 3072
  s_add_u32 s57, s45, 286720
  buffer_load_dwordx4 v3, s[24:27], s57 offen lds
  s_waitcnt lgkmcnt(0)
  s_barrier
  v_mfma_f32_32x32x16_bf16 v[48:63], v[140:143], v[32:35], v[48:63]
  ds_read_b64_tr_b16 v[16:17], v6 offset:32768
  ds_read_b64_tr_b16 v[18:19], v6 offset:33792
  ds_read_b64_tr_b16 v[20:21], v7 offset:32768
  v_mfma_f32_32x32x16_bf16 v[64:79], v[140:143], v[36:39], v[64:79]
  ds_read_b64_tr_b16 v[22:23], v7 offset:33792
  ds_read_b64_tr_b16 v[24:25], v8 offset:32768
  ds_read_b64_tr_b16 v[26:27], v8 offset:33792
  v_mfma_f32_32x32x16_bf16 v[80:95], v[140:143], v[40:43], v[80:95]
  ds_read_b64_tr_b16 v[28:29], v9 offset:32768
  ds_read_b64_tr_b16 v[30:31], v9 offset:33792
  s_add_u32 s67, s66, 5
  s_and_b32 s67, s67, 7
  s_lshl_b32 s67, s67, 19
  s_add_u32 s67, s67, s59
  s_add_u32 m0, s62, 16384
  s_add_u32 s57, s67, 0
  buffer_load_dwordx4 v2, s[16:19], s57 offen lds
  s_add_u32 m0, s62, 17408
  s_add_u32 s57, s67, 32768
  buffer_load_dwordx4 v2, s[16:19], s57 offen lds
  v_mfma_f32_32x32x16_bf16 v[96:111], v[140:143], v[44:47], v[96:111]
  s_waitcnt lgkmcnt(6)
  v_mfma_f32_32x32x16_bf16 v[48:63], v[144:147], v[16:19], v[48:63]
  ds_read_b64_tr_b16 v[32:33], v6 offset:36864
  ds_read_b64_tr_b16 v[34:35], v6 offset:37888
  ds_read_b64_tr_b16 v[36:37], v7 offset:36864
  s_waitcnt lgkmcnt(7)
  v_mfma_f32_32x32x16_bf16 v[64:79], v[144:147], v[20:23], v[64:79]
  ds_read_b64_tr_b16 v[38:39], v7 offset:37888
  ds_read_b64_tr_b16 v[40:41], v8 offset:36864
  ds_read_b64_tr_b16 v[42:43], v8 offset:37888
  s_waitcnt lgkmcnt(8)
  v_mfma_f32_32x32x16_bf16 v[80:95], v[144:147], v[24:27], v[80:95]
  ds_read_b64_tr_b16 v[44:45], v9 offset:36864
  ds_read_b64_tr_b16 v[46:47], v9 offset:37888
  s_add_u32 s57, s63, 6144
  buffer_store_dwordx4 v[248:251], v5, s[20:23], s57 offen sc1
  s_waitcnt lgkmcnt(8)
  v_mfma_f32_32x32x16_bf16 v[96:111], v[144:147], v[28:31], v[96:111]
  s_waitcnt lgkmcnt(6)
  v_mfma_f32_32x32x16_bf16 v[48:63], v[148:151], v[32:35], v[48:63]
  ds_read_b64_tr_b16 v[16:17], v6 offset:40960
  ds_read_b64_tr_b16 v[18:19], v6 offset:41984
  ds_read_b64_tr_b16 v[20:21], v7 offset:40960
  s_waitcnt lgkmcnt(7)
  v_mfma_f32_32x32x16_bf16 v[64:79], v[148:151], v[36:39], v[64:79]
  ds_read_b64_tr_b16 v[22:23], v7 offset:41984
  ds_read_b64_tr_b16 v[24:25], v8 offset:40960
  ds_read_b64_tr_b16 v[26:27], v8 offset:41984
  s_mov_b32 s36, s42
  s_mov_b32 s37, s43
  s_mov_b32 s38, 4194304
  s_mov_b32 s39, 0x20000
  s_add_u32 s58, s65, 0
  v_add_u32 v14, s58, v5
  s_add_u32 m0, s61, 6144
  s_nop 0
  buffer_load_dwordx4 v14, s[36:39], 0 offen lds
  v_add_u32 v14, 2097152, v14
  s_add_u32 m0, s61, 6144
  s_nop 0
  buffer_load_dwordx4 v14, s[36:39], 0 offen lds
  s_waitcnt lgkmcnt(8)
  v_mfma_f32_32x32x16_bf16 v[80:95], v[148:151], v[40:43], v[80:95]
  ds_read_b64_tr_b16 v[28:29], v9 offset:40960
  ds_read_b64_tr_b16 v[30:31], v9 offset:41984
  s_waitcnt lgkmcnt(8)
  v_mfma_f32_32x32x16_bf16 v[96:111], v[148:151], v[44:47], v[96:111]
  s_waitcnt lgkmcnt(6)
  v_mfma_f32_32x32x16_bf16 v[48:63], v[152:155], v[16:19], v[48:63]
  ds_read_b64_tr_b16 v[32:33], v6 offset:45056
  ds_read_b64_tr_b16 v[34:35], v6 offset:46080
  ds_read_b64_tr_b16 v[36:37], v7 offset:45056
  s_waitcnt lgkmcnt(7)
  v_mfma_f32_32x32x16_bf16 v[64:79], v[152:155], v[20:23], v[64:79]
  ds_read_b64_tr_b16 v[38:39], v7 offset:46080
  ds_read_b64_tr_b16 v[40:41], v8 offset:45056
  ds_read_b64_tr_b16 v[42:43], v8 offset:46080
  s_waitcnt lgkmcnt(8)
  v_mfma_f32_32x32x16_bf16 v[80:95], v[152:155], v[24:27], v[80:95]
  ds_read_b64_tr_b16 v[44:45], v9 offset:45056
  ds_read_b64_tr_b16 v[46:47], v9 offset:46080
  s_waitcnt lgkmcnt(8)
  v_mfma_f32_32x32x16_bf16 v[96:111], v[152:155], v[28:31], v[96:111]
  s_waitcnt lgkmcnt(0)
  s_barrier
  v_mfma_f32_32x32x16_bf16 v[48:63], v[156:159], v[32:35], v[48:63]
  ds_read_b64_tr_b16 v[16:17], v6 offset:49152
  ds_read_b64_tr_b16 v[18:19], v6 offset:50176
  ds_read_b64_tr_b16 v[20:21], v7 offset:49152
  v_mfma_f32_32x32x16_bf16 v[64:79], v[156:159], v[36:39], v[64:79]
  ds_read_b64_tr_b16 v[22:23], v7 offset:50176
  ds_read_b64_tr_b16 v[24:25], v8 offset:49152
  ds_read_b64_tr_b16 v[26:27], v8 offset:50176
  v_mfma_f32_32x32x16_bf16 v[80:95], v[156:159], v[40:43], v[80:95]
  ds_read_b64_tr_b16 v[28:29], v9 offset:49152
  ds_read_b64_tr_b16 v[30:31], v9 offset:50176
  s_add_u32 s67, s66, 6
  s_and_b32 s67, s67, 7
  s_lshl_b32 s67, s67, 19
  s_add_u32 s67, s67, s59
  s_add_u32 m0, s62, 32768
  s_add_u32 s57, s67, 0
  buffer_load_dwordx4 v2, s[16:19], s57 offen lds
  s_add_u32 m0, s62, 33792
  s_add_u32 s57, s67, 32768
  buffer_load_dwordx4 v2, s[16:19], s57 offen lds
  v_mfma_f32_32x32x16_bf16 v[96:111], v[156:159], v[44:47], v[96:111]
  s_waitcnt lgkmcnt(6)
  v_mfma_f32_32x32x16_bf16 v[48:63], v[160:163], v[16:19], v[48:63]
  ds_read_b64_tr_b16 v[32:33], v6 offset:53248
  ds_read_b64_tr_b16 v[34:35], v6 offset:54272
  ds_read_b64_tr_b16 v[36:37], v7 offset:53248
  s_waitcnt lgkmcnt(7)
  v_mfma_f32_32x32x16_bf16 v[64:79], v[160:163], v[20:23], v[64:79]
  ds_read_b64_tr_b16 v[38:39], v7 offset:54272
  ds_read_b64_tr_b16 v[40:41], v8 offset:53248
  ds_read_b64_tr_b16 v[42:43], v8 offset:54272
  s_waitcnt lgkmcnt(8)
  v_mfma_f32_32x32x16_bf16 v[80:95], v[160:163], v[24:27], v[80:95]
  ds_read_b64_tr_b16 v[44:45], v9 offset:53248
  ds_read_b64_tr_b16 v[46:47], v9 offset:54272
  s_add_u32 s57, s63, 7168
  buffer_store_dwordx4 v[252:255], v5, s[20:23], s57 offen sc1
  s_waitcnt lgkmcnt(8)
  v_mfma_f32_32x32x16_bf16 v[96:111], v[160:163], v[28:31], v[96:111]
  s_waitcnt lgkmcnt(6)
  v_mfma_f32_32x32x16_bf16 v[48:63], v[164:167], v[32:35], v[48:63]
  ds_read_b64_tr_b16 v[16:17], v6 offset:57344
  ds_read_b64_tr_b16 v[18:19], v6 offset:58368
  ds_read_b64_tr_b16 v[20:21], v7 offset:57344
  s_waitcnt lgkmcnt(7)
  v_mfma_f32_32x32x16_bf16 v[64:79], v[164:167], v[36:39], v[64:79]
  ds_read_b64_tr_b16 v[22:23], v7 offset:58368
  ds_read_b64_tr_b16 v[24:25], v8 offset:57344
  ds_read_b64_tr_b16 v[26:27], v8 offset:58368
  s_waitcnt lgkmcnt(8)
  v_mfma_f32_32x32x16_bf16 v[80:95], v[164:167], v[40:43], v[80:95]
  ds_read_b64_tr_b16 v[28:29], v9 offset:57344
  ds_read_b64_tr_b16 v[30:31], v9 offset:58368
  s_waitcnt lgkmcnt(8)
  v_mfma_f32_32x32x16_bf16 v[96:111], v[164:167], v[44:47], v[96:111]
  s_waitcnt lgkmcnt(6)
  v_mfma_f32_32x32x16_bf16 v[48:63], v[168:171], v[16:19], v[48:63]
  ds_read_b64_tr_b16 v[32:33], v6 offset:61440
  ds_read_b64_tr_b16 v[34:35], v6 offset:62464
  ds_read_b64_tr_b16 v[36:37], v7 offset:61440
  s_waitcnt lgkmcnt(7)
  v_mfma_f32_32x32x16_bf16 v[64:79], v[168:171], v[20:23], v[64:79]
  ds_read_b64_tr_b16 v[38:39], v7 offset:62464
  ds_read_b64_tr_b16 v[40:41], v8 offset:61440
  ds_read_b64_tr_b16 v[42:43], v8 offset:62464
  s_waitcnt lgkmcnt(8)
  v_mfma_f32_32x32x16_bf16 v[80:95], v[168:171], v[24:27], v[80:95]
  ds_read_b64_tr_b16 v[44:45], v9 offset:61440
  ds_read_b64_tr_b16 v[46:47], v9 offset:62464
  s_waitcnt lgkmcnt(8)
  v_mfma_f32_32x32x16_bf16 v[96:111], v[168:171], v[28:31], v[96:111]
  s_waitcnt lgkmcnt(0)
  s_waitcnt vmcnt(13)
  s_barrier
  v_mfma_f32_32x32x16_bf16 v[48:63], v[172:175], v[32:35], v[48:63]
  ds_read_b64_tr_b16 v[16:17], v6 offset:0
  ds_read_b64_tr_b16 v[18:19], v6 offset:1024
  ds_read_b64_tr_b16 v[20:21], v7 offset:0
  v_mfma_f32_32x32x16_bf16 v[64:79], v[172:175], v[36:39], v[64:79]
  ds_read_b64_tr_b16 v[22:23], v7 offset:1024
  ds_read_b64_tr_b16 v[24:25], v8 offset:0
  ds_read_b64_tr_b16 v[26:27], v8 offset:1024
  v_mfma_f32_32x32x16_bf16 v[80:95], v[172:175], v[40:43], v[80:95]
  ds_read_b64_tr_b16 v[28:29], v9 offset:0
  ds_read_b64_tr_b16 v[30:31], v9 offset:1024
  s_add_u32 s67, s66, 7
  s_and_b32 s67, s67, 7
  s_lshl_b32 s67, s67, 19
  s_add_u32 s67, s67, s59
  s_add_u32 m0, s62, 49152
  s_add_u32 s57, s67, 0
  buffer_load_dwordx4 v2, s[16:19], s57 offen lds
  s_add_u32 m0, s62, 50176
  s_add_u32 s57, s67, 32768
  buffer_load_dwordx4 v2, s[16:19], s57 offen lds
  v_mfma_f32_32x32x16_bf16 v[96:111], v[172:175], v[44:47], v[96:111]
  s_waitcnt lgkmcnt(6)
  v_mfma_f32_32x32x16_bf16 v[48:63], v[176:179], v[16:19], v[48:63]
  ds_read_b64_tr_b16 v[32:33], v6 offset:4096
  ds_read_b64_tr_b16 v[34:35], v6 offset:5120
  ds_read_b64_tr_b16 v[36:37], v7 offset:4096
  s_waitcnt lgkmcnt(7)
  v_mfma_f32_32x32x16_bf16 v[64:79], v[176:179], v[20:23], v[64:79]
  ds_read_b64_tr_b16 v[38:39], v7 offset:5120
  ds_read_b64_tr_b16 v[40:41], v8 offset:4096
  ds_read_b64_tr_b16 v[42:43], v8 offset:5120
  s_waitcnt lgkmcnt(8)
  v_mfma_f32_32x32x16_bf16 v[80:95], v[176:179], v[24:27], v[80:95]
  ds_read_b64_tr_b16 v[44:45], v9 offset:4096
  ds_read_b64_tr_b16 v[46:47], v9 offset:5120
  s_waitcnt lgkmcnt(8)
  v_mfma_f32_32x32x16_bf16 v[96:111], v[176:179], v[28:31], v[96:111]
  s_waitcnt lgkmcnt(6)
  v_mfma_f32_32x32x16_bf16 v[48:63], v[180:183], v[32:35], v[48:63]
  ds_read_b64_tr_b16 v[16:17], v6 offset:8192
  ds_read_b64_tr_b16 v[18:19], v6 offset:9216
  ds_read_b64_tr_b16 v[20:21], v7 offset:8192
  s_waitcnt lgkmcnt(7)
  v_mfma_f32_32x32x16_bf16 v[64:79], v[180:183], v[36:39], v[64:79]
  ds_read_b64_tr_b16 v[22:23], v7 offset:9216
  ds_read_b64_tr_b16 v[24:25], v8 offset:8192
  ds_read_b64_tr_b16 v[26:27], v8 offset:9216
  s_waitcnt lgkmcnt(8)
  v_mfma_f32_32x32x16_bf16 v[80:95], v[180:183], v[40:43], v[80:95]
  ds_read_b64_tr_b16 v[28:29], v9 offset:8192
  ds_read_b64_tr_b16 v[30:31], v9 offset:9216
  s_waitcnt lgkmcnt(8)
  v_mfma_f32_32x32x16_bf16 v[96:111], v[180:183], v[44:47], v[96:111]
  s_waitcnt lgkmcnt(6)
  v_mfma_f32_32x32x16_bf16 v[48:63], v[184:187], v[16:19], v[48:63]
  ds_read_b64_tr_b16 v[32:33], v6 offset:12288
  ds_read_b64_tr_b16 v[34:35], v6 offset:13312
  ds_read_b64_tr_b16 v[36:37], v7 offset:12288
  s_waitcnt lgkmcnt(7)
  v_mfma_f32_32x32x16_bf16 v[64:79], v[184:187], v[20:23], v[64:79]
  ds_read_b64_tr_b16 v[38:39], v7 offset:13312
  ds_read_b64_tr_b16 v[40:41], v8 offset:12288
  ds_read_b64_tr_b16 v[42:43], v8 offset:13312
  s_cmp_lg_u32 s54, 0
  s_cbranch_scc1 kv_kernel_pol6
  v_min_u32 v14, 2, v1
  v_add_u32 v14, s44, v14
  v_max_u32 v14, 1, v14
  v_min_u32 v14, 32, v14
  v_add_u32 v14, -1, v14
  v_lshlrev_b32 v14, 3, v14
  buffer_load_dword v4, v14, s[32:35], 0 offen sc1
kv_kernel_pol6:
  s_waitcnt lgkmcnt(8)
  v_mfma_f32_32x32x16_bf16 v[80:95], v[184:187], v[24:27], v[80:95]
  ds_read_b64_tr_b16 v[44:45], v9 offset:12288
  ds_read_b64_tr_b16 v[46:47], v9 offset:13312
  s_waitcnt lgkmcnt(8)
  v_mfma_f32_32x32x16_bf16 v[96:111], v[184:187], v[28:31], v[96:111]
  s_waitcnt lgkmcnt(0)
  s_waitcnt vmcnt(8)
  s_barrier
  v_mfma_f32_32x32x16_bf16 v[48:63], v[188:191], v[32:35], v[48:63]
  ds_read_b64_tr_b16 v[16:17], v6 offset:16384
  ds_read_b64_tr_b16 v[18:19], v6 offset:17408
  ds_read_b64_tr_b16 v[20:21], v7 offset:16384
  v_mfma_f32_32x32x16_bf16 v[64:79], v[188:191], v[36:39], v[64:79]
  ds_read_b64_tr_b16 v[22:23], v7 offset:17408
  ds_read_b64_tr_b16 v[24:25], v8 offset:16384
  ds_read_b64_tr_b16 v[26:27], v8 offset:17408
  v_mfma_f32_32x32x16_bf16 v[80:95], v[188:191], v[40:43], v[80:95]
  ds_read_b64_tr_b16 v[28:29], v9 offset:16384
  ds_read_b64_tr_b16 v[30:31], v9 offset:17408
  v_mfma_f32_32x32x16_bf16 v[96:111], v[188:191], v[44:47], v[96:111]
  s_waitcnt lgkmcnt(6)
  v_mfma_f32_32x32x16_bf16 v[48:63], v[192:195], v[16:19], v[48:63]
  ds_read_b64_tr_b16 v[32:33], v6 offset:20480
  ds_read_b64_tr_b16 v[34:35], v6 offset:21504
  ds_read_b64_tr_b16 v[36:37], v7 offset:20480
  s_waitcnt lgkmcnt(7)
  v_mfma_f32_32x32x16_bf16 v[64:79], v[192:195], v[20:23], v[64:79]
  ds_read_b64_tr_b16 v[38:39], v7 offset:21504
  ds_read_b64_tr_b16 v[40:41], v8 offset:20480
  ds_read_b64_tr_b16 v[42:43], v8 offset:21504
  s_waitcnt lgkmcnt(8)
  v_mfma_f32_32x32x16_bf16 v[80:95], v[192:195], v[24:27], v[80:95]
  ds_read_b64_tr_b16 v[44:45], v9 offset:20480
  ds_read_b64_tr_b16 v[46:47], v9 offset:21504
  s_waitcnt lgkmcnt(8)
  v_mfma_f32_32x32x16_bf16 v[96:111], v[192:195], v[28:31], v[96:111]
  s_waitcnt lgkmcnt(6)
  v_mfma_f32_32x32x16_bf16 v[48:63], v[196:199], v[32:35], v[48:63]
  ds_read_b64_tr_b16 v[16:17], v6 offset:24576
  ds_read_b64_tr_b16 v[18:19], v6 offset:25600
  ds_read_b64_tr_b16 v[20:21], v7 offset:24576
  s_waitcnt lgkmcnt(7)
  v_mfma_f32_32x32x16_bf16 v[64:79], v[196:199], v[36:39], v[64:79]
  ds_read_b64_tr_b16 v[22:23], v7 offset:25600
  ds_read_b64_tr_b16 v[24:25], v8 offset:24576
  ds_read_b64_tr_b16 v[26:27], v8 offset:25600
  s_waitcnt lgkmcnt(8)
  v_mfma_f32_32x32x16_bf16 v[80:95], v[196:199], v[40:43], v[80:95]
  ds_read_b64_tr_b16 v[28:29], v9 offset:24576
  ds_read_b64_tr_b16 v[30:31], v9 offset:25600
  s_waitcnt lgkmcnt(8)
  v_mfma_f32_32x32x16_bf16 v[96:111], v[196:199], v[44:47], v[96:111]
  s_waitcnt lgkmcnt(6)
  v_mfma_f32_32x32x16_bf16 v[48:63], v[200:203], v[16:19], v[48:63]
  ds_read_b64_tr_b16 v[32:33], v6 offset:28672
  ds_read_b64_tr_b16 v[34:35], v6 offset:29696
  ds_read_b64_tr_b16 v[36:37], v7 offset:28672
  s_waitcnt lgkmcnt(7)
  v_mfma_f32_32x32x16_bf16 v[64:79], v[200:203], v[20:23], v[64:79]
  ds_read_b64_tr_b16 v[38:39], v7 offset:29696
  ds_read_b64_tr_b16 v[40:41], v8 offset:28672
  ds_read_b64_tr_b16 v[42:43], v8 offset:29696
  s_waitcnt lgkmcnt(8)
  v_mfma_f32_32x32x16_bf16 v[80:95], v[200:203], v[24:27], v[80:95]
  ds_read_b64_tr_b16 v[44:45], v9 offset:28672
  ds_read_b64_tr_b16 v[46:47], v9 offset:29696
  s_waitcnt lgkmcnt(8)
  v_mfma_f32_32x32x16_bf16 v[96:111], v[200:203], v[28:31], v[96:111]
  s_waitcnt lgkmcnt(0)
  s_cmp_lg_u32 s54, 0
  s_cbranch_scc1 kv_kernel_chk7
  s_waitcnt vmcnt(0)
  v_lshrrev_b32 v4, 8, v4
  v_cmp_le_u32 vcc, 8, v4
  s_cmp_eq_u64 vcc, -1
  s_cbranch_scc1 kv_kernel_chk7
  s_mov_b32 s49, 16384
kv_kernel_spin8:
  v_min_u32 v14, 2, v1
  v_add_u32 v14, s44, v14
  v_max_u32 v14, 1, v14
  v_min_u32 v14, 32, v14
  v_add_u32 v14, -1, v14
  v_lshlrev_b32 v14, 3, v14
  buffer_load_dword v4, v14, s[32:35], 0 offen sc1
  s_waitcnt vmcnt(0)
  v_lshrrev_b32 v4, 8, v4
  v_cmp_le_u32 vcc, 8, v4
  s_cmp_eq_u64 vcc, -1
  s_cbranch_scc1 kv_kernel_chk7
  s_sub_u32 s49, s49, 1
  s_cmp_eq_u32 s49, 0
  s_cbranch_scc0 kv_kernel_spin8
kv_kernel_chk7:
  s_waitcnt vmcnt(3)
  s_barrier
  v_mfma_f32_32x32x16_bf16 v[48:63], v[204:207], v[32:35], v[48:63]
  ds_read_b64_tr_b16 v[16:17], v6 offset:32768
  ds_read_b64_tr_b16 v[18:19], v6 offset:33792
  ds_read_b64_tr_b16 v[20:21], v7 offset:32768
  v_mfma_f32_32x32x16_bf16 v[64:79], v[204:207], v[36:39], v[64:79]
  ds_read_b64_tr_b16 v[22:23], v7 offset:33792
  ds_read_b64_tr_b16 v[24:25], v8 offset:32768
  ds_read_b64_tr_b16 v[26:27], v8 offset:33792
  v_mfma_f32_32x32x16_bf16 v[80:95], v[204:207], v[40:43], v[80:95]
  ds_read_b64_tr_b16 v[28:29], v9 offset:32768
  ds_read_b64_tr_b16 v[30:31], v9 offset:33792
  v_mfma_f32_32x32x16_bf16 v[96:111], v[204:207], v[44:47], v[96:111]
  s_waitcnt lgkmcnt(6)
  v_mfma_f32_32x32x16_bf16 v[48:63], v[208:211], v[16:19], v[48:63]
  ds_read_b64_tr_b16 v[32:33], v6 offset:36864
  ds_read_b64_tr_b16 v[34:35], v6 offset:37888
  ds_read_b64_tr_b16 v[36:37], v7 offset:36864
  s_lshl_b32 s57, s52, 4
  s_lshl_b32 s58, s50, 10
  s_add_u32 s58, s58, 6291456
  v_and_b32 v152, 15, v1
  v_add_u32 v152, s57, v152
  v_add_u32 v152, -1, v152
  v_lshrrev_b32 v153, 4, v152
  v_lshlrev_b32 v153, 14, v153
  v_and_b32 v148, 15, v152
  v_lshl_add_u32 v153, v148, 4, v153
  v_lshrrev_b32 v148, 4, v1
  v_lshl_add_u32 v153, v148, 8, v153
  v_add_u32 v153, s58, v153
  v_add_u32 v153, 0, v153
  v_mov_b32 v148, 0x40000000
  v_cmp_gt_u32 vcc, 2048, v152
  s_nop 1
  v_cndmask_b32 v148, v148, v153, vcc
  v_and_b32 v152, 15, v1
  v_add_u32 v152, s57, v152
  v_add_u32 v152, 1, v152
  v_lshrrev_b32 v153, 4, v152
  v_lshlrev_b32 v153, 14, v153
  v_and_b32 v149, 15, v152
  v_lshl_add_u32 v153, v149, 4, v153
  v_lshrrev_b32 v149, 4, v1
  v_lshl_add_u32 v153, v149, 8, v153
  v_add_u32 v153, s58, v153
  v_add_u32 v153, 4096, v153
  v_mov_b32 v149, 0x40000000
  v_cmp_gt_u32 vcc, 2048, v152
  s_nop 1
  v_cndmask_b32 v149, v149, v153, vcc
  v_and_b32 v152, 15, v1
  v_add_u32 v152, s57, v152
  v_add_u32 v152, -2, v152
  v_lshrrev_b32 v153, 4, v152
  v_lshlrev_b32 v153, 14, v153
  v_and_b32 v150, 15, v152
  v_lshl_add_u32 v153, v150, 4, v153
  v_lshrrev_b32 v150, 4, v1
  v_lshl_add_u32 v153, v150, 8, v153
  v_add_u32 v153, s58, v153
  v_add_u32 v153, 8192, v153
  v_mov_b32 v150, 0x40000000
  v_cmp_gt_u32 vcc, 2048, v152
  s_nop 1
  v_cndmask_b32 v150, v150, v153, vcc
  v_and_b32 v152, 15, v1
  v_add_u32 v152, s57, v152
  v_add_u32 v152, 2, v152
  v_lshrrev_b32 v153, 4, v152
  v_lshlrev_b32 v153, 14, v153
  v_and_b32 v151, 15, v152
  v_lshl_add_u32 v153, v151, 4, v153
  v_lshrrev_b32 v151, 4, v1
  v_lshl_add_u32 v153, v151, 8, v153
  v_add_u32 v153, s58, v153
  v_add_u32 v153, 12288, v153
  v_mov_b32 v151, 0x40000000
  v_cmp_gt_u32 vcc, 2048, v152
  s_nop 1
  v_cndmask_b32 v151, v151, v153, vcc
  s_waitcnt lgkmcnt(7)
  v_mfma_f32_32x32x16_bf16 v[64:79], v[208:211], v[20:23], v[64:79]
  ds_read_b64_tr_b16 v[38:39], v7 offset:37888
  ds_read_b64_tr_b16 v[40:41], v8 offset:36864
  ds_read_b64_tr_b16 v[42:43], v8 offset:37888
  s_waitcnt lgkmcnt(8)
  v_mfma_f32_32x32x16_bf16 v[80:95], v[208:211], v[24:27], v[80:95]
  ds_read_b64_tr_b16 v[44:45], v9 offset:36864
  ds_read_b64_tr_b16 v[46:47], v9 offset:37888
  s_waitcnt lgkmcnt(8)
  v_mfma_f32_32x32x16_bf16 v[96:111], v[208:211], v[28:31], v[96:111]
  s_waitcnt lgkmcnt(6)
  v_mfma_f32_32x32x16_bf16 v[48:63], v[212:215], v[32:35], v[48:63]
  ds_read_b64_tr_b16 v[16:17], v6 offset:40960
  ds_read_b64_tr_b16 v[18:19], v6 offset:41984
  ds_read_b64_tr_b16 v[20:21], v7 offset:40960
  buffer_load_dwordx4 v[112:115], v148, s[28:31], 0 offen offset:0 sc1
  s_waitcnt lgkmcnt(7)
  v_mfma_f32_32x32x16_bf16 v[64:79], v[212:215], v[36:39], v[64:79]
  ds_read_b64_tr_b16 v[22:23], v7 offset:41984
  ds_read_b64_tr_b16 v[24:25], v8 offset:40960
  ds_read_b64_tr_b16 v[26:27], v8 offset:41984
  buffer_load_dwordx4 v[116:119], v148, s[28:31], 0 offen offset:2048 sc1
  s_waitcnt lgkmcnt(8)
  v_mfma_f32_32x32x16_bf16 v[80:95], v[212:215], v[40:43], v[80:95]
  ds_read_b64_tr_b16 v[28:29], v9 offset:40960
  ds_read_b64_tr_b16 v[30:31], v9 offset:41984
  buffer_load_dwordx4 v[120:123], v150, s[28:31], 0 offen offset:0 sc1
  s_waitcnt lgkmcnt(8)
  v_mfma_f32_32x32x16_bf16 v[96:111], v[212:215], v[44:47], v[96:111]
  buffer_load_dwordx4 v[124:127], v150, s[28:31], 0 offen offset:2048 sc1
  s_waitcnt lgkmcnt(6)
  v_mfma_f32_32x32x16_bf16 v[48:63], v[216:219], v[16:19], v[48:63]
  ds_read_b64_tr_b16 v[32:33], v6 offset:45056
  ds_read_b64_tr_b16 v[34:35], v6 offset:46080
  ds_read_b64_tr_b16 v[36:37], v7 offset:45056
  buffer_load_dwordx4 v[128:131], v149, s[28:31], 0 offen offset:0 sc1
  s_waitcnt lgkmcnt(7)
  v_mfma_f32_32x32x16_bf16 v[64:79], v[216:219], v[20:23], v[64:79]
  ds_read_b64_tr_b16 v[38:39], v7 offset:46080
  ds_read_b64_tr_b16 v[40:41], v8 offset:45056
  ds_read_b64_tr_b16 v[42:43], v8 offset:46080
  buffer_load_dwordx4 v[132:135], v149, s[28:31], 0 offen offset:2048 sc1
  s_waitcnt lgkmcnt(8)
  v_mfma_f32_32x32x16_bf16 v[80:95], v[216:219], v[24:27], v[80:95]
  ds_read_b64_tr_b16 v[44:45], v9 offset:45056
  ds_read_b64_tr_b16 v[46:47], v9 offset:46080
  buffer_load_dwordx4 v[136:139], v151, s[28:31], 0 offen offset:0 sc1
  s_waitcnt lgkmcnt(8)
  v_mfma_f32_32x32x16_bf16 v[96:111], v[216:219], v[28:31], v[96:111]
  buffer_load_dwordx4 v[140:143], v151, s[28:31], 0 offen offset:2048 sc1
  s_waitcnt lgkmcnt(0)
  s_waitcnt vmcnt(8)
  s_barrier
  v_mfma_f32_32x32x16_bf16 v[48:63], v[220:223], v[32:35], v[48:63]
  ds_read_b64_tr_b16 v[16:17], v6 offset:49152
  ds_read_b64_tr_b16 v[18:19], v6 offset:50176
  ds_read_b64_tr_b16 v[20:21], v7 offset:49152
  s_add_u32 s57, s46, 0
  buffer_load_dwordx4 v[144:147], v5, s[28:31], s57 offen sc1
  v_mfma_f32_32x32x16_bf16 v[64:79], v[220:223], v[36:39], v[64:79]
  ds_read_b64_tr_b16 v[22:23], v7 offset:50176
  ds_read_b64_tr_b16 v[24:25], v8 offset:49152
  ds_read_b64_tr_b16 v[26:27], v8 offset:50176
  v_mfma_f32_32x32x16_bf16 v[80:95], v[220:223], v[40:43], v[80:95]
  ds_read_b64_tr_b16 v[28:29], v9 offset:49152
  ds_read_b64_tr_b16 v[30:31], v9 offset:50176
  v_mfma_f32_32x32x16_bf16 v[96:111], v[220:223], v[44:47], v[96:111]
  s_waitcnt lgkmcnt(6)
  v_mfma_f32_32x32x16_bf16 v[48:63], v[224:227], v[16:19], v[48:63]
  ds_read_b64_tr_b16 v[32:33], v6 offset:53248
  ds_read_b64_tr_b16 v[34:35], v6 offset:54272
  ds_read_b64_tr_b16 v[36:37], v7 offset:53248
  s_waitcnt lgkmcnt(7)
  v_mfma_f32_32x32x16_bf16 v[64:79], v[224:227], v[20:23], v[64:79]
  ds_read_b64_tr_b16 v[38:39], v7 offset:54272
  ds_read_b64_tr_b16 v[40:41], v8 offset:53248
  ds_read_b64_tr_b16 v[42:43], v8 offset:54272
  s_waitcnt lgkmcnt(8)
  v_mfma_f32_32x32x16_bf16 v[80:95], v[224:227], v[24:27], v[80:95]
  ds_read_b64_tr_b16 v[44:45], v9 offset:53248
  ds_read_b64_tr_b16 v[46:47], v9 offset:54272
  s_waitcnt lgkmcnt(8)
  v_mfma_f32_32x32x16_bf16 v[96:111], v[224:227], v[28:31], v[96:111]
  s_waitcnt lgkmcnt(6)
  v_mfma_f32_32x32x16_bf16 v[48:63], v[228:231], v[32:35], v[48:63]
  ds_read_b64_tr_b16 v[16:17], v6 offset:57344
  ds_read_b64_tr_b16 v[18:19], v6 offset:58368
  ds_read_b64_tr_b16 v[20:21], v7 offset:57344
  s_waitcnt lgkmcnt(7)
  v_mfma_f32_32x32x16_bf16 v[64:79], v[228:231], v[36:39], v[64:79]
  ds_read_b64_tr_b16 v[22:23], v7 offset:58368
  ds_read_b64_tr_b16 v[24:25], v8 offset:57344
  ds_read_b64_tr_b16 v[26:27], v8 offset:58368
  s_waitcnt lgkmcnt(8)
  v_mfma_f32_32x32x16_bf16 v[80:95], v[228:231], v[40:43], v[80:95]
  ds_read_b64_tr_b16 v[28:29], v9 offset:57344
  ds_read_b64_tr_b16 v[30:31], v9 offset:58368
  s_waitcnt lgkmcnt(8)
  v_mfma_f32_32x32x16_bf16 v[96:111], v[228:231], v[44:47], v[96:111]
  s_waitcnt lgkmcnt(6)
  v_mfma_f32_32x32x16_bf16 v[48:63], v[232:235], v[16:19], v[48:63]
  ds_read_b64_tr_b16 v[32:33], v6 offset:61440
  ds_read_b64_tr_b16 v[34:35], v6 offset:62464
  ds_read_b64_tr_b16 v[36:37], v7 offset:61440
  s_waitcnt lgkmcnt(7)
  v_mfma_f32_32x32x16_bf16 v[64:79], v[232:235], v[20:23], v[64:79]
  ds_read_b64_tr_b16 v[38:39], v7 offset:62464
  ds_read_b64_tr_b16 v[40:41], v8 offset:61440
  ds_read_b64_tr_b16 v[42:43], v8 offset:62464
  s_waitcnt lgkmcnt(8)
  v_mfma_f32_32x32x16_bf16 v[80:95], v[232:235], v[24:27], v[80:95]
  ds_read_b64_tr_b16 v[44:45], v9 offset:61440
  ds_read_b64_tr_b16 v[46:47], v9 offset:62464
  s_waitcnt lgkmcnt(8)
  v_mfma_f32_32x32x16_bf16 v[96:111], v[232:235], v[28:31], v[96:111]
  s_waitcnt lgkmcnt(0)
  v_mfma_f32_32x32x16_bf16 v[48:63], v[236:239], v[32:35], v[48:63]
  ds_read_b64_tr_b16 v[16:17], v10 offset:8192
  ds_read_b64_tr_b16 v[18:19], v10 offset:10240
  ds_read_b64_tr_b16 v[20:21], v11 offset:8192
  v_mfma_f32_32x32x16_bf16 v[64:79], v[236:239], v[36:39], v[64:79]
  ds_read_b64_tr_b16 v[22:23], v11 offset:10240
  ds_read_b64_tr_b16 v[24:25], v12 offset:8192
  ds_read_b64_tr_b16 v[26:27], v12 offset:10240
  v_mfma_f32_32x32x16_bf16 v[80:95], v[236:239], v[40:43], v[80:95]
  ds_read_b64_tr_b16 v[28:29], v13 offset:8192
  ds_read_b64_tr_b16 v[30:31], v13 offset:10240
  v_mfma_f32_32x32x16_bf16 v[96:111], v[236:239], v[44:47], v[96:111]
  s_nop 0
  v_cvt_pk_bf16_f32 v48, v48, v49
  v_cvt_pk_bf16_f32 v49, v50, v51
  v_cvt_pk_bf16_f32 v50, v52, v53
  v_cvt_pk_bf16_f32 v51, v54, v55
  v_cvt_pk_bf16_f32 v56, v56, v57
  v_cvt_pk_bf16_f32 v57, v58, v59
  v_cvt_pk_bf16_f32 v58, v60, v61
  v_cvt_pk_bf16_f32 v59, v62, v63
  v_cvt_pk_bf16_f32 v64, v64, v65
  v_cvt_pk_bf16_f32 v65, v66, v67
  v_cvt_pk_bf16_f32 v66, v68, v69
  v_cvt_pk_bf16_f32 v67, v70, v71
  v_cvt_pk_bf16_f32 v72, v72, v73
  v_cvt_pk_bf16_f32 v73, v74, v75
  v_cvt_pk_bf16_f32 v74, v76, v77
  v_cvt_pk_bf16_f32 v75, v78, v79
  v_cvt_pk_bf16_f32 v80, v80, v81
  v_cvt_pk_bf16_f32 v81, v82, v83
  v_cvt_pk_bf16_f32 v82, v84, v85
  v_cvt_pk_bf16_f32 v83, v86, v87
  v_cvt_pk_bf16_f32 v88, v88, v89
  v_cvt_pk_bf16_f32 v89, v90, v91
  v_cvt_pk_bf16_f32 v90, v92, v93
  v_cvt_pk_bf16_f32 v91, v94, v95
  v_cvt_pk_bf16_f32 v96, v96, v97
  v_cvt_pk_bf16_f32 v97, v98, v99
  v_cvt_pk_bf16_f32 v98, v100, v101
  v_cvt_pk_bf16_f32 v99, v102, v103
  v_cvt_pk_bf16_f32 v104, v104, v105
  v_cvt_pk_bf16_f32 v105, v106, v107
  v_cvt_pk_bf16_f32 v106, v108, v109
  v_cvt_pk_bf16_f32 v107, v110, v111
  ds_read_b64_tr_b16 v[32:33], v10 offset:32768
  ds_read_b64_tr_b16 v[34:35], v10 offset:34816
  ds_read_b64_tr_b16 v[36:37], v11 offset:32768
  ds_read_b64_tr_b16 v[38:39], v11 offset:34816
  ds_read_b64_tr_b16 v[40:41], v12 offset:32768
  ds_read_b64_tr_b16 v[42:43], v12 offset:34816
  s_waitcnt vmcnt(8) lgkmcnt(12)
  v_mfma_f32_16x16x32_bf16 v[160:163], v[16:19], v[112:115], 0
  ds_read_b64_tr_b16 v[44:45], v13 offset:32768
  ds_read_b64_tr_b16 v[46:47], v13 offset:34816
  s_waitcnt lgkmcnt(12)
  v_mfma_f32_16x16x32_bf16 v[164:167], v[20:23], v[112:115], 0
  ds_read_b64_tr_b16 v[16:17], v10 offset:0
  ds_read_b64_tr_b16 v[18:19], v10 offset:2048
  s_add_u32 s57, s63, 8192
  buffer_store_dwordx4 v[48:51], v5, s[20:23], s57 offen sc1
  s_waitcnt lgkmcnt(12)
  v_mfma_f32_16x16x32_bf16 v[168:171], v[24:27], v[112:115], 0
  ds_read_b64_tr_b16 v[20:21], v11 offset:0
  ds_read_b64_tr_b16 v[22:23], v11 offset:2048
  s_waitcnt lgkmcnt(12)
  v_mfma_f32_16x16x32_bf16 v[172:175], v[28:31], v[112:115], 0
  ds_read_b64_tr_b16 v[24:25], v12 offset:0
  ds_read_b64_tr_b16 v[26:27], v12 offset:2048
  s_waitcnt vmcnt(8) lgkmcnt(12)
  v_mfma_f32_16x16x32_bf16 v[160:163], v[32:35], v[116:119], v[160:163]
  ds_read_b64_tr_b16 v[28:29], v13 offset:0
  ds_read_b64_tr_b16 v[30:31], v13 offset:2048
  s_waitcnt lgkmcnt(12)
  v_mfma_f32_16x16x32_bf16 v[164:167], v[36:39], v[116:119], v[164:167]
  ds_read_b64_tr_b16 v[32:33], v10 offset:24576
  ds_read_b64_tr_b16 v[34:35], v10 offset:26624
  s_add_u32 s57, s63, 9216
  buffer_store_dwordx4 v[56:59], v5, s[20:23], s57 offen sc1
  s_waitcnt lgkmcnt(12)
  v_mfma_f32_16x16x32_bf16 v[168:171], v[40:43], v[116:119], v[168:171]
  ds_read_b64_tr_b16 v[36:37], v11 offset:24576
  ds_read_b64_tr_b16 v[38:39], v11 offset:26624
  s_waitcnt lgkmcnt(12)
  v_mfma_f32_16x16x32_bf16 v[172:175], v[44:47], v[116:119], v[172:175]
  ds_read_b64_tr_b16 v[40:41], v12 offset:24576
  ds_read_b64_tr_b16 v[42:43], v12 offset:26624
  s_waitcnt vmcnt(8) lgkmcnt(12)
  v_mfma_f32_16x16x32_bf16 v[160:163], v[16:19], v[120:123], v[160:163]
  ds_read_b64_tr_b16 v[44:45], v13 offset:24576
  ds_read_b64_tr_b16 v[46:47], v13 offset:26624
  s_waitcnt lgkmcnt(12)
  v_mfma_f32_16x16x32_bf16 v[164:167], v[20:23], v[120:123], v[164:167]
  v_add_u32 v10, 49152, v10
  v_add_u32 v11, 49152, v11
  v_add_u32 v12, 49152, v12
  v_add_u32 v13, 49152, v13
  ds_read_b64_tr_b16 v[16:17], v10 offset:8192
  ds_read_b64_tr_b16 v[18:19], v10 offset:10240
  s_add_u32 s57, s63, 10240
  buffer_store_dwordx4 v[64:67], v5, s[20:23], s57 offen sc1
  s_waitcnt lgkmcnt(12)
  v_mfma_f32_16x16x32_bf16 v[168:171], v[24:27], v[120:123], v[168:171]
  ds_read_b64_tr_b16 v[20:21], v11 offset:8192
  ds_read_b64_tr_b16 v[22:23], v11 offset:10240
  s_waitcnt lgkmcnt(12)
  v_mfma_f32_16x16x32_bf16 v[172:175], v[28:31], v[120:123], v[172:175]
  ds_read_b64_tr_b16 v[24:25], v12 offset:8192
  ds_read_b64_tr_b16 v[26:27], v12 offset:10240
  s_waitcnt vmcnt(8) lgkmcnt(12)
  v_mfma_f32_16x16x32_bf16 v[160:163], v[32:35], v[124:127], v[160:163]
  ds_read_b64_tr_b16 v[28:29], v13 offset:8192
  ds_read_b64_tr_b16 v[30:31], v13 offset:10240
  s_waitcnt lgkmcnt(12)
  v_mfma_f32_16x16x32_bf16 v[164:167], v[36:39], v[124:127], v[164:167]
  ds_read_b64_tr_b16 v[32:33], v10 offset:32768
  ds_read_b64_tr_b16 v[34:35], v10 offset:34816
  s_add_u32 s57, s63, 11264
  buffer_store_dwordx4 v[72:75], v5, s[20:23], s57 offen sc1
  s_waitcnt lgkmcnt(12)
  v_mfma_f32_16x16x32_bf16 v[168:171], v[40:43], v[124:127], v[168:171]
  ds_read_b64_tr_b16 v[36:37], v11 offset:32768
  ds_read_b64_tr_b16 v[38:39], v11 offset:34816
  s_waitcnt lgkmcnt(12)
  v_mfma_f32_16x16x32_bf16 v[172:175], v[44:47], v[124:127], v[172:175]
  ds_read_b64_tr_b16 v[40:41], v12 offset:32768
  ds_read_b64_tr_b16 v[42:43], v12 offset:34816
  s_waitcnt vmcnt(8) lgkmcnt(12)
  v_mfma_f32_16x16x32_bf16 v[160:163], v[16:19], v[128:131], v[160:163]
  ds_read_b64_tr_b16 v[44:45], v13 offset:32768
  ds_read_b64_tr_b16 v[46:47], v13 offset:34816
  s_waitcnt lgkmcnt(12)
  v_mfma_f32_16x16x32_bf16 v[164:167], v[20:23], v[128:131], v[164:167]
  ds_read_b64_tr_b16 v[16:17], v10 offset:0
  ds_read_b64_tr_b16 v[18:19], v10 offset:2048
  s_add_u32 s57, s63, 12288
  buffer_store_dwordx4 v[80:83], v5, s[20:23], s57 offen sc1
  s_waitcnt lgkmcnt(12)
  v_mfma_f32_16x16x32_bf16 v[168:171], v[24:27], v[128:131], v[168:171]
  ds_read_b64_tr_b16 v[20:21], v11 offset:0
  ds_read_b64_tr_b16 v[22:23], v11 offset:2048
  s_waitcnt lgkmcnt(12)
  v_mfma_f32_16x16x32_bf16 v[172:175], v[28:31], v[128:131], v[172:175]
  ds_read_b64_tr_b16 v[24:25], v12 offset:0
  ds_read_b64_tr_b16 v[26:27], v12 offset:2048
  s_waitcnt vmcnt(8) lgkmcnt(12)
  v_mfma_f32_16x16x32_bf16 v[160:163], v[32:35], v[132:135], v[160:163]
  ds_read_b64_tr_b16 v[28:29], v13 offset:0
  ds_read_b64_tr_b16 v[30:31], v13 offset:2048
  s_waitcnt lgkmcnt(12)
  v_mfma_f32_16x16x32_bf16 v[164:167], v[36:39], v[132:135], v[164:167]
  ds_read_b64_tr_b16 v[32:33], v10 offset:24576
  ds_read_b64_tr_b16 v[34:35], v10 offset:26624
  s_add_u32 s57, s63, 13312
  buffer_store_dwordx4 v[88:91], v5, s[20:23], s57 offen sc1
  s_waitcnt lgkmcnt(12)
  v_mfma_f32_16x16x32_bf16 v[168:171], v[40:43], v[132:135], v[168:171]
  ds_read_b64_tr_b16 v[36:37], v11 offset:24576
  ds_read_b64_tr_b16 v[38:39], v11 offset:26624
  s_waitcnt lgkmcnt(12)
  v_mfma_f32_16x16x32_bf16 v[172:175], v[44:47], v[132:135], v[172:175]
  ds_read_b64_tr_b16 v[40:41], v12 offset:24576
  ds_read_b64_tr_b16 v[42:43], v12 offset:26624
  s_waitcnt vmcnt(8) lgkmcnt(12)
  v_mfma_f32_16x16x32_bf16 v[160:163], v[16:19], v[136:139], v[160:163]
  ds_read_b64_tr_b16 v[44:45], v13 offset:24576
  ds_read_b64_tr_b16 v[46:47], v13 offset:26624
  s_waitcnt lgkmcnt(12)
  v_mfma_f32_16x16x32_bf16 v[164:167], v[20:23], v[136:139], v[164:167]
  s_waitcnt lgkmcnt(10)
  v_mfma_f32_16x16x32_bf16 v[168:171], v[24:27], v[136:139], v[168:171]
  s_waitcnt lgkmcnt(8)
  v_mfma_f32_16x16x32_bf16 v[172:175], v[28:31], v[136:139], v[172:175]
  s_waitcnt vmcnt(7) lgkmcnt(6)
  v_mfma_f32_16x16x32_bf16 v[160:163], v[32:35], v[140:143], v[160:163]
  s_waitcnt lgkmcnt(4)
  v_mfma_f32_16x16x32_bf16 v[164:167], v[36:39], v[140:143], v[164:167]
  s_waitcnt lgkmcnt(2)
  v_mfma_f32_16x16x32_bf16 v[168:171], v[40:43], v[140:143], v[168:171]
  s_waitcnt lgkmcnt(0)
  v_mfma_f32_16x16x32_bf16 v[172:175], v[44:47], v[140:143], v[172:175]
  s_add_u32 s57, s61, 4096
  v_add_u32 v14, s57, v5
  s_nop 3
  ds_write_b128 v14, v[168:171]
  s_nop 0
  ds_write_b128 v14, v[172:175] offset:1024
  s_xor_b32 s57, s54, 4
  s_mul_i32 s57, s57, 12288
  s_add_u32 s57, s57, 69632
  v_add_u32 v15, s57, v5
  s_waitcnt lgkmcnt(0)
  s_barrier
  ds_read_b128 v[240:243], v15
  ds_read_b128 v[244:247], v15 offset:1024
  s_add_u32 s57, s63, 14336
  buffer_store_dwordx4 v[96:99], v5, s[20:23], s57 offen sc1
  s_add_u32 s57, s63, 15360
  buffer_store_dwordx4 v[104:107], v5, s[20:23], s57 offen sc1
  s_waitcnt lgkmcnt(1)
  v_add_f32 v160, v160, v240
  v_add_f32 v161, v161, v241
  v_add_f32 v162, v162, v242
  v_add_f32 v163, v163, v243
  s_waitcnt lgkmcnt(0)
  v_add_f32 v164, v164, v244
  v_add_f32 v165, v165, v245
  v_add_f32 v166, v166, v246
  v_add_f32 v167, v167, v247
  s_waitcnt vmcnt(8)
  v_lshlrev_b32 v176, 16, v144
  v_and_b32 v177, 0xffff0000, v144
  v_lshlrev_b32 v178, 16, v145
  v_and_b32 v179, 0xffff0000, v145
  v_lshlrev_b32 v180, 16, v146
  v_and_b32 v181, 0xffff0000, v146
  v_lshlrev_b32 v182, 16, v147
  v_and_b32 v183, 0xffff0000, v147
  v_add_f32 v160, v160, v176
  v_add_f32 v161, v161, v177
  v_add_f32 v162, v162, v178
  v_add_f32 v163, v163, v179
  v_add_f32 v164, v164, v180
  v_add_f32 v165, v165, v181
  v_add_f32 v166, v166, v182
  v_add_f32 v167, v167, v183
  v_cvt_pk_bf16_f32 v184, v160, v161
  v_cvt_pk_bf16_f32 v185, v162, v163
  v_cvt_pk_bf16_f32 v186, v164, v165
  v_cvt_pk_bf16_f32 v187, v166, v167
  s_add_u32 s57, s46, 8388608
  buffer_store_dwordx4 v[184:187], v5, s[28:31], s57 offen
  v_lshlrev_b32 v176, 16, v184
  v_and_b32 v177, 0xffff0000, v184
  v_lshlrev_b32 v178, 16, v185
  v_and_b32 v179, 0xffff0000, v185
  v_lshlrev_b32 v180, 16, v186
  v_and_b32 v181, 0xffff0000, v186
  v_lshlrev_b32 v182, 16, v187
  v_and_b32 v183, 0xffff0000, v187
  v_add_f32 v188, v176, v177
  v_add_f32 v188, v188, v178
  v_add_f32 v188, v188, v179
  v_add_f32 v188, v188, v180
  v_add_f32 v188, v188, v181
  v_add_f32 v188, v188, v182
  v_add_f32 v188, v188, v183
  v_mov_b32 v190, v188
  s_nop 1
  v_permlane16_swap_b32 v190, v188
  v_add_f32 v188, v188, v190
  v_mov_b32 v190, v188
  s_nop 1
  v_permlane32_swap_b32 v190, v188
  v_add_f32 v188, v188, v190
  v_mul_f32 v188, 0x3d000000, v188
  v_sub_f32 v176, v176, v188
  v_sub_f32 v177, v177, v188
  v_sub_f32 v178, v178, v188
  v_sub_f32 v179, v179, v188
  v_sub_f32 v180, v180, v188
  v_sub_f32 v181, v181, v188
  v_sub_f32 v182, v182, v188
  v_sub_f32 v183, v183, v188
  v_mul_f32 v189, v176, v176
  v_fmac_f32 v189, v177, v177
  v_fmac_f32 v189, v178, v178
  v_fmac_f32 v189, v179, v179
  v_fmac_f32 v189, v180, v180
  v_fmac_f32 v189, v181, v181
  v_fmac_f32 v189, v182, v182
  v_fmac_f32 v189, v183, v183
  v_mov_b32 v190, v189
  s_nop 1
  v_permlane16_swap_b32 v190, v189
  v_add_f32 v189, v189, v190
  v_mov_b32 v190, v189
  s_nop 1
  v_permlane32_swap_b32 v190, v189
  v_add_f32 v189, v189, v190
  v_lshlrev_b32 v14, 7, v1
  v_mov_b32 v15, 0x40000000
  v_cmp_gt_u32 vcc, 16, v1
  s_nop 1
  v_cndmask_b32 v14, v15, v14, vcc
  s_lshl_b32 s57, s51, 1
  s_add_u32 s57, s57, s50
  s_lshl_b32 s57, s57, 3
  s_lshl_b32 s58, s52, 11
  s_add_u32 s57, s57, s58
  s_add_u32 s57, s57, 10485760
  v_mov_b32 v192, v188
  v_mov_b32 v193, v189
  buffer_store_dwordx2 v[192:193], v14, s[28:31], s57 offen
  s_waitcnt vmcnt(0)
kv_kernel_done:
  s_endpgm
.text
.globl at_kernel
.p2align 8
.type at_kernel,@function
at_kernel:
  s_cmp_ge_u32 s2, 256
  s_cbranch_scc1 at_kernel_done
  s_load_dwordx2 s[4:5], s[0:1], 104
  s_load_dwordx2 s[6:7], s[0:1], 16
  s_load_dwordx2 s[8:9], s[0:1], 72
  v_and_b32 v1, 63, v0
  v_lshrrev_b32 v2, 6, v0
  s_nop 0
  v_readfirstlane_b32 s10, v2
  s_and_b32 s19, s2, 7
  s_lshl_b32 s19, s19, 2
  s_bfe_u32 s20, s2, 0x20003
  s_add_u32 s11, s19, s20
  s_lshr_b32 s12, s2, 5
  s_lshl_b32 s19, s12, 2
  s_sub_u32 s32, 64, s19
  s_sub_u32 s15, 16, s12
  s_lshl_b32 s20, s12, 1
  s_sub_u32 s16, 15, s20
  s_cmp_ge_u32 s10, 4
  s_cbranch_scc1 at_kernel_roleB
  s_sub_u32 s13, 60, s19
  s_add_u32 s13, s13, s10
  s_sub_u32 s14, 3, s10
  s_mov_b32 s31, s14
  s_branch at_kernel_roleE
at_kernel_roleB:
  s_sub_u32 s20, 7, s10
  s_add_u32 s13, s19, s20
  s_sub_u32 s14, s10, 4
  s_lshl_b32 s31, s16, 2
  s_add_u32 s31, s31, s14
at_kernel_roleE:
  s_lshr_b32 s29, s13, 2
  s_and_b32 s30, s13, 3
  s_add_u32 s18, s12, 1
  v_lshrrev_b32 v2, 4, v1
  v_lshlrev_b32 v3, 2, v2
  v_and_b32 v188, 15, v1
  v_xor_b32 v188, v188, v3
  v_lshlrev_b32 v188, 4, v188
  v_lshl_add_u32 v188, v2, 13, v188
  v_add_u32 v206, 31744, v188
  s_lshl_b32 s19, s10, 16
  s_lshl_b32 s22, s11, 8
  s_add_u32 s22, s22, s19
  s_lshl_b32 s23, s10, 11
  s_and_b32 s19, s2, 7
  s_lshl_b32 s19, s19, 1
  s_bfe_u32 s20, s2, 0x10003
  s_add_u32 s19, s19, s20
  s_lshr_b32 s38, s2, 4
  s_lshl_b32 s19, s19, 3
  s_and_b32 s20, s10, 3
  s_lshl_b32 s20, s20, 1
  s_add_u32 s39, s19, s20
  s_lshl_b32 s40, s39, 14
  s_lshr_b32 s19, s10, 2
  s_lshl_b32 s19, s19, 10
  s_add_u32 s40, s40, s19
  s_lshl_b32 s41, s38, 8
  s_add_u32 s19, s32, 8
  s_mul_i32 s20, s19, 205
  s_lshr_b32 s20, s20, 11
  s_mul_i32 s20, s20, 10
  s_sub_u32 s42, s19, s20
  s_lshl_b32 s42, s42, 14
  s_add_u32 s19, s32, 7
  s_mul_i32 s20, s19, 205
  s_lshr_b32 s20, s20, 11
  s_mul_i32 s20, s20, 10
  s_sub_u32 s45, s19, s20
  s_lshl_b32 s45, s45, 14
  v_bfe_u32 v2, v1, 4, 1
  v_lshlrev_b32 v2, 14, v2
  v_and_b32 v3, 15, v1
  v_lshl_add_u32 v2, v3, 4, v2
  v_lshrrev_b32 v3, 5, v1
  v_lshl_add_u32 v189, v3, 8, v2
  s_lshl_b32 s24, s13, 15
  s_waitcnt lgkmcnt(0)
  s_mov_b32 s48, s6
  s_mov_b32 s49, s7
  s_mov_b32 s50, 4194304
  s_mov_b32 s51, 0x20000
  s_add_u32 s52, s4, 33554432
  s_addc_u32 s53, s5, 0
  s_mov_b32 s54, 2097152
  s_mov_b32 s55, 0x20000
  s_lshr_b32 s19, s2, 5
  s_mul_i32 s19, s19, 1
  s_bfe_u32 s20, s2, 0x20003
  s_mul_i32 s20, s20, 0
  s_add_u32 s64, s19, s20
  s_add_u32 m0, s23, 0
  s_add_u32 s19, s64, 0
  s_and_b32 s19, s19, 7
  s_lshl_b32 s19, s19, 19
  s_add_u32 s19, s19, s22
  buffer_load_dwordx4 v188, s[48:51], s19 offen lds
  buffer_load_dwordx4 v206, s[48:51], s19 offen offset:1024 lds
  s_add_u32 s65, s64, 0
  s_and_b32 s65, s65, 7
  s_lshl_b32 s65, s65, 11
  s_add_u32 s65, s65, s24
  buffer_load_dwordx4 v[68:71], v189, s[52:55], s65 offen offset:0
  buffer_load_dwordx4 v[72:75], v189, s[52:55], s65 offen offset:512
  buffer_load_dwordx4 v[76:79], v189, s[52:55], s65 offen offset:1024
  buffer_load_dwordx4 v[80:83], v189, s[52:55], s65 offen offset:1536
  s_add_u32 m0, s23, 16384
  s_add_u32 s19, s64, 1
  s_and_b32 s19, s19, 7
  s_lshl_b32 s19, s19, 19
  s_add_u32 s19, s19, s22
  buffer_load_dwordx4 v188, s[48:51], s19 offen lds
  buffer_load_dwordx4 v206, s[48:51], s19 offen offset:1024 lds
  s_mov_b32 s56, s4
  s_mov_b32 s57, s5
  s_mov_b32 s58, 33554432
  s_mov_b32 s59, 0x20000
  s_add_u32 s60, s4, 54525952
  s_addc_u32 s61, s5, 0
  s_mov_b32 s62, 16777216
  s_mov_b32 s63, 0x20000
  v_bfe_u32 v2, v1, 2, 2
  v_lshrrev_b32 v3, 5, v1
  v_lshl_add_u32 v3, v3, 2, v2
  v_lshlrev_b32 v3, 8, v3
  v_bfe_u32 v191, v1, 4, 1
  v_lshl_add_u32 v3, v191, 5, v3
  v_and_b32 v191, 3, v1
  v_lshl_add_u32 v3, v191, 3, v3
  v_xor_b32 v194, 3, v2
  v_lshl_add_u32 v194, v194, 6, v3
  v_xor_b32 v193, 2, v2
  v_lshl_add_u32 v193, v193, 6, v3
  v_xor_b32 v192, 1, v2
  v_lshl_add_u32 v192, v192, 6, v3
  v_xor_b32 v191, 0, v2
  v_lshl_add_u32 v191, v191, 6, v3
  v_lshlrev_b32 v190, 4, v1
  s_lshl_b32 s25, s11, 20
  s_sub_u32 s19, s10, 4
  s_lshl_b32 s34, s19, 12
  s_add_u32 s33, s25, s34
  s_add_u32 s25, s25, s23
  s_mov_b32 s26, s25
  s_sub_u32 s19, s32, 1
  s_lshl_b32 s19, s19, 14
  s_add_u32 s35, s19, s25
  s_add_u32 s36, s19, s33
  s_add_u32 s27, s23, 131072
  s_add_u32 s28, s23, 163840
  v_and_b32 v200, 31, v1
  v_lshrrev_b32 v2, 5, v1
  v_lshlrev_b32 v2, 2, v2
  v_sub_u32 v200, v200, v2
  v_mov_b32 v201, 0xff800000
  v_bfe_u32 v2, v1, 4, 1
  v_lshlrev_b32 v2, 17, v2
  v_and_b32 v3, 15, v1
  v_lshl_add_u32 v2, v3, 4, v2
  v_lshrrev_b32 v3, 5, v1
  v_lshl_add_u32 v202, v3, 8, v2
  v_mov_b32 v204, 0
  v_mov_b32 v205, 0
  s_waitcnt vmcnt(6)
  s_barrier
  ds_read_b64_tr_b16 v[156:157], v191 offset:0
  ds_read_b64_tr_b16 v[158:159], v191 offset:4096
  ds_read_b64_tr_b16 v[160:161], v192 offset:0
  ds_read_b64_tr_b16 v[162:163], v192 offset:4096
  ds_read_b64_tr_b16 v[164:165], v193 offset:0
  ds_read_b64_tr_b16 v[166:167], v193 offset:4096
  ds_read_b64_tr_b16 v[168:169], v194 offset:0
  ds_read_b64_tr_b16 v[170:171], v194 offset:4096
  s_waitcnt vmcnt(5) lgkmcnt(6)
  v_mfma_f32_32x32x16_bf16 v[4:19], v[156:159], v[68:71], 0
  ds_read_b64_tr_b16 v[172:173], v191 offset:2048
  ds_read_b64_tr_b16 v[174:175], v191 offset:6144
  s_waitcnt lgkmcnt(6)
  v_mfma_f32_32x32x16_bf16 v[20:35], v[160:163], v[68:71], 0
  ds_read_b64_tr_b16 v[176:177], v192 offset:2048
  ds_read_b64_tr_b16 v[178:179], v192 offset:6144
  s_add_u32 s65, s64, 1
  s_and_b32 s65, s65, 7
  s_lshl_b32 s65, s65, 11
  s_add_u32 s65, s65, s24
  buffer_load_dwordx4 v[84:87], v189, s[52:55], s65 offen offset:0
  s_waitcnt lgkmcnt(6)
  v_mfma_f32_32x32x16_bf16 v[36:51], v[164:167], v[68:71], 0
  ds_read_b64_tr_b16 v[180:181], v193 offset:2048
  ds_read_b64_tr_b16 v[182:183], v193 offset:6144
  s_waitcnt lgkmcnt(6)
  v_mfma_f32_32x32x16_bf16 v[52:67], v[168:171], v[68:71], 0
  ds_read_b64_tr_b16 v[184:185], v194 offset:2048
  ds_read_b64_tr_b16 v[186:187], v194 offset:6144
  buffer_load_dwordx4 v[88:91], v189, s[52:55], s65 offen offset:512
  s_waitcnt vmcnt(6) lgkmcnt(6)
  v_mfma_f32_32x32x16_bf16 v[4:19], v[172:175], v[72:75], v[4:19]
  ds_read_b64_tr_b16 v[156:157], v191 offset:8192
  ds_read_b64_tr_b16 v[158:159], v191 offset:12288
  s_waitcnt lgkmcnt(6)
  v_mfma_f32_32x32x16_bf16 v[20:35], v[176:179], v[72:75], v[20:35]
  ds_read_b64_tr_b16 v[160:161], v192 offset:8192
  ds_read_b64_tr_b16 v[162:163], v192 offset:12288
  buffer_load_dwordx4 v[92:95], v189, s[52:55], s65 offen offset:1024
  s_waitcnt lgkmcnt(6)
  v_mfma_f32_32x32x16_bf16 v[36:51], v[180:183], v[72:75], v[36:51]
  ds_read_b64_tr_b16 v[164:165], v193 offset:8192
  ds_read_b64_tr_b16 v[166:167], v193 offset:12288
  s_waitcnt lgkmcnt(6)
  v_mfma_f32_32x32x16_bf16 v[52:67], v[184:187], v[72:75], v[52:67]
  ds_read_b64_tr_b16 v[168:169], v194 offset:8192
  ds_read_b64_tr_b16 v[170:171], v194 offset:12288
  buffer_load_dwordx4 v[96:99], v189, s[52:55], s65 offen offset:1536
  s_waitcnt vmcnt(7) lgkmcnt(6)
  v_mfma_f32_32x32x16_bf16 v[4:19], v[156:159], v[76:79], v[4:19]
  ds_read_b64_tr_b16 v[172:173], v191 offset:10240
  ds_read_b64_tr_b16 v[174:175], v191 offset:14336
  s_waitcnt lgkmcnt(6)
  v_mfma_f32_32x32x16_bf16 v[20:35], v[160:163], v[76:79], v[20:35]
  ds_read_b64_tr_b16 v[176:177], v192 offset:10240
  ds_read_b64_tr_b16 v[178:179], v192 offset:14336
  s_add_u32 m0, s23, 32768
  s_add_u32 s19, s64, 2
  s_and_b32 s19, s19, 7
  s_lshl_b32 s19, s19, 19
  s_add_u32 s19, s19, s22
  buffer_load_dwordx4 v188, s[48:51], s19 offen lds
  buffer_load_dwordx4 v206, s[48:51], s19 offen offset:1024 lds
  s_waitcnt lgkmcnt(6)
  v_mfma_f32_32x32x16_bf16 v[36:51], v[164:167], v[76:79], v[36:51]
  ds_read_b64_tr_b16 v[180:181], v193 offset:10240
  ds_read_b64_tr_b16 v[182:183], v193 offset:14336
  s_waitcnt lgkmcnt(6)
  v_mfma_f32_32x32x16_bf16 v[52:67], v[168:171], v[76:79], v[52:67]
  ds_read_b64_tr_b16 v[184:185], v194 offset:10240
  ds_read_b64_tr_b16 v[186:187], v194 offset:14336
  s_add_u32 s65, s64, 2
  s_and_b32 s65, s65, 7
  s_lshl_b32 s65, s65, 11
  s_add_u32 s65, s65, s24
  buffer_load_dwordx4 v[100:103], v189, s[52:55], s65 offen offset:0
  s_waitcnt vmcnt(9) lgkmcnt(6)
  v_mfma_f32_32x32x16_bf16 v[4:19], v[172:175], v[80:83], v[4:19]
  s_waitcnt vmcnt(7)
  s_barrier
  ds_read_b64_tr_b16 v[156:157], v191 offset:16384
  ds_read_b64_tr_b16 v[158:159], v191 offset:20480
  s_waitcnt lgkmcnt(6)
  v_mfma_f32_32x32x16_bf16 v[20:35], v[176:179], v[80:83], v[20:35]
  ds_read_b64_tr_b16 v[160:161], v192 offset:16384
  ds_read_b64_tr_b16 v[162:163], v192 offset:20480
  buffer_load_dwordx4 v[104:107], v189, s[52:55], s65 offen offset:512
  s_waitcnt lgkmcnt(6)
  v_mfma_f32_32x32x16_bf16 v[36:51], v[180:183], v[80:83], v[36:51]
  ds_read_b64_tr_b16 v[164:165], v193 offset:16384
  ds_read_b64_tr_b16 v[166:167], v193 offset:20480
  s_waitcnt lgkmcnt(6)
  v_mfma_f32_32x32x16_bf16 v[52:67], v[184:187], v[80:83], v[52:67]
  ds_read_b64_tr_b16 v[168:169], v194 offset:16384
  ds_read_b64_tr_b16 v[170:171], v194 offset:20480
  buffer_load_dwordx4 v[108:111], v189, s[52:55], s65 offen offset:1024
  s_waitcnt vmcnt(8) lgkmcnt(6)
  v_mfma_f32_32x32x16_bf16 v[4:19], v[156:159], v[84:87], v[4:19]
  ds_read_b64_tr_b16 v[172:173], v191 offset:18432
  ds_read_b64_tr_b16 v[174:175], v191 offset:22528
  s_waitcnt lgkmcnt(6)
  v_mfma_f32_32x32x16_bf16 v[20:35], v[160:163], v[84:87], v[20:35]
  ds_read_b64_tr_b16 v[176:177], v192 offset:18432
  ds_read_b64_tr_b16 v[178:179], v192 offset:22528
  buffer_load_dwordx4 v[112:115], v189, s[52:55], s65 offen offset:1536
  s_waitcnt lgkmcnt(6)
  v_mfma_f32_32x32x16_bf16 v[36:51], v[164:167], v[84:87], v[36:51]
  ds_read_b64_tr_b16 v[180:181], v193 offset:18432
  ds_read_b64_tr_b16 v[182:183], v193 offset:22528
  s_waitcnt lgkmcnt(6)
  v_mfma_f32_32x32x16_bf16 v[52:67], v[168:171], v[84:87], v[52:67]
  ds_read_b64_tr_b16 v[184:185], v194 offset:18432
  ds_read_b64_tr_b16 v[186:187], v194 offset:22528
  s_add_u32 m0, s23, 49152
  s_add_u32 s19, s64, 3
  s_and_b32 s19, s19, 7
  s_lshl_b32 s19, s19, 19
  s_add_u32 s19, s19, s22
  buffer_load_dwordx4 v188, s[48:51], s19 offen lds
  buffer_load_dwordx4 v206, s[48:51], s19 offen offset:1024 lds
  s_waitcnt vmcnt(10) lgkmcnt(6)
  v_mfma_f32_32x32x16_bf16 v[4:19], v[172:175], v[88:91], v[4:19]
  ds_read_b64_tr_b16 v[156:157], v191 offset:24576
  ds_read_b64_tr_b16 v[158:159], v191 offset:28672
  s_waitcnt lgkmcnt(6)
  v_mfma_f32_32x32x16_bf16 v[20:35], v[176:179], v[88:91], v[20:35]
  ds_read_b64_tr_b16 v[160:161], v192 offset:24576
  ds_read_b64_tr_b16 v[162:163], v192 offset:28672
  s_add_u32 s65, s64, 3
  s_and_b32 s65, s65, 7
  s_lshl_b32 s65, s65, 11
  s_add_u32 s65, s65, s24
  buffer_load_dwordx4 v[116:119], v189, s[52:55], s65 offen offset:0
  s_waitcnt lgkmcnt(6)
  v_mfma_f32_32x32x16_bf16 v[36:51], v[180:183], v[88:91], v[36:51]
  ds_read_b64_tr_b16 v[164:165], v193 offset:24576
  ds_read_b64_tr_b16 v[166:167], v193 offset:28672
  s_waitcnt lgkmcnt(6)
  v_mfma_f32_32x32x16_bf16 v[52:67], v[184:187], v[88:91], v[52:67]
  ds_read_b64_tr_b16 v[168:169], v194 offset:24576
  ds_read_b64_tr_b16 v[170:171], v194 offset:28672
  buffer_load_dwordx4 v[120:123], v189, s[52:55], s65 offen offset:512
  s_waitcnt vmcnt(11) lgkmcnt(6)
  v_mfma_f32_32x32x16_bf16 v[4:19], v[156:159], v[92:95], v[4:19]
  ds_read_b64_tr_b16 v[172:173], v191 offset:26624
  ds_read_b64_tr_b16 v[174:175], v191 offset:30720
  s_waitcnt lgkmcnt(6)
  v_mfma_f32_32x32x16_bf16 v[20:35], v[160:163], v[92:95], v[20:35]
  ds_read_b64_tr_b16 v[176:177], v192 offset:26624
  ds_read_b64_tr_b16 v[178:179], v192 offset:30720
  buffer_load_dwordx4 v[124:127], v189, s[52:55], s65 offen offset:1024
  s_waitcnt lgkmcnt(6)
  v_mfma_f32_32x32x16_bf16 v[36:51], v[164:167], v[92:95], v[36:51]
  ds_read_b64_tr_b16 v[180:181], v193 offset:26624
  ds_read_b64_tr_b16 v[182:183], v193 offset:30720
  s_waitcnt lgkmcnt(6)
  v_mfma_f32_32x32x16_bf16 v[52:67], v[168:171], v[92:95], v[52:67]
  ds_read_b64_tr_b16 v[184:185], v194 offset:26624
  ds_read_b64_tr_b16 v[186:187], v194 offset:30720
  buffer_load_dwordx4 v[128:131], v189, s[52:55], s65 offen offset:1536
  s_waitcnt vmcnt(12) lgkmcnt(6)
  v_mfma_f32_32x32x16_bf16 v[4:19], v[172:175], v[96:99], v[4:19]
  s_waitcnt vmcnt(10)
  s_barrier
  ds_read_b64_tr_b16 v[156:157], v191 offset:32768
  ds_read_b64_tr_b16 v[158:159], v191 offset:36864
  s_waitcnt lgkmcnt(6)
  v_mfma_f32_32x32x16_bf16 v[20:35], v[176:179], v[96:99], v[20:35]
  ds_read_b64_tr_b16 v[160:161], v192 offset:32768
  ds_read_b64_tr_b16 v[162:163], v192 offset:36864
  s_add_u32 m0, s23, 65536
  s_add_u32 s19, s64, 4
  s_and_b32 s19, s19, 7
  s_lshl_b32 s19, s19, 19
  s_add_u32 s19, s19, s22
  buffer_load_dwordx4 v188, s[48:51], s19 offen lds
  buffer_load_dwordx4 v206, s[48:51], s19 offen offset:1024 lds
  s_waitcnt lgkmcnt(6)
  v_mfma_f32_32x32x16_bf16 v[36:51], v[180:183], v[96:99], v[36:51]
  ds_read_b64_tr_b16 v[164:165], v193 offset:32768
  ds_read_b64_tr_b16 v[166:167], v193 offset:36864
  s_waitcnt lgkmcnt(6)
  v_mfma_f32_32x32x16_bf16 v[52:67], v[184:187], v[96:99], v[52:67]
  ds_read_b64_tr_b16 v[168:169], v194 offset:32768
  ds_read_b64_tr_b16 v[170:171], v194 offset:36864
  s_add_u32 s65, s64, 4
  s_and_b32 s65, s65, 7
  s_lshl_b32 s65, s65, 11
  s_add_u32 s65, s65, s24
  buffer_load_dwordx4 v[132:135], v189, s[52:55], s65 offen offset:0
  s_waitcnt vmcnt(12) lgkmcnt(6)
  v_mfma_f32_32x32x16_bf16 v[4:19], v[156:159], v[100:103], v[4:19]
  ds_read_b64_tr_b16 v[172:173], v191 offset:34816
  ds_read_b64_tr_b16 v[174:175], v191 offset:38912
  s_waitcnt lgkmcnt(6)
  v_mfma_f32_32x32x16_bf16 v[20:35], v[160:163], v[100:103], v[20:35]
  ds_read_b64_tr_b16 v[176:177], v192 offset:34816
  ds_read_b64_tr_b16 v[178:179], v192 offset:38912
  buffer_load_dwordx4 v[136:139], v189, s[52:55], s65 offen offset:512
  s_waitcnt lgkmcnt(6)
  v_mfma_f32_32x32x16_bf16 v[36:51], v[164:167], v[100:103], v[36:51]
  ds_read_b64_tr_b16 v[180:181], v193 offset:34816
  ds_read_b64_tr_b16 v[182:183], v193 offset:38912
  s_waitcnt lgkmcnt(6)
  v_mfma_f32_32x32x16_bf16 v[52:67], v[168:171], v[100:103], v[52:67]
  ds_read_b64_tr_b16 v[184:185], v194 offset:34816
  ds_read_b64_tr_b16 v[186:187], v194 offset:38912
  buffer_load_dwordx4 v[140:143], v189, s[52:55], s65 offen offset:1024
  s_waitcnt vmcnt(13) lgkmcnt(6)
  v_mfma_f32_32x32x16_bf16 v[4:19], v[172:175], v[104:107], v[4:19]
  ds_read_b64_tr_b16 v[156:157], v191 offset:40960
  ds_read_b64_tr_b16 v[158:159], v191 offset:45056
  s_waitcnt lgkmcnt(6)
  v_mfma_f32_32x32x16_bf16 v[20:35], v[176:179], v[104:107], v[20:35]
  ds_read_b64_tr_b16 v[160:161], v192 offset:40960
  ds_read_b64_tr_b16 v[162:163], v192 offset:45056
  buffer_load_dwordx4 v[144:147], v189, s[52:55], s65 offen offset:1536
  s_waitcnt lgkmcnt(6)
  v_mfma_f32_32x32x16_bf16 v[36:51], v[180:183], v[104:107], v[36:51]
  ds_read_b64_tr_b16 v[164:165], v193 offset:40960
  ds_read_b64_tr_b16 v[166:167], v193 offset:45056
  s_waitcnt lgkmcnt(6)
  v_mfma_f32_32x32x16_bf16 v[52:67], v[184:187], v[104:107], v[52:67]
  ds_read_b64_tr_b16 v[168:169], v194 offset:40960
  ds_read_b64_tr_b16 v[170:171], v194 offset:45056
  s_add_u32 m0, s23, 81920
  s_add_u32 s19, s64, 5
  s_and_b32 s19, s19, 7
  s_lshl_b32 s19, s19, 19
  s_add_u32 s19, s19, s22
  buffer_load_dwordx4 v188, s[48:51], s19 offen lds
  buffer_load_dwordx4 v206, s[48:51], s19 offen offset:1024 lds
  s_waitcnt vmcnt(15) lgkmcnt(6)
  v_mfma_f32_32x32x16_bf16 v[4:19], v[156:159], v[108:111], v[4:19]
  ds_read_b64_tr_b16 v[172:173], v191 offset:43008
  ds_read_b64_tr_b16 v[174:175], v191 offset:47104
  s_waitcnt lgkmcnt(6)
  v_mfma_f32_32x32x16_bf16 v[20:35], v[160:163], v[108:111], v[20:35]
  ds_read_b64_tr_b16 v[176:177], v192 offset:43008
  ds_read_b64_tr_b16 v[178:179], v192 offset:47104
  s_add_u32 s65, s64, 5
  s_and_b32 s65, s65, 7
  s_lshl_b32 s65, s65, 11
  s_add_u32 s65, s65, s24
  buffer_load_dwordx4 v[148:151], v189, s[52:55], s65 offen offset:0
  s_waitcnt lgkmcnt(6)
  v_mfma_f32_32x32x16_bf16 v[36:51], v[164:167], v[108:111], v[36:51]
  ds_read_b64_tr_b16 v[180:181], v193 offset:43008
  ds_read_b64_tr_b16 v[182:183], v193 offset:47104
  s_waitcnt lgkmcnt(6)
  v_mfma_f32_32x32x16_bf16 v[52:67], v[168:171], v[108:111], v[52:67]
  ds_read_b64_tr_b16 v[184:185], v194 offset:43008
  ds_read_b64_tr_b16 v[186:187], v194 offset:47104
  buffer_load_dwordx4 v[152:155], v189, s[52:55], s65 offen offset:512
  s_waitcnt vmcnt(16) lgkmcnt(6)
  v_mfma_f32_32x32x16_bf16 v[4:19], v[172:175], v[112:115], v[4:19]
  s_waitcnt vmcnt(14)
  s_barrier
  ds_read_b64_tr_b16 v[156:157], v191 offset:49152
  ds_read_b64_tr_b16 v[158:159], v191 offset:53248
  s_waitcnt lgkmcnt(6)
  v_mfma_f32_32x32x16_bf16 v[20:35], v[176:179], v[112:115], v[20:35]
  ds_read_b64_tr_b16 v[160:161], v192 offset:49152
  ds_read_b64_tr_b16 v[162:163], v192 offset:53248
  buffer_load_dwordx4 v[68:71], v189, s[52:55], s65 offen offset:1024
  s_waitcnt lgkmcnt(6)
  v_mfma_f32_32x32x16_bf16 v[36:51], v[180:183], v[112:115], v[36:51]
  ds_read_b64_tr_b16 v[164:165], v193 offset:49152
  ds_read_b64_tr_b16 v[166:167], v193 offset:53248
  s_waitcnt lgkmcnt(6)
  v_mfma_f32_32x32x16_bf16 v[52:67], v[184:187], v[112:115], v[52:67]
  ds_read_b64_tr_b16 v[168:169], v194 offset:49152
  ds_read_b64_tr_b16 v[170:171], v194 offset:53248
  buffer_load_dwordx4 v[72:75], v189, s[52:55], s65 offen offset:1536
  s_waitcnt vmcnt(15) lgkmcnt(6)
  v_mfma_f32_32x32x16_bf16 v[4:19], v[156:159], v[116:119], v[4:19]
  ds_read_b64_tr_b16 v[172:173], v191 offset:51200
  ds_read_b64_tr_b16 v[174:175], v191 offset:55296
  s_waitcnt lgkmcnt(6)
  v_mfma_f32_32x32x16_bf16 v[20:35], v[160:163], v[116:119], v[20:35]
  ds_read_b64_tr_b16 v[176:177], v192 offset:51200
  ds_read_b64_tr_b16 v[178:179], v192 offset:55296
  s_add_u32 m0, s23, 98304
  s_add_u32 s19, s64, 6
  s_and_b32 s19, s19, 7
  s_lshl_b32 s19, s19, 19
  s_add_u32 s19, s19, s22
  buffer_load_dwordx4 v188, s[48:51], s19 offen lds
  buffer_load_dwordx4 v206, s[48:51], s19 offen offset:1024 lds
  s_waitcnt lgkmcnt(6)
  v_mfma_f32_32x32x16_bf16 v[36:51], v[164:167], v[116:119], v[36:51]
  ds_read_b64_tr_b16 v[180:181], v193 offset:51200
  ds_read_b64_tr_b16 v[182:183], v193 offset:55296
  s_waitcnt lgkmcnt(6)
  v_mfma_f32_32x32x16_bf16 v[52:67], v[168:171], v[116:119], v[52:67]
  ds_read_b64_tr_b16 v[184:185], v194 offset:51200
  ds_read_b64_tr_b16 v[186:187], v194 offset:55296
  s_add_u32 s65, s64, 6
  s_and_b32 s65, s65, 7
  s_lshl_b32 s65, s65, 11
  s_add_u32 s65, s65, s24
  buffer_load_dwordx4 v[76:79], v189, s[52:55], s65 offen offset:0
  s_waitcnt vmcnt(17) lgkmcnt(6)
  v_mfma_f32_32x32x16_bf16 v[4:19], v[172:175], v[120:123], v[4:19]
  ds_read_b64_tr_b16 v[156:157], v191 offset:57344
  ds_read_b64_tr_b16 v[158:159], v191 offset:61440
  s_waitcnt lgkmcnt(6)
  v_mfma_f32_32x32x16_bf16 v[20:35], v[176:179], v[120:123], v[20:35]
  ds_read_b64_tr_b16 v[160:161], v192 offset:57344
  ds_read_b64_tr_b16 v[162:163], v192 offset:61440
  buffer_load_dwordx4 v[80:83], v189, s[52:55], s65 offen offset:512
  s_waitcnt lgkmcnt(6)
  v_mfma_f32_32x32x16_bf16 v[36:51], v[180:183], v[120:123], v[36:51]
  ds_read_b64_tr_b16 v[164:165], v193 offset:57344
  ds_read_b64_tr_b16 v[166:167], v193 offset:61440
  s_waitcnt lgkmcnt(6)
  v_mfma_f32_32x32x16_bf16 v[52:67], v[184:187], v[120:123], v[52:67]
  ds_read_b64_tr_b16 v[168:169], v194 offset:57344
  ds_read_b64_tr_b16 v[170:171], v194 offset:61440
  buffer_load_dwordx4 v[84:87], v189, s[52:55], s65 offen offset:1024
  s_waitcnt vmcnt(18) lgkmcnt(6)
  v_mfma_f32_32x32x16_bf16 v[4:19], v[156:159], v[124:127], v[4:19]
  ds_read_b64_tr_b16 v[172:173], v191 offset:59392
  ds_read_b64_tr_b16 v[174:175], v191 offset:63488
  s_waitcnt lgkmcnt(6)
  v_mfma_f32_32x32x16_bf16 v[20:35], v[160:163], v[124:127], v[20:35]
  ds_read_b64_tr_b16 v[176:177], v192 offset:59392
  ds_read_b64_tr_b16 v[178:179], v192 offset:63488
  buffer_load_dwordx4 v[88:91], v189, s[52:55], s65 offen offset:1536
  s_waitcnt lgkmcnt(6)
  v_mfma_f32_32x32x16_bf16 v[36:51], v[164:167], v[124:127], v[36:51]
  ds_read_b64_tr_b16 v[180:181], v193 offset:59392
  ds_read_b64_tr_b16 v[182:183], v193 offset:63488
  s_waitcnt lgkmcnt(6)
  v_mfma_f32_32x32x16_bf16 v[52:67], v[168:171], v[124:127], v[52:67]
  ds_read_b64_tr_b16 v[184:185], v194 offset:59392
  ds_read_b64_tr_b16 v[186:187], v194 offset:63488
  s_add_u32 m0, s23, 114688
  s_add_u32 s19, s64, 7
  s_and_b32 s19, s19, 7
  s_lshl_b32 s19, s19, 19
  s_add_u32 s19, s19, s22
  buffer_load_dwordx4 v188, s[48:51], s19 offen lds
  buffer_load_dwordx4 v206, s[48:51], s19 offen offset:1024 lds
  s_waitcnt vmcnt(20) lgkmcnt(6)
  v_mfma_f32_32x32x16_bf16 v[4:19], v[172:175], v[128:131], v[4:19]
  s_waitcnt vmcnt(18)
  s_barrier
  v_add_u32 v191, 0x10000, v191
  v_add_u32 v192, 0x10000, v192
  v_add_u32 v193, 0x10000, v193
  v_add_u32 v194, 0x10000, v194
  ds_read_b64_tr_b16 v[156:157], v191 offset:0
  ds_read_b64_tr_b16 v[158:159], v191 offset:4096
  s_waitcnt lgkmcnt(6)
  v_mfma_f32_32x32x16_bf16 v[20:35], v[176:179], v[128:131], v[20:35]
  ds_read_b64_tr_b16 v[160:161], v192 offset:0
  ds_read_b64_tr_b16 v[162:163], v192 offset:4096
  s_add_u32 s65, s64, 7
  s_and_b32 s65, s65, 7
  s_lshl_b32 s65, s65, 11
  s_add_u32 s65, s65, s24
  buffer_load_dwordx4 v[92:95], v189, s[52:55], s65 offen offset:0
  s_waitcnt lgkmcnt(6)
  v_mfma_f32_32x32x16_bf16 v[36:51], v[180:183], v[128:131], v[36:51]
  ds_read_b64_tr_b16 v[164:165], v193 offset:0
  ds_read_b64_tr_b16 v[166:167], v193 offset:4096
  s_waitcnt lgkmcnt(6)
  v_mfma_f32_32x32x16_bf16 v[52:67], v[184:187], v[128:131], v[52:67]
  ds_read_b64_tr_b16 v[168:169], v194 offset:0
  ds_read_b64_tr_b16 v[170:171], v194 offset:4096
  buffer_load_dwordx4 v[96:99], v189, s[52:55], s65 offen offset:512
  s_waitcnt vmcnt(19) lgkmcnt(6)
  v_mfma_f32_32x32x16_bf16 v[4:19], v[156:159], v[132:135], v[4:19]
  ds_read_b64_tr_b16 v[172:173], v191 offset:2048
  ds_read_b64_tr_b16 v[174:175], v191 offset:6144
  s_waitcnt lgkmcnt(6)
  v_mfma_f32_32x32x16_bf16 v[20:35], v[160:163], v[132:135], v[20:35]
  ds_read_b64_tr_b16 v[176:177], v192 offset:2048
  ds_read_b64_tr_b16 v[178:179], v192 offset:6144
  buffer_load_dwordx4 v[100:103], v189, s[52:55], s65 offen offset:1024
  s_waitcnt lgkmcnt(6)
  v_mfma_f32_32x32x16_bf16 v[36:51], v[164:167], v[132:135], v[36:51]
  ds_read_b64_tr_b16 v[180:181], v193 offset:2048
  ds_read_b64_tr_b16 v[182:183], v193 offset:6144
  s_waitcnt lgkmcnt(6)
  v_mfma_f32_32x32x16_bf16 v[52:67], v[168:171], v[132:135], v[52:67]
  ds_read_b64_tr_b16 v[184:185], v194 offset:2048
  ds_read_b64_tr_b16 v[186:187], v194 offset:6144
  buffer_load_dwordx4 v[104:107], v189, s[52:55], s65 offen offset:1536
  s_waitcnt vmcnt(20) lgkmcnt(6)
  v_mfma_f32_32x32x16_bf16 v[4:19], v[172:175], v[136:139], v[4:19]
  ds_read_b64_tr_b16 v[156:157], v191 offset:8192
  ds_read_b64_tr_b16 v[158:159], v191 offset:12288
  s_waitcnt lgkmcnt(6)
  v_mfma_f32_32x32x16_bf16 v[20:35], v[176:179], v[136:139], v[20:35]
  ds_read_b64_tr_b16 v[160:161], v192 offset:8192
  ds_read_b64_tr_b16 v[162:163], v192 offset:12288
  s_min_u32 s19, s26, s35
  s_mov_b32 m0, s27
  s_nop 0
  buffer_load_dwordx4 v190, s[56:59], s19 offen lds
  buffer_load_dwordx4 v190, s[56:59], s19 offen offset:1024 lds
  s_add_u32 s26, s26, 16384
  s_add_u32 s27, s27, 16384
  s_cmp_eq_u32 s27, s28
  s_cselect_b32 s27, s23, s27
  s_waitcnt lgkmcnt(6)
  v_mfma_f32_32x32x16_bf16 v[36:51], v[180:183], v[136:139], v[36:51]
  ds_read_b64_tr_b16 v[164:165], v193 offset:8192
  ds_read_b64_tr_b16 v[166:167], v193 offset:12288
  s_waitcnt lgkmcnt(6)
  v_mfma_f32_32x32x16_bf16 v[52:67], v[184:187], v[136:139], v[52:67]
  ds_read_b64_tr_b16 v[168:169], v194 offset:8192
  ds_read_b64_tr_b16 v[170:171], v194 offset:12288
  s_min_u32 s19, s26, s35
  s_mov_b32 m0, s27
  s_nop 0
  buffer_load_dwordx4 v190, s[56:59], s19 offen lds
  buffer_load_dwordx4 v190, s[56:59], s19 offen offset:1024 lds
  s_add_u32 s26, s26, 16384
  s_add_u32 s27, s27, 16384
  s_cmp_eq_u32 s27, s28
  s_cselect_b32 s27, s23, s27
  s_waitcnt vmcnt(23) lgkmcnt(6)
  v_mfma_f32_32x32x16_bf16 v[4:19], v[156:159], v[140:143], v[4:19]
  ds_read_b64_tr_b16 v[172:173], v191 offset:10240
  ds_read_b64_tr_b16 v[174:175], v191 offset:14336
  s_waitcnt lgkmcnt(6)
  v_mfma_f32_32x32x16_bf16 v[20:35], v[160:163], v[140:143], v[20:35]
  ds_read_b64_tr_b16 v[176:177], v192 offset:10240
  ds_read_b64_tr_b16 v[178:179], v192 offset:14336
  s_min_u32 s19, s26, s35
  s_mov_b32 m0, s27
  s_nop 0
  buffer_load_dwordx4 v190, s[56:59], s19 offen lds
  buffer_load_dwordx4 v190, s[56:59], s19 offen offset:1024 lds
  s_add_u32 s26, s26, 16384
  s_add_u32 s27, s27, 16384
  s_cmp_eq_u32 s27, s28
  s_cselect_b32 s27, s23, s27
  s_waitcnt lgkmcnt(6)
  v_mfma_f32_32x32x16_bf16 v[36:51], v[164:167], v[140:143], v[36:51]
  ds_read_b64_tr_b16 v[180:181], v193 offset:10240
  ds_read_b64_tr_b16 v[182:183], v193 offset:14336
  s_waitcnt lgkmcnt(6)
  v_mfma_f32_32x32x16_bf16 v[52:67], v[168:171], v[140:143], v[52:67]
  ds_read_b64_tr_b16 v[184:185], v194 offset:10240
  ds_read_b64_tr_b16 v[186:187], v194 offset:14336
  s_min_u32 s19, s26, s35
  s_mov_b32 m0, s27
  s_nop 0
  buffer_load_dwordx4 v190, s[56:59], s19 offen lds
  buffer_load_dwordx4 v190, s[56:59], s19 offen offset:1024 lds
  s_add_u32 s26, s26, 16384
  s_add_u32 s27, s27, 16384
  s_cmp_eq_u32 s27, s28
  s_cselect_b32 s27, s23, s27
  s_waitcnt vmcnt(26) lgkmcnt(6)
  v_mfma_f32_32x32x16_bf16 v[4:19], v[172:175], v[144:147], v[4:19]
  s_waitcnt vmcnt(24)
  s_barrier
  ds_read_b64_tr_b16 v[156:157], v191 offset:16384
  ds_read_b64_tr_b16 v[158:159], v191 offset:20480
  s_waitcnt lgkmcnt(6)
  v_mfma_f32_32x32x16_bf16 v[20:35], v[176:179], v[144:147], v[20:35]
  ds_read_b64_tr_b16 v[160:161], v192 offset:16384
  ds_read_b64_tr_b16 v[162:163], v192 offset:20480
  s_min_u32 s19, s26, s35
  s_mov_b32 m0, s27
  s_nop 0
  buffer_load_dwordx4 v190, s[56:59], s19 offen lds
  buffer_load_dwordx4 v190, s[56:59], s19 offen offset:1024 lds
  s_add_u32 s26, s26, 16384
  s_add_u32 s27, s27, 16384
  s_cmp_eq_u32 s27, s28
  s_cselect_b32 s27, s23, s27
  s_waitcnt lgkmcnt(6)
  v_mfma_f32_32x32x16_bf16 v[36:51], v[180:183], v[144:147], v[36:51]
  ds_read_b64_tr_b16 v[164:165], v193 offset:16384
  ds_read_b64_tr_b16 v[166:167], v193 offset:20480
  s_waitcnt lgkmcnt(6)
  v_mfma_f32_32x32x16_bf16 v[52:67], v[184:187], v[144:147], v[52:67]
  ds_read_b64_tr_b16 v[168:169], v194 offset:16384
  ds_read_b64_tr_b16 v[170:171], v194 offset:20480
  s_waitcnt vmcnt(25) lgkmcnt(6)
  v_mfma_f32_32x32x16_bf16 v[4:19], v[156:159], v[148:151], v[4:19]
  ds_read_b64_tr_b16 v[172:173], v191 offset:18432
  ds_read_b64_tr_b16 v[174:175], v191 offset:22528
  s_waitcnt lgkmcnt(6)
  v_mfma_f32_32x32x16_bf16 v[20:35], v[160:163], v[148:151], v[20:35]
  ds_read_b64_tr_b16 v[176:177], v192 offset:18432
  ds_read_b64_tr_b16 v[178:179], v192 offset:22528
  s_waitcnt lgkmcnt(6)
  v_mfma_f32_32x32x16_bf16 v[36:51], v[164:167], v[148:151], v[36:51]
  ds_read_b64_tr_b16 v[180:181], v193 offset:18432
  ds_read_b64_tr_b16 v[182:183], v193 offset:22528
  s_waitcnt lgkmcnt(6)
  v_mfma_f32_32x32x16_bf16 v[52:67], v[168:171], v[148:151], v[52:67]
  ds_read_b64_tr_b16 v[184:185], v194 offset:18432
  ds_read_b64_tr_b16 v[186:187], v194 offset:22528
  s_waitcnt vmcnt(24) lgkmcnt(6)
  v_mfma_f32_32x32x16_bf16 v[4:19], v[172:175], v[152:155], v[4:19]
  ds_read_b64_tr_b16 v[156:157], v191 offset:24576
  ds_read_b64_tr_b16 v[158:159], v191 offset:28672
  s_waitcnt lgkmcnt(6)
  v_mfma_f32_32x32x16_bf16 v[20:35], v[176:179], v[152:155], v[20:35]
  ds_read_b64_tr_b16 v[160:161], v192 offset:24576
  ds_read_b64_tr_b16 v[162:163], v192 offset:28672
  s_waitcnt lgkmcnt(6)
  v_mfma_f32_32x32x16_bf16 v[36:51], v[180:183], v[152:155], v[36:51]
  ds_read_b64_tr_b16 v[164:165], v193 offset:24576
  ds_read_b64_tr_b16 v[166:167], v193 offset:28672
  s_waitcnt lgkmcnt(6)
  v_mfma_f32_32x32x16_bf16 v[52:67], v[184:187], v[152:155], v[52:67]
  ds_read_b64_tr_b16 v[168:169], v194 offset:24576
  ds_read_b64_tr_b16 v[170:171], v194 offset:28672
  s_waitcnt vmcnt(23) lgkmcnt(6)
  v_mfma_f32_32x32x16_bf16 v[4:19], v[156:159], v[68:71], v[4:19]
  ds_read_b64_tr_b16 v[172:173], v191 offset:26624
  ds_read_b64_tr_b16 v[174:175], v191 offset:30720
  s_waitcnt lgkmcnt(6)
  v_mfma_f32_32x32x16_bf16 v[20:35], v[160:163], v[68:71], v[20:35]
  ds_read_b64_tr_b16 v[176:177], v192 offset:26624
  ds_read_b64_tr_b16 v[178:179], v192 offset:30720
  s_waitcnt lgkmcnt(6)
  v_mfma_f32_32x32x16_bf16 v[36:51], v[164:167], v[68:71], v[36:51]
  ds_read_b64_tr_b16 v[180:181], v193 offset:26624
  ds_read_b64_tr_b16 v[182:183], v193 offset:30720
  s_waitcnt lgkmcnt(6)
  v_mfma_f32_32x32x16_bf16 v[52:67], v[168:171], v[68:71], v[52:67]
  ds_read_b64_tr_b16 v[184:185], v194 offset:26624
  ds_read_b64_tr_b16 v[186:187], v194 offset:30720
  s_waitcnt vmcnt(22) lgkmcnt(6)
  v_mfma_f32_32x32x16_bf16 v[4:19], v[172:175], v[72:75], v[4:19]
  s_waitcnt vmcnt(20)
  s_barrier
  ds_read_b64_tr_b16 v[156:157], v191 offset:32768
  ds_read_b64_tr_b16 v[158:159], v191 offset:36864
  s_waitcnt lgkmcnt(6)
  v_mfma_f32_32x32x16_bf16 v[20:35], v[176:179], v[72:75], v[20:35]
  ds_read_b64_tr_b16 v[160:161], v192 offset:32768
  ds_read_b64_tr_b16 v[162:163], v192 offset:36864
  s_waitcnt lgkmcnt(6)
  v_mfma_f32_32x32x16_bf16 v[36:51], v[180:183], v[72:75], v[36:51]
  ds_read_b64_tr_b16 v[164:165], v193 offset:32768
  ds_read_b64_tr_b16 v[166:167], v193 offset:36864
  s_waitcnt lgkmcnt(6)
  v_mfma_f32_32x32x16_bf16 v[52:67], v[184:187], v[72:75], v[52:67]
  ds_read_b64_tr_b16 v[168:169], v194 offset:32768
  ds_read_b64_tr_b16 v[170:171], v194 offset:36864
  s_waitcnt vmcnt(19) lgkmcnt(6)
  v_mfma_f32_32x32x16_bf16 v[4:19], v[156:159], v[76:79], v[4:19]
  ds_read_b64_tr_b16 v[172:173], v191 offset:34816
  ds_read_b64_tr_b16 v[174:175], v191 offset:38912
  s_waitcnt lgkmcnt(6)
  v_mfma_f32_32x32x16_bf16 v[20:35], v[160:163], v[76:79], v[20:35]
  ds_read_b64_tr_b16 v[176:177], v192 offset:34816
  ds_read_b64_tr_b16 v[178:179], v192 offset:38912
  s_waitcnt lgkmcnt(6)
  v_mfma_f32_32x32x16_bf16 v[36:51], v[164:167], v[76:79], v[36:51]
  ds_read_b64_tr_b16 v[180:181], v193 offset:34816
  ds_read_b64_tr_b16 v[182:183], v193 offset:38912
  s_waitcnt lgkmcnt(6)
  v_mfma_f32_32x32x16_bf16 v[52:67], v[168:171], v[76:79], v[52:67]
  ds_read_b64_tr_b16 v[184:185], v194 offset:34816
  ds_read_b64_tr_b16 v[186:187], v194 offset:38912
  s_waitcnt vmcnt(18) lgkmcnt(6)
  v_mfma_f32_32x32x16_bf16 v[4:19], v[172:175], v[80:83], v[4:19]
  ds_read_b64_tr_b16 v[156:157], v191 offset:40960
  ds_read_b64_tr_b16 v[158:159], v191 offset:45056
  s_waitcnt lgkmcnt(6)
  v_mfma_f32_32x32x16_bf16 v[20:35], v[176:179], v[80:83], v[20:35]
  ds_read_b64_tr_b16 v[160:161], v192 offset:40960
  ds_read_b64_tr_b16 v[162:163], v192 offset:45056
  s_waitcnt lgkmcnt(6)
  v_mfma_f32_32x32x16_bf16 v[36:51], v[180:183], v[80:83], v[36:51]
  ds_read_b64_tr_b16 v[164:165], v193 offset:40960
  ds_read_b64_tr_b16 v[166:167], v193 offset:45056
  s_waitcnt lgkmcnt(6)
  v_mfma_f32_32x32x16_bf16 v[52:67], v[184:187], v[80:83], v[52:67]
  ds_read_b64_tr_b16 v[168:169], v194 offset:40960
  ds_read_b64_tr_b16 v[170:171], v194 offset:45056
  s_waitcnt vmcnt(17) lgkmcnt(6)
  v_mfma_f32_32x32x16_bf16 v[4:19], v[156:159], v[84:87], v[4:19]
  ds_read_b64_tr_b16 v[172:173], v191 offset:43008
  ds_read_b64_tr_b16 v[174:175], v191 offset:47104
  s_waitcnt lgkmcnt(6)
  v_mfma_f32_32x32x16_bf16 v[20:35], v[160:163], v[84:87], v[20:35]
  ds_read_b64_tr_b16 v[176:177], v192 offset:43008
  ds_read_b64_tr_b16 v[178:179], v192 offset:47104
  s_waitcnt lgkmcnt(6)
  v_mfma_f32_32x32x16_bf16 v[36:51], v[164:167], v[84:87], v[36:51]
  ds_read_b64_tr_b16 v[180:181], v193 offset:43008
  ds_read_b64_tr_b16 v[182:183], v193 offset:47104
  s_waitcnt lgkmcnt(6)
  v_mfma_f32_32x32x16_bf16 v[52:67], v[168:171], v[84:87], v[52:67]
  ds_read_b64_tr_b16 v[184:185], v194 offset:43008
  ds_read_b64_tr_b16 v[186:187], v194 offset:47104
  s_waitcnt vmcnt(16) lgkmcnt(6)
  v_mfma_f32_32x32x16_bf16 v[4:19], v[172:175], v[88:91], v[4:19]
  s_waitcnt vmcnt(14)
  s_barrier
  ds_read_b64_tr_b16 v[156:157], v191 offset:49152
  ds_read_b64_tr_b16 v[158:159], v191 offset:53248
  s_waitcnt lgkmcnt(6)
  v_mfma_f32_32x32x16_bf16 v[20:35], v[176:179], v[88:91], v[20:35]
  ds_read_b64_tr_b16 v[160:161], v192 offset:49152
  ds_read_b64_tr_b16 v[162:163], v192 offset:53248
  s_waitcnt lgkmcnt(6)
  v_mfma_f32_32x32x16_bf16 v[36:51], v[180:183], v[88:91], v[36:51]
  ds_read_b64_tr_b16 v[164:165], v193 offset:49152
  ds_read_b64_tr_b16 v[166:167], v193 offset:53248
  s_waitcnt lgkmcnt(6)
  v_mfma_f32_32x32x16_bf16 v[52:67], v[184:187], v[88:91], v[52:67]
  ds_read_b64_tr_b16 v[168:169], v194 offset:49152
  ds_read_b64_tr_b16 v[170:171], v194 offset:53248
  s_waitcnt vmcnt(13) lgkmcnt(6)
  v_mfma_f32_32x32x16_bf16 v[4:19], v[156:159], v[92:95], v[4:19]
  ds_read_b64_tr_b16 v[172:173], v191 offset:51200
  ds_read_b64_tr_b16 v[174:175], v191 offset:55296
  s_waitcnt lgkmcnt(6)
  v_mfma_f32_32x32x16_bf16 v[20:35], v[160:163], v[92:95], v[20:35]
  ds_read_b64_tr_b16 v[176:177], v192 offset:51200
  ds_read_b64_tr_b16 v[178:179], v192 offset:55296
  s_waitcnt lgkmcnt(6)
  v_mfma_f32_32x32x16_bf16 v[36:51], v[164:167], v[92:95], v[36:51]
  ds_read_b64_tr_b16 v[180:181], v193 offset:51200
  ds_read_b64_tr_b16 v[182:183], v193 offset:55296
  s_waitcnt lgkmcnt(6)
  v_mfma_f32_32x32x16_bf16 v[52:67], v[168:171], v[92:95], v[52:67]
  ds_read_b64_tr_b16 v[184:185], v194 offset:51200
  ds_read_b64_tr_b16 v[186:187], v194 offset:55296
  s_waitcnt vmcnt(12) lgkmcnt(6)
  v_mfma_f32_32x32x16_bf16 v[4:19], v[172:175], v[96:99], v[4:19]
  ds_read_b64_tr_b16 v[156:157], v191 offset:57344
  ds_read_b64_tr_b16 v[158:159], v191 offset:61440
  s_waitcnt lgkmcnt(6)
  v_mfma_f32_32x32x16_bf16 v[20:35], v[176:179], v[96:99], v[20:35]
  ds_read_b64_tr_b16 v[160:161], v192 offset:57344
  ds_read_b64_tr_b16 v[162:163], v192 offset:61440
  s_waitcnt lgkmcnt(6)
  v_mfma_f32_32x32x16_bf16 v[36:51], v[180:183], v[96:99], v[36:51]
  ds_read_b64_tr_b16 v[164:165], v193 offset:57344
  ds_read_b64_tr_b16 v[166:167], v193 offset:61440
  s_waitcnt lgkmcnt(6)
  v_mfma_f32_32x32x16_bf16 v[52:67], v[184:187], v[96:99], v[52:67]
  ds_read_b64_tr_b16 v[168:169], v194 offset:57344
  ds_read_b64_tr_b16 v[170:171], v194 offset:61440
  s_waitcnt vmcnt(11) lgkmcnt(6)
  v_mfma_f32_32x32x16_bf16 v[4:19], v[156:159], v[100:103], v[4:19]
  ds_read_b64_tr_b16 v[172:173], v191 offset:59392
  ds_read_b64_tr_b16 v[174:175], v191 offset:63488
  s_waitcnt lgkmcnt(6)
  v_mfma_f32_32x32x16_bf16 v[20:35], v[160:163], v[100:103], v[20:35]
  ds_read_b64_tr_b16 v[176:177], v192 offset:59392
  ds_read_b64_tr_b16 v[178:179], v192 offset:63488
  s_waitcnt lgkmcnt(6)
  v_mfma_f32_32x32x16_bf16 v[36:51], v[164:167], v[100:103], v[36:51]
  ds_read_b64_tr_b16 v[180:181], v193 offset:59392
  ds_read_b64_tr_b16 v[182:183], v193 offset:63488
  s_waitcnt lgkmcnt(6)
  v_mfma_f32_32x32x16_bf16 v[52:67], v[168:171], v[100:103], v[52:67]
  ds_read_b64_tr_b16 v[184:185], v194 offset:59392
  ds_read_b64_tr_b16 v[186:187], v194 offset:63488
  s_waitcnt vmcnt(10) lgkmcnt(6)
  v_mfma_f32_32x32x16_bf16 v[4:19], v[172:175], v[104:107], v[4:19]
  s_waitcnt lgkmcnt(4)
  v_mfma_f32_32x32x16_bf16 v[20:35], v[176:179], v[104:107], v[20:35]
  s_waitcnt lgkmcnt(2)
  v_mfma_f32_32x32x16_bf16 v[36:51], v[180:183], v[104:107], v[36:51]
  s_waitcnt lgkmcnt(0)
  v_mfma_f32_32x32x16_bf16 v[52:67], v[184:187], v[104:107], v[52:67]
  s_mov_b32 s66, 0x3e0293ee
  s_mov_b32 s67, s66
  s_nop 3
  v_pk_mul_f32 v[4:5], v[4:5], s[66:67]
  v_pk_mul_f32 v[6:7], v[6:7], s[66:67]
  v_pk_mul_f32 v[8:9], v[8:9], s[66:67]
  v_pk_mul_f32 v[10:11], v[10:11], s[66:67]
  v_pk_mul_f32 v[12:13], v[12:13], s[66:67]
  v_pk_mul_f32 v[14:15], v[14:15], s[66:67]
  v_pk_mul_f32 v[16:17], v[16:17], s[66:67]
  v_pk_mul_f32 v[18:19], v[18:19], s[66:67]
  v_cvt_pk_bf16_f32 v124, v4, v5
  v_cvt_pk_bf16_f32 v125, v6, v7
  v_cvt_pk_bf16_f32 v126, v8, v9
  v_cvt_pk_bf16_f32 v127, v10, v11
  v_cvt_pk_bf16_f32 v128, v12, v13
  v_cvt_pk_bf16_f32 v129, v14, v15
  v_cvt_pk_bf16_f32 v130, v16, v17
  v_cvt_pk_bf16_f32 v131, v18, v19
  v_pk_mul_f32 v[20:21], v[20:21], s[66:67]
  v_pk_mul_f32 v[22:23], v[22:23], s[66:67]
  v_pk_mul_f32 v[24:25], v[24:25], s[66:67]
  v_pk_mul_f32 v[26:27], v[26:27], s[66:67]
  v_pk_mul_f32 v[28:29], v[28:29], s[66:67]
  v_pk_mul_f32 v[30:31], v[30:31], s[66:67]
  v_pk_mul_f32 v[32:33], v[32:33], s[66:67]
  v_pk_mul_f32 v[34:35], v[34:35], s[66:67]
  v_cvt_pk_bf16_f32 v132, v20, v21
  v_cvt_pk_bf16_f32 v133, v22, v23
  v_cvt_pk_bf16_f32 v134, v24, v25
  v_cvt_pk_bf16_f32 v135, v26, v27
  v_cvt_pk_bf16_f32 v136, v28, v29
  v_cvt_pk_bf16_f32 v137, v30, v31
  v_cvt_pk_bf16_f32 v138, v32, v33
  v_cvt_pk_bf16_f32 v139, v34, v35
  v_pk_mul_f32 v[36:37], v[36:37], s[66:67]
  v_pk_mul_f32 v[38:39], v[38:39], s[66:67]
  v_pk_mul_f32 v[40:41], v[40:41], s[66:67]
  v_pk_mul_f32 v[42:43], v[42:43], s[66:67]
  v_pk_mul_f32 v[44:45], v[44:45], s[66:67]
  v_pk_mul_f32 v[46:47], v[46:47], s[66:67]
  v_pk_mul_f32 v[48:49], v[48:49], s[66:67]
  v_pk_mul_f32 v[50:51], v[50:51], s[66:67]
  v_cvt_pk_bf16_f32 v140, v36, v37
  v_cvt_pk_bf16_f32 v141, v38, v39
  v_cvt_pk_bf16_f32 v142, v40, v41
  v_cvt_pk_bf16_f32 v143, v42, v43
  v_cvt_pk_bf16_f32 v144, v44, v45
  v_cvt_pk_bf16_f32 v145, v46, v47
  v_cvt_pk_bf16_f32 v146, v48, v49
  v_cvt_pk_bf16_f32 v147, v50, v51
  v_pk_mul_f32 v[52:53], v[52:53], s[66:67]
  v_pk_mul_f32 v[54:55], v[54:55], s[66:67]
  v_pk_mul_f32 v[56:57], v[56:57], s[66:67]
  v_pk_mul_f32 v[58:59], v[58:59], s[66:67]
  v_pk_mul_f32 v[60:61], v[60:61], s[66:67]
  v_pk_mul_f32 v[62:63], v[62:63], s[66:67]
  v_pk_mul_f32 v[64:65], v[64:65], s[66:67]
  v_pk_mul_f32 v[66:67], v[66:67], s[66:67]
  v_cvt_pk_bf16_f32 v148, v52, v53
  v_cvt_pk_bf16_f32 v149, v54, v55
  v_cvt_pk_bf16_f32 v150, v56, v57
  v_cvt_pk_bf16_f32 v151, v58, v59
  v_cvt_pk_bf16_f32 v152, v60, v61
  v_cvt_pk_bf16_f32 v153, v62, v63
  v_cvt_pk_bf16_f32 v154, v64, v65
  v_cvt_pk_bf16_f32 v155, v66, v67
  v_pk_mov_b32 v[4:5], v[204:205], v[204:205]
  v_pk_mov_b32 v[6:7], v[204:205], v[204:205]
  v_pk_mov_b32 v[8:9], v[204:205], v[204:205]
  v_pk_mov_b32 v[10:11], v[204:205], v[204:205]
  v_pk_mov_b32 v[12:13], v[204:205], v[204:205]
  v_pk_mov_b32 v[14:15], v[204:205], v[204:205]
  v_pk_mov_b32 v[16:17], v[204:205], v[204:205]
  v_pk_mov_b32 v[18:19], v[204:205], v[204:205]
  v_pk_mov_b32 v[20:21], v[204:205], v[204:205]
  v_pk_mov_b32 v[22:23], v[204:205], v[204:205]
  v_pk_mov_b32 v[24:25], v[204:205], v[204:205]
  v_pk_mov_b32 v[26:27], v[204:205], v[204:205]
  v_pk_mov_b32 v[28:29], v[204:205], v[204:205]
  v_pk_mov_b32 v[30:31], v[204:205], v[204:205]
  v_pk_mov_b32 v[32:33], v[204:205], v[204:205]
  v_pk_mov_b32 v[34:35], v[204:205], v[204:205]
  v_pk_mov_b32 v[36:37], v[204:205], v[204:205]
  v_pk_mov_b32 v[38:39], v[204:205], v[204:205]
  v_pk_mov_b32 v[40:41], v[204:205], v[204:205]
  v_pk_mov_b32 v[42:43], v[204:205], v[204:205]
  v_pk_mov_b32 v[44:45], v[204:205], v[204:205]
  v_pk_mov_b32 v[46:47], v[204:205], v[204:205]
  v_pk_mov_b32 v[48:49], v[204:205], v[204:205]
  v_pk_mov_b32 v[50:51], v[204:205], v[204:205]
  v_pk_mov_b32 v[52:53], v[204:205], v[204:205]
  v_pk_mov_b32 v[54:55], v[204:205], v[204:205]
  v_pk_mov_b32 v[56:57], v[204:205], v[204:205]
  v_pk_mov_b32 v[58:59], v[204:205], v[204:205]
  v_pk_mov_b32 v[60:61], v[204:205], v[204:205]
  v_pk_mov_b32 v[62:63], v[204:205], v[204:205]
  v_pk_mov_b32 v[64:65], v[204:205], v[204:205]
  v_pk_mov_b32 v[66:67], v[204:205], v[204:205]
  v_mov_b32 v197, 0
  v_mov_b32 v198, 0
  v_lshrrev_b32 v2, 4, v1
  v_bfe_u32 v3, v1, 1, 3
  v_xor_b32 v3, v3, v2
  v_lshlrev_b32 v3, 5, v3
  v_and_b32 v208, 1, v1
  v_lshl_add_u32 v3, v208, 4, v3
  s_mov_b32 s19, 3584
  v_mad_u32_u24 v207, v2, s19, v3
  v_xor_b32 v3, 128, v3
  v_mad_u32_u24 v208, v2, s19, v3
  v_add_u32 v208, 13312, v208
  s_mov_b32 s17, 0
  s_waitcnt vmcnt(0)
  s_barrier
  s_min_u32 s19, s26, s35
  s_mov_b32 m0, s27
  s_nop 0
  buffer_load_dwordx4 v190, s[56:59], s19 offen lds
  buffer_load_dwordx4 v190, s[56:59], s19 offen offset:1024 lds
  s_add_u32 s26, s26, 16384
  s_add_u32 s27, s27, 16384
  s_cmp_eq_u32 s27, s28
  s_cselect_b32 s27, s23, s27
  s_min_u32 s19, s26, s35
  s_mov_b32 m0, s27
  s_nop 0
  buffer_load_dwordx4 v190, s[56:59], s19 offen lds
  buffer_load_dwordx4 v190, s[56:59], s19 offen offset:1024 lds
  s_add_u32 s26, s26, 16384
  s_add_u32 s27, s27, 16384
  s_cmp_eq_u32 s27, s28
  s_cselect_b32 s27, s23, s27
  s_min_u32 s19, s26, s35
  s_mov_b32 m0, s27
  s_nop 0
  buffer_load_dwordx4 v190, s[56:59], s19 offen lds
  buffer_load_dwordx4 v190, s[56:59], s19 offen offset:1024 lds
  s_add_u32 s26, s26, 16384
  s_add_u32 s27, s27, 16384
  s_cmp_eq_u32 s27, s28
  s_cselect_b32 s27, s23, s27
  s_min_u32 s19, s26, s35
  s_mov_b32 m0, s27
  s_nop 0
  buffer_load_dwordx4 v190, s[56:59], s19 offen lds
  buffer_load_dwordx4 v190, s[56:59], s19 offen offset:1024 lds
  s_add_u32 s26, s26, 16384
  s_add_u32 s27, s27, 16384
  s_cmp_eq_u32 s27, s28
  s_cselect_b32 s27, s23, s27
  v_add_u32 v195, 131072, v190
  v_add_u32 v196, 114688, v190
  ds_read_b128 v[156:159], v195 offset:0
  ds_read_b128 v[160:163], v195 offset:1024
  ds_read_b128 v[164:167], v195 offset:2048
  ds_read_b128 v[168:171], v195 offset:3072
  ds_read_b128 v[172:175], v195 offset:4096
  ds_read_b128 v[176:179], v195 offset:5120
  ds_read_b128 v[180:183], v195 offset:6144
  ds_read_b128 v[184:187], v195 offset:7168
  s_waitcnt lgkmcnt(7)
  v_mfma_f32_32x32x16_bf16 v[68:83], v[156:159], v[124:127], 0
  s_waitcnt lgkmcnt(6)
  v_mfma_f32_32x32x16_bf16 v[68:83], v[160:163], v[128:131], v[68:83]
  s_waitcnt lgkmcnt(5)
  v_mfma_f32_32x32x16_bf16 v[68:83], v[164:167], v[132:135], v[68:83]
  s_waitcnt lgkmcnt(4)
  v_mfma_f32_32x32x16_bf16 v[68:83], v[168:171], v[136:139], v[68:83]
  s_waitcnt lgkmcnt(3)
  v_mfma_f32_32x32x16_bf16 v[68:83], v[172:175], v[140:143], v[68:83]
  s_waitcnt lgkmcnt(2)
  v_mfma_f32_32x32x16_bf16 v[68:83], v[176:179], v[144:147], v[68:83]
  s_waitcnt lgkmcnt(1)
  v_mfma_f32_32x32x16_bf16 v[68:83], v[180:183], v[148:151], v[68:83]
  s_waitcnt lgkmcnt(0)
  v_mfma_f32_32x32x16_bf16 v[68:83], v[184:187], v[152:155], v[68:83]
  s_cmp_lg_u32 s13, 0
  s_cbranch_scc1 at_kernel_nomask0
  v_cmp_le_i32 vcc, 0, v200
  s_nop 8
  v_cndmask_b32 v68, v201, v68, vcc
  v_cmp_le_i32 vcc, 1, v200
  s_nop 1
  v_cndmask_b32 v69, v201, v69, vcc
  v_cmp_le_i32 vcc, 2, v200
  s_nop 1
  v_cndmask_b32 v70, v201, v70, vcc
  v_cmp_le_i32 vcc, 3, v200
  s_nop 1
  v_cndmask_b32 v71, v201, v71, vcc
  v_cmp_le_i32 vcc, 8, v200
  s_nop 1
  v_cndmask_b32 v72, v201, v72, vcc
  v_cmp_le_i32 vcc, 9, v200
  s_nop 1
  v_cndmask_b32 v73, v201, v73, vcc
  v_cmp_le_i32 vcc, 10, v200
  s_nop 1
  v_cndmask_b32 v74, v201, v74, vcc
  v_cmp_le_i32 vcc, 11, v200
  s_nop 1
  v_cndmask_b32 v75, v201, v75, vcc
  v_cmp_le_i32 vcc, 16, v200
  s_nop 1
  v_cndmask_b32 v76, v201, v76, vcc
  v_cmp_le_i32 vcc, 17, v200
  s_nop 1
  v_cndmask_b32 v77, v201, v77, vcc
  v_cmp_le_i32 vcc, 18, v200
  s_nop 1
  v_cndmask_b32 v78, v201, v78, vcc
  v_cmp_le_i32 vcc, 19, v200
  s_nop 1
  v_cndmask_b32 v79, v201, v79, vcc
  v_cmp_le_i32 vcc, 24, v200
  s_nop 1
  v_cndmask_b32 v80, v201, v80, vcc
  v_cmp_le_i32 vcc, 25, v200
  s_nop 1
  v_cndmask_b32 v81, v201, v81, vcc
  v_cmp_le_i32 vcc, 26, v200
  s_nop 1
  v_cndmask_b32 v82, v201, v82, vcc
  v_cmp_le_i32 vcc, 27, v200
  s_nop 1
  v_cndmask_b32 v83, v201, v83, vcc
at_kernel_nomask0:
  s_nop 9
  v_max3_f32 v199, v68, v69, v70
  v_max3_f32 v199, v199, v71, v72
  v_max3_f32 v199, v199, v73, v74
  v_max3_f32 v199, v199, v75, v76
  v_max3_f32 v199, v199, v77, v78
  v_max3_f32 v199, v199, v79, v80
  v_max3_f32 v199, v199, v81, v82
  v_max_f32 v199, v199, v83
  v_mov_b32 v2, v199
  s_nop 1
  v_permlane32_swap_b32 v2, v199
  v_max_f32 v199, v199, v2
  v_sub_f32 v68, v68, v199
  v_sub_f32 v69, v69, v199
  v_sub_f32 v70, v70, v199
  v_sub_f32 v71, v71, v199
  v_sub_f32 v72, v72, v199
  v_sub_f32 v73, v73, v199
  v_sub_f32 v74, v74, v199
  v_sub_f32 v75, v75, v199
  v_sub_f32 v76, v76, v199
  v_sub_f32 v77, v77, v199
  v_sub_f32 v78, v78, v199
  v_sub_f32 v79, v79, v199
  v_sub_f32 v80, v80, v199
  v_sub_f32 v81, v81, v199
  v_sub_f32 v82, v82, v199
  v_sub_f32 v83, v83, v199
  v_sub_f32 v100, 0, v199
  v_mov_b32 v101, v100
  v_mov_b32 v102, v100
  v_mov_b32 v103, v100
  v_mov_b32 v104, v100
  v_mov_b32 v105, v100
  v_mov_b32 v106, v100
  v_mov_b32 v107, v100
  v_mov_b32 v108, v100
  v_mov_b32 v109, v100
  v_mov_b32 v110, v100
  v_mov_b32 v111, v100
  v_mov_b32 v112, v100
  v_mov_b32 v113, v100
  v_mov_b32 v114, v100
  v_mov_b32 v115, v100
  v_add_u32 v196, 0x8000, v196
  v_subrev_u32 v2, 0x28000, v196
  v_min_u32 v196, v196, v2
  ds_read_b128 v[156:159], v196 offset:0
  ds_read_b128 v[160:163], v196 offset:1024
  ds_read_b128 v[164:167], v196 offset:2048
  ds_read_b128 v[168:171], v196 offset:3072
  ds_read_b128 v[172:175], v196 offset:4096
  ds_read_b128 v[176:179], v196 offset:5120
  s_cmp_eq_u32 s13, 0
  s_cbranch_scc1 at_kernel_tail0
  s_cmp_eq_u32 s29, 0
  s_cbranch_scc1 at_kernel_last1
  s_branch at_kernel_sub1
at_kernel_dtop:
  v_mfma_f32_32x32x16_bf16 v[52:67], v[184:187], v[120:123], v[52:67]
  ds_read_b128 v[176:179], v195 offset:5120
  s_waitcnt vmcnt(0)
  s_barrier
  s_waitcnt lgkmcnt(4)
  v_mfma_f32_32x32x16_bf16 v[68:83], v[156:159], v[124:127], v[100:115]
  ds_read_b128 v[180:183], v195 offset:6144
  v_exp_f32 v84, v84
  v_exp_f32 v85, v85
  s_min_u32 s19, s26, s35
  s_mov_b32 m0, s27
  s_nop 0
  buffer_load_dwordx4 v190, s[56:59], s19 offen lds
  v_mfma_f32_32x32x16_bf16 v[68:83], v[160:163], v[128:131], v[68:83]
  ds_read_b128 v[184:187], v195 offset:7168
  v_exp_f32 v86, v86
  v_exp_f32 v87, v87
  buffer_load_dwordx4 v190, s[56:59], s19 offen offset:1024 lds
  s_waitcnt lgkmcnt(4)
  v_mfma_f32_32x32x16_bf16 v[68:83], v[164:167], v[132:135], v[68:83]
  ds_read_b128 v[156:159], v196 offset:8192
  v_exp_f32 v88, v88
  v_exp_f32 v89, v89
  s_add_u32 s26, s26, 16384
  s_add_u32 s27, s27, 16384
  v_mfma_f32_32x32x16_bf16 v[68:83], v[168:171], v[136:139], v[68:83]
  ds_read_b128 v[160:163], v196 offset:10240
  v_exp_f32 v90, v90
  v_exp_f32 v91, v91
  s_cmp_eq_u32 s27, s28
  s_cselect_b32 s27, s23, s27
  s_waitcnt lgkmcnt(4)
  v_mfma_f32_32x32x16_bf16 v[68:83], v[172:175], v[140:143], v[68:83]
  ds_read_b128 v[164:167], v196 offset:12288
  v_cvt_pk_bf16_f32 v116, v84, v85
  v_cvt_pk_bf16_f32 v117, v86, v87
  v_exp_f32 v92, v92
  s_min_u32 s19, s26, s35
  s_mov_b32 m0, s27
  s_nop 0
  buffer_load_dwordx4 v190, s[56:59], s19 offen lds
  v_mfma_f32_32x32x16_bf16 v[68:83], v[176:179], v[144:147], v[68:83]
  ds_read_b128 v[168:171], v196 offset:14336
  v_cvt_pk_bf16_f32 v118, v88, v89
  v_cvt_pk_bf16_f32 v119, v90, v91
  v_exp_f32 v93, v93
  buffer_load_dwordx4 v190, s[56:59], s19 offen offset:1024 lds
  s_waitcnt lgkmcnt(4)
  v_mfma_f32_32x32x16_bf16 v[68:83], v[180:183], v[148:151], v[68:83]
  ds_read_b128 v[172:175], v196 offset:9216
  v_exp_f32 v94, v94
  v_exp_f32 v95, v95
  s_add_u32 s26, s26, 16384
  s_add_u32 s27, s27, 16384
  v_mfma_f32_32x32x16_bf16 v[68:83], v[184:187], v[152:155], v[68:83]
  ds_read_b128 v[176:179], v196 offset:11264
  v_exp_f32 v96, v96
  v_exp_f32 v97, v97
  s_cmp_eq_u32 s27, s28
  s_cselect_b32 s27, s23, s27
  s_waitcnt lgkmcnt(4)
  v_mfma_f32_32x32x16_bf16 v[4:19], v[156:159], v[116:119], v[4:19]
  ds_read_b128 v[180:183], v196 offset:13312
  v_exp_f32 v98, v98
  v_exp_f32 v99, v99
  s_min_u32 s19, s26, s35
  s_mov_b32 m0, s27
  s_nop 0
  buffer_load_dwordx4 v190, s[56:59], s19 offen lds
  v_mfma_f32_32x32x16_bf16 v[20:35], v[160:163], v[116:119], v[20:35]
  ds_read_b128 v[184:187], v196 offset:15360
  v_cvt_pk_bf16_f32 v120, v92, v93
  v_cvt_pk_bf16_f32 v121, v94, v95
  v_add_f32 v197, v197, v84
  v_add_f32 v198, v198, v85
  buffer_load_dwordx4 v190, s[56:59], s19 offen offset:1024 lds
  s_waitcnt lgkmcnt(4)
  v_mfma_f32_32x32x16_bf16 v[36:51], v[164:167], v[116:119], v[36:51]
  v_add_u32 v196, 0x8000, v196
  v_subrev_u32 v2, 0x28000, v196
  v_min_u32 v196, v196, v2
  ds_read_b128 v[156:159], v196 offset:0
  v_cvt_pk_bf16_f32 v122, v96, v97
  v_cvt_pk_bf16_f32 v123, v98, v99
  s_add_u32 s26, s26, 16384
  s_add_u32 s27, s27, 16384
  v_mfma_f32_32x32x16_bf16 v[52:67], v[168:171], v[116:119], v[52:67]
  ds_read_b128 v[160:163], v196 offset:1024
  v_add_f32 v197, v197, v86
  v_add_f32 v198, v198, v87
  v_add_f32 v197, v197, v88
  v_add_f32 v198, v198, v89
  s_cmp_eq_u32 s27, s28
  s_cselect_b32 s27, s23, s27
  s_waitcnt lgkmcnt(4)
  v_mfma_f32_32x32x16_bf16 v[4:19], v[172:175], v[120:123], v[4:19]
  ds_read_b128 v[164:167], v196 offset:2048
  v_add_f32 v197, v197, v90
  v_add_f32 v198, v198, v91
  v_add_f32 v197, v197, v92
  v_add_f32 v198, v198, v93
  s_min_u32 s19, s26, s35
  s_mov_b32 m0, s27
  s_nop 0
  buffer_load_dwordx4 v190, s[56:59], s19 offen lds
  v_mfma_f32_32x32x16_bf16 v[20:35], v[176:179], v[120:123], v[20:35]
  ds_read_b128 v[168:171], v196 offset:3072
  v_add_f32 v197, v197, v94
  v_add_f32 v198, v198, v95
  v_add_f32 v197, v197, v96
  v_add_f32 v198, v198, v97
  buffer_load_dwordx4 v190, s[56:59], s19 offen offset:1024 lds
  s_waitcnt lgkmcnt(4)
  v_mfma_f32_32x32x16_bf16 v[36:51], v[180:183], v[120:123], v[36:51]
  ds_read_b128 v[172:175], v196 offset:4096
  v_add_f32 v197, v197, v98
  v_add_f32 v198, v198, v99
  s_add_u32 s26, s26, 16384
  s_add_u32 s27, s27, 16384
  v_mfma_f32_32x32x16_bf16 v[52:67], v[184:187], v[120:123], v[52:67]
  ds_read_b128 v[176:179], v196 offset:5120
  s_cmp_eq_u32 s27, s28
  s_cselect_b32 s27, s23, s27
  s_branch at_kernel_sub1
at_kernel_atop:
  v_mfma_f32_32x32x16_bf16 v[52:67], v[184:187], v[120:123], v[52:67]
  ds_read_b128 v[176:179], v195 offset:5120
  s_waitcnt vmcnt(0)
  s_barrier
  s_waitcnt lgkmcnt(4)
  v_mfma_f32_32x32x16_bf16 v[68:83], v[156:159], v[124:127], v[100:115]
  ds_read_b128 v[180:183], v195 offset:6144
  v_exp_f32 v84, v84
  v_exp_f32 v85, v85
  v_mfma_f32_32x32x16_bf16 v[68:83], v[160:163], v[128:131], v[68:83]
  ds_read_b128 v[184:187], v195 offset:7168
  v_exp_f32 v86, v86
  v_exp_f32 v87, v87
  s_waitcnt lgkmcnt(4)
  v_mfma_f32_32x32x16_bf16 v[68:83], v[164:167], v[132:135], v[68:83]
  ds_read_b128 v[156:159], v196 offset:8192
  v_exp_f32 v88, v88
  v_exp_f32 v89, v89
  v_mfma_f32_32x32x16_bf16 v[68:83], v[168:171], v[136:139], v[68:83]
  ds_read_b128 v[160:163], v196 offset:10240
  v_exp_f32 v90, v90
  v_exp_f32 v91, v91
  s_waitcnt lgkmcnt(4)
  v_mfma_f32_32x32x16_bf16 v[68:83], v[172:175], v[140:143], v[68:83]
  ds_read_b128 v[164:167], v196 offset:12288
  v_cvt_pk_bf16_f32 v116, v84, v85
  v_cvt_pk_bf16_f32 v117, v86, v87
  v_exp_f32 v92, v92
  v_mfma_f32_32x32x16_bf16 v[68:83], v[176:179], v[144:147], v[68:83]
  ds_read_b128 v[168:171], v196 offset:14336
  v_cvt_pk_bf16_f32 v118, v88, v89
  v_cvt_pk_bf16_f32 v119, v90, v91
  v_exp_f32 v93, v93
  s_waitcnt lgkmcnt(4)
  v_mfma_f32_32x32x16_bf16 v[68:83], v[180:183], v[148:151], v[68:83]
  ds_read_b128 v[172:175], v196 offset:9216
  v_exp_f32 v94, v94
  v_exp_f32 v95, v95
  v_mfma_f32_32x32x16_bf16 v[68:83], v[184:187], v[152:155], v[68:83]
  ds_read_b128 v[176:179], v196 offset:11264
  v_exp_f32 v96, v96
  v_exp_f32 v97, v97
  s_waitcnt lgkmcnt(4)
  v_mfma_f32_32x32x16_bf16 v[4:19], v[156:159], v[116:119], v[4:19]
  ds_read_b128 v[180:183], v196 offset:13312
  v_exp_f32 v98, v98
  v_exp_f32 v99, v99
  v_mfma_f32_32x32x16_bf16 v[20:35], v[160:163], v[116:119], v[20:35]
  ds_read_b128 v[184:187], v196 offset:15360
  v_cvt_pk_bf16_f32 v120, v92, v93
  v_cvt_pk_bf16_f32 v121, v94, v95
  v_add_f32 v197, v197, v84
  v_add_f32 v198, v198, v85
  s_waitcnt lgkmcnt(4)
  v_mfma_f32_32x32x16_bf16 v[36:51], v[164:167], v[116:119], v[36:51]
  v_add_u32 v196, 0x8000, v196
  v_subrev_u32 v2, 0x28000, v196
  v_min_u32 v196, v196, v2
  ds_read_b128 v[156:159], v196 offset:0
  v_cvt_pk_bf16_f32 v122, v96, v97
  v_cvt_pk_bf16_f32 v123, v98, v99
  v_mfma_f32_32x32x16_bf16 v[52:67], v[168:171], v[116:119], v[52:67]
  ds_read_b128 v[160:163], v196 offset:1024
  v_add_f32 v197, v197, v86
  v_add_f32 v198, v198, v87
  v_add_f32 v197, v197, v88
  v_add_f32 v198, v198, v89
  s_waitcnt lgkmcnt(4)
  v_mfma_f32_32x32x16_bf16 v[4:19], v[172:175], v[120:123], v[4:19]
  ds_read_b128 v[164:167], v196 offset:2048
  v_add_f32 v197, v197, v90
  v_add_f32 v198, v198, v91
  v_add_f32 v197, v197, v92
  v_add_f32 v198, v198, v93
  v_mfma_f32_32x32x16_bf16 v[20:35], v[176:179], v[120:123], v[20:35]
  ds_read_b128 v[168:171], v196 offset:3072
  v_add_f32 v197, v197, v94
  v_add_f32 v198, v198, v95
  v_add_f32 v197, v197, v96
  v_add_f32 v198, v198, v97
  s_waitcnt lgkmcnt(4)
  v_mfma_f32_32x32x16_bf16 v[36:51], v[180:183], v[120:123], v[36:51]
  ds_read_b128 v[172:175], v196 offset:4096
  v_add_f32 v197, v197, v98
  v_add_f32 v198, v198, v99
  v_mfma_f32_32x32x16_bf16 v[52:67], v[184:187], v[120:123], v[52:67]
  ds_read_b128 v[176:179], v196 offset:5120
at_kernel_sub1:
  s_waitcnt lgkmcnt(4)
  v_mfma_f32_32x32x16_bf16 v[84:99], v[156:159], v[124:127], v[100:115]
  ds_read_b128 v[180:183], v196 offset:6144
  v_exp_f32 v68, v68
  v_exp_f32 v69, v69
  v_mfma_f32_32x32x16_bf16 v[84:99], v[160:163], v[128:131], v[84:99]
  ds_read_b128 v[184:187], v196 offset:7168
  v_exp_f32 v70, v70
  v_exp_f32 v71, v71
  s_waitcnt lgkmcnt(4)
  v_mfma_f32_32x32x16_bf16 v[84:99], v[164:167], v[132:135], v[84:99]
  ds_read_b128 v[156:159], v195 offset:8192
  v_exp_f32 v72, v72
  v_exp_f32 v73, v73
  v_mfma_f32_32x32x16_bf16 v[84:99], v[168:171], v[136:139], v[84:99]
  ds_read_b128 v[160:163], v195 offset:10240
  v_exp_f32 v74, v74
  v_exp_f32 v75, v75
  s_waitcnt lgkmcnt(4)
  v_mfma_f32_32x32x16_bf16 v[84:99], v[172:175], v[140:143], v[84:99]
  ds_read_b128 v[164:167], v195 offset:12288
  v_cvt_pk_bf16_f32 v116, v68, v69
  v_cvt_pk_bf16_f32 v117, v70, v71
  v_exp_f32 v76, v76
  v_mfma_f32_32x32x16_bf16 v[84:99], v[176:179], v[144:147], v[84:99]
  ds_read_b128 v[168:171], v195 offset:14336
  v_cvt_pk_bf16_f32 v118, v72, v73
  v_cvt_pk_bf16_f32 v119, v74, v75
  v_exp_f32 v77, v77
  s_waitcnt lgkmcnt(4)
  v_mfma_f32_32x32x16_bf16 v[84:99], v[180:183], v[148:151], v[84:99]
  ds_read_b128 v[172:175], v195 offset:9216
  v_exp_f32 v78, v78
  v_exp_f32 v79, v79
  v_mfma_f32_32x32x16_bf16 v[84:99], v[184:187], v[152:155], v[84:99]
  ds_read_b128 v[176:179], v195 offset:11264
  v_exp_f32 v80, v80
  v_exp_f32 v81, v81
  s_waitcnt lgkmcnt(4)
  v_mfma_f32_32x32x16_bf16 v[4:19], v[156:159], v[116:119], v[4:19]
  ds_read_b128 v[180:183], v195 offset:13312
  v_exp_f32 v82, v82
  v_exp_f32 v83, v83
  v_mfma_f32_32x32x16_bf16 v[20:35], v[160:163], v[116:119], v[20:35]
  ds_read_b128 v[184:187], v195 offset:15360
  v_cvt_pk_bf16_f32 v120, v76, v77
  v_cvt_pk_bf16_f32 v121, v78, v79
  v_add_f32 v197, v197, v68
  v_add_f32 v198, v198, v69
  s_waitcnt lgkmcnt(4)
  v_mfma_f32_32x32x16_bf16 v[36:51], v[164:167], v[116:119], v[36:51]
  v_add_u32 v195, 0x8000, v195
  v_subrev_u32 v2, 0x28000, v195
  v_min_u32 v195, v195, v2
  ds_read_b128 v[156:159], v195 offset:0
  v_cvt_pk_bf16_f32 v122, v80, v81
  v_cvt_pk_bf16_f32 v123, v82, v83
  v_mfma_f32_32x32x16_bf16 v[52:67], v[168:171], v[116:119], v[52:67]
  ds_read_b128 v[160:163], v195 offset:1024
  v_add_f32 v197, v197, v70
  v_add_f32 v198, v198, v71
  v_add_f32 v197, v197, v72
  v_add_f32 v198, v198, v73
  s_waitcnt lgkmcnt(4)
  v_mfma_f32_32x32x16_bf16 v[4:19], v[172:175], v[120:123], v[4:19]
  ds_read_b128 v[164:167], v195 offset:2048
  v_add_f32 v197, v197, v74
  v_add_f32 v198, v198, v75
  v_add_f32 v197, v197, v76
  v_add_f32 v198, v198, v77
  v_mfma_f32_32x32x16_bf16 v[20:35], v[176:179], v[120:123], v[20:35]
  ds_read_b128 v[168:171], v195 offset:3072
  v_add_f32 v197, v197, v78
  v_add_f32 v198, v198, v79
  v_add_f32 v197, v197, v80
  v_add_f32 v198, v198, v81
  s_waitcnt lgkmcnt(4)
  v_mfma_f32_32x32x16_bf16 v[36:51], v[180:183], v[120:123], v[36:51]
  ds_read_b128 v[172:175], v195 offset:4096
  v_add_f32 v197, v197, v82
  v_add_f32 v198, v198, v83
  v_mfma_f32_32x32x16_bf16 v[52:67], v[184:187], v[120:123], v[52:67]
  ds_read_b128 v[176:179], v195 offset:5120
  s_waitcnt lgkmcnt(4)
  v_mfma_f32_32x32x16_bf16 v[68:83], v[156:159], v[124:127], v[100:115]
  ds_read_b128 v[180:183], v195 offset:6144
  v_exp_f32 v84, v84
  v_exp_f32 v85, v85
  v_mfma_f32_32x32x16_bf16 v[68:83], v[160:163], v[128:131], v[68:83]
  ds_read_b128 v[184:187], v195 offset:7168
  v_exp_f32 v86, v86
  v_exp_f32 v87, v87
  s_waitcnt lgkmcnt(4)
  v_mfma_f32_32x32x16_bf16 v[68:83], v[164:167], v[132:135], v[68:83]
  ds_read_b128 v[156:159], v196 offset:8192
  v_exp_f32 v88, v88
  v_exp_f32 v89, v89
  v_mfma_f32_32x32x16_bf16 v[68:83], v[168:171], v[136:139], v[68:83]
  ds_read_b128 v[160:163], v196 offset:10240
  v_exp_f32 v90, v90
  v_exp_f32 v91, v91
  s_waitcnt lgkmcnt(4)
  v_mfma_f32_32x32x16_bf16 v[68:83], v[172:175], v[140:143], v[68:83]
  ds_read_b128 v[164:167], v196 offset:12288
  v_cvt_pk_bf16_f32 v116, v84, v85
  v_cvt_pk_bf16_f32 v117, v86, v87
  v_exp_f32 v92, v92
  v_mfma_f32_32x32x16_bf16 v[68:83], v[176:179], v[144:147], v[68:83]
  ds_read_b128 v[168:171], v196 offset:14336
  v_cvt_pk_bf16_f32 v118, v88, v89
  v_cvt_pk_bf16_f32 v119, v90, v91
  v_exp_f32 v93, v93
  s_waitcnt lgkmcnt(4)
  v_mfma_f32_32x32x16_bf16 v[68:83], v[180:183], v[148:151], v[68:83]
  ds_read_b128 v[172:175], v196 offset:9216
  v_exp_f32 v94, v94
  v_exp_f32 v95, v95
  v_mfma_f32_32x32x16_bf16 v[68:83], v[184:187], v[152:155], v[68:83]
  ds_read_b128 v[176:179], v196 offset:11264
  v_exp_f32 v96, v96
  v_exp_f32 v97, v97
  s_waitcnt lgkmcnt(4)
  v_mfma_f32_32x32x16_bf16 v[4:19], v[156:159], v[116:119], v[4:19]
  ds_read_b128 v[180:183], v196 offset:13312
  v_exp_f32 v98, v98
  v_exp_f32 v99, v99
  v_mfma_f32_32x32x16_bf16 v[20:35], v[160:163], v[116:119], v[20:35]
  ds_read_b128 v[184:187], v196 offset:15360
  v_cvt_pk_bf16_f32 v120, v92, v93
  v_cvt_pk_bf16_f32 v121, v94, v95
  v_add_f32 v197, v197, v84
  v_add_f32 v198, v198, v85
  s_waitcnt lgkmcnt(4)
  v_mfma_f32_32x32x16_bf16 v[36:51], v[164:167], v[116:119], v[36:51]
  v_add_u32 v196, 0x8000, v196
  v_subrev_u32 v2, 0x28000, v196
  v_min_u32 v196, v196, v2
  ds_read_b128 v[156:159], v196 offset:0
  v_cvt_pk_bf16_f32 v122, v96, v97
  v_cvt_pk_bf16_f32 v123, v98, v99
  v_mfma_f32_32x32x16_bf16 v[52:67], v[168:171], v[116:119], v[52:67]
  ds_read_b128 v[160:163], v196 offset:1024
  v_add_f32 v197, v197, v86
  v_add_f32 v198, v198, v87
  v_add_f32 v197, v197, v88
  v_add_f32 v198, v198, v89
  s_waitcnt lgkmcnt(4)
  v_mfma_f32_32x32x16_bf16 v[4:19], v[172:175], v[120:123], v[4:19]
  ds_read_b128 v[164:167], v196 offset:2048
  v_add_f32 v197, v197, v90
  v_add_f32 v198, v198, v91
  v_add_f32 v197, v197, v92
  v_add_f32 v198, v198, v93
  v_mfma_f32_32x32x16_bf16 v[20:35], v[176:179], v[120:123], v[20:35]
  ds_read_b128 v[168:171], v196 offset:3072
  v_add_f32 v197, v197, v94
  v_add_f32 v198, v198, v95
  v_add_f32 v197, v197, v96
  v_add_f32 v198, v198, v97
  s_waitcnt lgkmcnt(4)
  v_mfma_f32_32x32x16_bf16 v[36:51], v[180:183], v[120:123], v[36:51]
  ds_read_b128 v[172:175], v196 offset:4096
  v_add_f32 v197, v197, v98
  v_add_f32 v198, v198, v99
  v_mfma_f32_32x32x16_bf16 v[52:67], v[184:187], v[120:123], v[52:67]
  ds_read_b128 v[176:179], v196 offset:5120
  s_waitcnt lgkmcnt(4)
  v_mfma_f32_32x32x16_bf16 v[84:99], v[156:159], v[124:127], v[100:115]
  ds_read_b128 v[180:183], v196 offset:6144
  v_exp_f32 v68, v68
  v_exp_f32 v69, v69
  v_mfma_f32_32x32x16_bf16 v[84:99], v[160:163], v[128:131], v[84:99]
  ds_read_b128 v[184:187], v196 offset:7168
  v_exp_f32 v70, v70
  v_exp_f32 v71, v71
  s_waitcnt lgkmcnt(4)
  v_mfma_f32_32x32x16_bf16 v[84:99], v[164:167], v[132:135], v[84:99]
  ds_read_b128 v[156:159], v195 offset:8192
  v_exp_f32 v72, v72
  v_exp_f32 v73, v73
  v_mfma_f32_32x32x16_bf16 v[84:99], v[168:171], v[136:139], v[84:99]
  ds_read_b128 v[160:163], v195 offset:10240
  v_exp_f32 v74, v74
  v_exp_f32 v75, v75
  s_waitcnt lgkmcnt(4)
  v_mfma_f32_32x32x16_bf16 v[84:99], v[172:175], v[140:143], v[84:99]
  ds_read_b128 v[164:167], v195 offset:12288
  v_cvt_pk_bf16_f32 v116, v68, v69
  v_cvt_pk_bf16_f32 v117, v70, v71
  v_exp_f32 v76, v76
  v_mfma_f32_32x32x16_bf16 v[84:99], v[176:179], v[144:147], v[84:99]
  ds_read_b128 v[168:171], v195 offset:14336
  v_cvt_pk_bf16_f32 v118, v72, v73
  v_cvt_pk_bf16_f32 v119, v74, v75
  v_exp_f32 v77, v77
  s_waitcnt lgkmcnt(4)
  v_mfma_f32_32x32x16_bf16 v[84:99], v[180:183], v[148:151], v[84:99]
  ds_read_b128 v[172:175], v195 offset:9216
  v_exp_f32 v78, v78
  v_exp_f32 v79, v79
  v_mfma_f32_32x32x16_bf16 v[84:99], v[184:187], v[152:155], v[84:99]
  ds_read_b128 v[176:179], v195 offset:11264
  v_exp_f32 v80, v80
  v_exp_f32 v81, v81
  s_waitcnt lgkmcnt(4)
  v_mfma_f32_32x32x16_bf16 v[4:19], v[156:159], v[116:119], v[4:19]
  ds_read_b128 v[180:183], v195 offset:13312
  v_exp_f32 v82, v82
  v_exp_f32 v83, v83
  v_mfma_f32_32x32x16_bf16 v[20:35], v[160:163], v[116:119], v[20:35]
  ds_read_b128 v[184:187], v195 offset:15360
  v_cvt_pk_bf16_f32 v120, v76, v77
  v_cvt_pk_bf16_f32 v121, v78, v79
  v_add_f32 v197, v197, v68
  v_add_f32 v198, v198, v69
  s_waitcnt lgkmcnt(4)
  v_mfma_f32_32x32x16_bf16 v[36:51], v[164:167], v[116:119], v[36:51]
  v_add_u32 v195, 0x8000, v195
  v_subrev_u32 v2, 0x28000, v195
  v_min_u32 v195, v195, v2
  ds_read_b128 v[156:159], v195 offset:0
  v_cvt_pk_bf16_f32 v122, v80, v81
  v_cvt_pk_bf16_f32 v123, v82, v83
  v_mfma_f32_32x32x16_bf16 v[52:67], v[168:171], v[116:119], v[52:67]
  ds_read_b128 v[160:163], v195 offset:1024
  v_add_f32 v197, v197, v70
  v_add_f32 v198, v198, v71
  v_add_f32 v197, v197, v72
  v_add_f32 v198, v198, v73
  s_waitcnt lgkmcnt(4)
  v_mfma_f32_32x32x16_bf16 v[4:19], v[172:175], v[120:123], v[4:19]
  ds_read_b128 v[164:167], v195 offset:2048
  v_add_f32 v197, v197, v74
  v_add_f32 v198, v198, v75
  v_add_f32 v197, v197, v76
  v_add_f32 v198, v198, v77
  s_add_u32 s17, s17, 1
  s_cmp_eq_u32 s17, s29
  v_mfma_f32_32x32x16_bf16 v[20:35], v[176:179], v[120:123], v[20:35]
  ds_read_b128 v[168:171], v195 offset:3072
  v_add_f32 v197, v197, v78
  v_add_f32 v198, v198, v79
  v_add_f32 v197, v197, v80
  v_add_f32 v198, v198, v81
  s_waitcnt lgkmcnt(4)
  v_mfma_f32_32x32x16_bf16 v[36:51], v[180:183], v[120:123], v[36:51]
  ds_read_b128 v[172:175], v195 offset:4096
  v_add_f32 v197, v197, v82
  v_add_f32 v198, v198, v83
  s_cbranch_scc1 at_kernel_last
  s_cmp_lt_u32 s17, s18
  s_cbranch_scc1 at_kernel_dtop
  s_branch at_kernel_atop
at_kernel_last:
  v_mfma_f32_32x32x16_bf16 v[52:67], v[184:187], v[120:123], v[52:67]
  ds_read_b128 v[176:179], v195 offset:5120
  s_waitcnt vmcnt(0)
  s_barrier
  s_cmp_lt_u32 s17, s18
  s_cbranch_scc0 at_kernel_lastA
  s_min_u32 s19, s26, s35
  s_mov_b32 m0, s27
  s_nop 0
  buffer_load_dwordx4 v190, s[56:59], s19 offen lds
  buffer_load_dwordx4 v190, s[56:59], s19 offen offset:1024 lds
  s_add_u32 s26, s26, 16384
  s_add_u32 s27, s27, 16384
  s_cmp_eq_u32 s27, s28
  s_cselect_b32 s27, s23, s27
  s_min_u32 s19, s26, s35
  s_mov_b32 m0, s27
  s_nop 0
  buffer_load_dwordx4 v190, s[56:59], s19 offen lds
  buffer_load_dwordx4 v190, s[56:59], s19 offen offset:1024 lds
  s_add_u32 s26, s26, 16384
  s_add_u32 s27, s27, 16384
  s_cmp_eq_u32 s27, s28
  s_cselect_b32 s27, s23, s27
  s_min_u32 s19, s26, s35
  s_mov_b32 m0, s27
  s_nop 0
  buffer_load_dwordx4 v190, s[56:59], s19 offen lds
  buffer_load_dwordx4 v190, s[56:59], s19 offen offset:1024 lds
  s_add_u32 s26, s26, 16384
  s_add_u32 s27, s27, 16384
  s_cmp_eq_u32 s27, s28
  s_cselect_b32 s27, s23, s27
  s_min_u32 s19, s26, s35
  s_mov_b32 m0, s27
  s_nop 0
  buffer_load_dwordx4 v190, s[56:59], s19 offen lds
  buffer_load_dwordx4 v190, s[56:59], s19 offen offset:1024 lds
  s_add_u32 s26, s26, 16384
  s_add_u32 s27, s27, 16384
  s_cmp_eq_u32 s27, s28
  s_cselect_b32 s27, s23, s27
  s_branch at_kernel_last0
at_kernel_lastA:
  s_cmp_eq_u32 s12, 7
  s_cbranch_scc1 at_kernel_last0
  s_add_u32 s52, s4, 41943040
  s_addc_u32 s53, s5, 0
  s_mov_b32 s54, 2097152
  s_mov_b32 s55, 0x20000
  s_waitcnt lgkmcnt(4)
  v_mfma_f32_32x32x16_bf16 v[68:83], v[156:159], v[124:127], v[100:115]
  ds_read_b128 v[180:183], v195 offset:6144
  v_exp_f32 v84, v84
  v_exp_f32 v85, v85
  v_mfma_f32_32x32x16_bf16 v[68:83], v[160:163], v[128:131], v[68:83]
  ds_read_b128 v[184:187], v195 offset:7168
  v_exp_f32 v86, v86
  v_exp_f32 v87, v87
  buffer_load_dwordx4 v[212:215], v190, s[52:55], s40 offen offset:0
  s_waitcnt lgkmcnt(4)
  v_mfma_f32_32x32x16_bf16 v[68:83], v[164:167], v[132:135], v[68:83]
  ds_read_b128 v[156:159], v196 offset:8192
  v_exp_f32 v88, v88
  v_exp_f32 v89, v89
  s_add_u32 s19, s40, 16384
  buffer_load_dwordx4 v[216:219], v190, s[52:55], s19 offen offset:0
  v_mfma_f32_32x32x16_bf16 v[68:83], v[168:171], v[136:139], v[68:83]
  ds_read_b128 v[160:163], v196 offset:10240
  v_exp_f32 v90, v90
  v_exp_f32 v91, v91
  buffer_load_dwordx4 v[220:223], v190, s[52:55], s40 offen offset:2048
  s_waitcnt lgkmcnt(4)
  v_mfma_f32_32x32x16_bf16 v[68:83], v[172:175], v[140:143], v[68:83]
  ds_read_b128 v[164:167], v196 offset:12288
  v_cvt_pk_bf16_f32 v116, v84, v85
  v_cvt_pk_bf16_f32 v117, v86, v87
  v_exp_f32 v92, v92
  s_add_u32 s19, s40, 16384
  buffer_load_dwordx4 v[224:227], v190, s[52:55], s19 offen offset:2048
  v_mfma_f32_32x32x16_bf16 v[68:83], v[176:179], v[144:147], v[68:83]
  ds_read_b128 v[168:171], v196 offset:14336
  v_cvt_pk_bf16_f32 v118, v88, v89
  v_cvt_pk_bf16_f32 v119, v90, v91
  v_exp_f32 v93, v93
  s_add_u32 s19, s40, 4096
  buffer_load_dwordx4 v[228:231], v190, s[52:55], s19 offen offset:0
  s_waitcnt lgkmcnt(4)
  v_mfma_f32_32x32x16_bf16 v[68:83], v[180:183], v[148:151], v[68:83]
  ds_read_b128 v[172:175], v196 offset:9216
  v_exp_f32 v94, v94
  v_exp_f32 v95, v95
  s_add_u32 s19, s40, 20480
  buffer_load_dwordx4 v[232:235], v190, s[52:55], s19 offen offset:0
  v_mfma_f32_32x32x16_bf16 v[68:83], v[184:187], v[152:155], v[68:83]
  ds_read_b128 v[176:179], v196 offset:11264
  v_exp_f32 v96, v96
  v_exp_f32 v97, v97
  s_add_u32 s19, s40, 4096
  buffer_load_dwordx4 v[236:239], v190, s[52:55], s19 offen offset:2048
  s_waitcnt lgkmcnt(4)
  v_mfma_f32_32x32x16_bf16 v[4:19], v[156:159], v[116:119], v[4:19]
  ds_read_b128 v[180:183], v196 offset:13312
  v_exp_f32 v98, v98
  v_exp_f32 v99, v99
  s_add_u32 s19, s40, 20480
  buffer_load_dwordx4 v[240:243], v190, s[52:55], s19 offen offset:2048
  v_mfma_f32_32x32x16_bf16 v[20:35], v[160:163], v[116:119], v[20:35]
  ds_read_b128 v[184:187], v196 offset:15360
  v_cvt_pk_bf16_f32 v120, v92, v93
  v_cvt_pk_bf16_f32 v121, v94, v95
  v_add_f32 v197, v197, v84
  v_add_f32 v198, v198, v85
  s_add_u32 s19, s40, 8192
  buffer_load_dwordx4 v[244:247], v190, s[52:55], s19 offen offset:0
  s_waitcnt lgkmcnt(4)
  v_mfma_f32_32x32x16_bf16 v[36:51], v[164:167], v[116:119], v[36:51]
  v_add_u32 v196, 0x8000, v196
  v_subrev_u32 v2, 0x28000, v196
  v_min_u32 v196, v196, v2
  ds_read_b128 v[156:159], v196 offset:0
  v_cvt_pk_bf16_f32 v122, v96, v97
  v_cvt_pk_bf16_f32 v123, v98, v99
  s_add_u32 s19, s40, 24576
  buffer_load_dwordx4 v[248:251], v190, s[52:55], s19 offen offset:0
  v_mfma_f32_32x32x16_bf16 v[52:67], v[168:171], v[116:119], v[52:67]
  ds_read_b128 v[160:163], v196 offset:1024
  v_add_f32 v197, v197, v86
  v_add_f32 v198, v198, v87
  v_add_f32 v197, v197, v88
  v_add_f32 v198, v198, v89
  s_waitcnt lgkmcnt(4)
  v_mfma_f32_32x32x16_bf16 v[4:19], v[172:175], v[120:123], v[4:19]
  ds_read_b128 v[164:167], v196 offset:2048
  v_add_f32 v197, v197, v90
  v_add_f32 v198, v198, v91
  v_add_f32 v197, v197, v92
  v_add_f32 v198, v198, v93
  v_mfma_f32_32x32x16_bf16 v[20:35], v[176:179], v[120:123], v[20:35]
  ds_read_b128 v[168:171], v196 offset:3072
  v_add_f32 v197, v197, v94
  v_add_f32 v198, v198, v95
  v_add_f32 v197, v197, v96
  v_add_f32 v198, v198, v97
  s_waitcnt lgkmcnt(4)
  v_mfma_f32_32x32x16_bf16 v[36:51], v[180:183], v[120:123], v[36:51]
  ds_read_b128 v[172:175], v196 offset:4096
  v_add_f32 v197, v197, v98
  v_add_f32 v198, v198, v99
  s_cmp_eq_u32 s30, 0
  v_mfma_f32_32x32x16_bf16 v[52:67], v[184:187], v[120:123], v[52:67]
  ds_read_b128 v[176:179], v196 offset:5120
  s_cbranch_scc1 at_kernel_tail0
  s_branch at_kernel_last1
at_kernel_last0:
  s_waitcnt lgkmcnt(4)
  v_mfma_f32_32x32x16_bf16 v[68:83], v[156:159], v[124:127], v[100:115]
  ds_read_b128 v[180:183], v195 offset:6144
  v_exp_f32 v84, v84
  v_exp_f32 v85, v85
  v_mfma_f32_32x32x16_bf16 v[68:83], v[160:163], v[128:131], v[68:83]
  ds_read_b128 v[184:187], v195 offset:7168
  v_exp_f32 v86, v86
  v_exp_f32 v87, v87
  s_waitcnt lgkmcnt(4)
  v_mfma_f32_32x32x16_bf16 v[68:83], v[164:167], v[132:135], v[68:83]
  ds_read_b128 v[156:159], v196 offset:8192
  v_exp_f32 v88, v88
  v_exp_f32 v89, v89
  v_mfma_f32_32x32x16_bf16 v[68:83], v[168:171], v[136:139], v[68:83]
  ds_read_b128 v[160:163], v196 offset:10240
  v_exp_f32 v90, v90
  v_exp_f32 v91, v91
  s_waitcnt lgkmcnt(4)
  v_mfma_f32_32x32x16_bf16 v[68:83], v[172:175], v[140:143], v[68:83]
  ds_read_b128 v[164:167], v196 offset:12288
  v_cvt_pk_bf16_f32 v116, v84, v85
  v_cvt_pk_bf16_f32 v117, v86, v87
  v_exp_f32 v92, v92
  v_mfma_f32_32x32x16_bf16 v[68:83], v[176:179], v[144:147], v[68:83]
  ds_read_b128 v[168:171], v196 offset:14336
  v_cvt_pk_bf16_f32 v118, v88, v89
  v_cvt_pk_bf16_f32 v119, v90, v91
  v_exp_f32 v93, v93
  s_waitcnt lgkmcnt(4)
  v_mfma_f32_32x32x16_bf16 v[68:83], v[180:183], v[148:151], v[68:83]
  ds_read_b128 v[172:175], v196 offset:9216
  v_exp_f32 v94, v94
  v_exp_f32 v95, v95
  v_mfma_f32_32x32x16_bf16 v[68:83], v[184:187], v[152:155], v[68:83]
  ds_read_b128 v[176:179], v196 offset:11264
  v_exp_f32 v96, v96
  v_exp_f32 v97, v97
  s_waitcnt lgkmcnt(4)
  v_mfma_f32_32x32x16_bf16 v[4:19], v[156:159], v[116:119], v[4:19]
  ds_read_b128 v[180:183], v196 offset:13312
  v_exp_f32 v98, v98
  v_exp_f32 v99, v99
  v_mfma_f32_32x32x16_bf16 v[20:35], v[160:163], v[116:119], v[20:35]
  ds_read_b128 v[184:187], v196 offset:15360
  v_cvt_pk_bf16_f32 v120, v92, v93
  v_cvt_pk_bf16_f32 v121, v94, v95
  v_add_f32 v197, v197, v84
  v_add_f32 v198, v198, v85
  s_waitcnt lgkmcnt(4)
  v_mfma_f32_32x32x16_bf16 v[36:51], v[164:167], v[116:119], v[36:51]
  v_add_u32 v196, 0x8000, v196
  v_subrev_u32 v2, 0x28000, v196
  v_min_u32 v196, v196, v2
  ds_read_b128 v[156:159], v196 offset:0
  v_cvt_pk_bf16_f32 v122, v96, v97
  v_cvt_pk_bf16_f32 v123, v98, v99
  v_mfma_f32_32x32x16_bf16 v[52:67], v[168:171], v[116:119], v[52:67]
  ds_read_b128 v[160:163], v196 offset:1024
  v_add_f32 v197, v197, v86
  v_add_f32 v198, v198, v87
  v_add_f32 v197, v197, v88
  v_add_f32 v198, v198, v89
  s_waitcnt lgkmcnt(4)
  v_mfma_f32_32x32x16_bf16 v[4:19], v[172:175], v[120:123], v[4:19]
  ds_read_b128 v[164:167], v196 offset:2048
  v_add_f32 v197, v197, v90
  v_add_f32 v198, v198, v91
  v_add_f32 v197, v197, v92
  v_add_f32 v198, v198, v93
  v_mfma_f32_32x32x16_bf16 v[20:35], v[176:179], v[120:123], v[20:35]
  ds_read_b128 v[168:171], v196 offset:3072
  v_add_f32 v197, v197, v94
  v_add_f32 v198, v198, v95
  v_add_f32 v197, v197, v96
  v_add_f32 v198, v198, v97
  s_waitcnt lgkmcnt(4)
  v_mfma_f32_32x32x16_bf16 v[36:51], v[180:183], v[120:123], v[36:51]
  ds_read_b128 v[172:175], v196 offset:4096
  v_add_f32 v197, v197, v98
  v_add_f32 v198, v198, v99
  s_cmp_eq_u32 s30, 0
  v_mfma_f32_32x32x16_bf16 v[52:67], v[184:187], v[120:123], v[52:67]
  ds_read_b128 v[176:179], v196 offset:5120
  s_cbranch_scc1 at_kernel_tail0
at_kernel_last1:
  s_waitcnt lgkmcnt(4)
  v_mfma_f32_32x32x16_bf16 v[84:99], v[156:159], v[124:127], v[100:115]
  ds_read_b128 v[180:183], v196 offset:6144
  v_exp_f32 v68, v68
  v_exp_f32 v69, v69
  v_mfma_f32_32x32x16_bf16 v[84:99], v[160:163], v[128:131], v[84:99]
  ds_read_b128 v[184:187], v196 offset:7168
  v_exp_f32 v70, v70
  v_exp_f32 v71, v71
  s_waitcnt lgkmcnt(4)
  v_mfma_f32_32x32x16_bf16 v[84:99], v[164:167], v[132:135], v[84:99]
  ds_read_b128 v[156:159], v195 offset:8192
  v_exp_f32 v72, v72
  v_exp_f32 v73, v73
  v_mfma_f32_32x32x16_bf16 v[84:99], v[168:171], v[136:139], v[84:99]
  ds_read_b128 v[160:163], v195 offset:10240
  v_exp_f32 v74, v74
  v_exp_f32 v75, v75
  s_waitcnt lgkmcnt(4)
  v_mfma_f32_32x32x16_bf16 v[84:99], v[172:175], v[140:143], v[84:99]
  ds_read_b128 v[164:167], v195 offset:12288
  v_cvt_pk_bf16_f32 v116, v68, v69
  v_cvt_pk_bf16_f32 v117, v70, v71
  v_exp_f32 v76, v76
  v_mfma_f32_32x32x16_bf16 v[84:99], v[176:179], v[144:147], v[84:99]
  ds_read_b128 v[168:171], v195 offset:14336
  v_cvt_pk_bf16_f32 v118, v72, v73
  v_cvt_pk_bf16_f32 v119, v74, v75
  v_exp_f32 v77, v77
  s_waitcnt lgkmcnt(4)
  v_mfma_f32_32x32x16_bf16 v[84:99], v[180:183], v[148:151], v[84:99]
  ds_read_b128 v[172:175], v195 offset:9216
  v_exp_f32 v78, v78
  v_exp_f32 v79, v79
  v_mfma_f32_32x32x16_bf16 v[84:99], v[184:187], v[152:155], v[84:99]
  ds_read_b128 v[176:179], v195 offset:11264
  v_exp_f32 v80, v80
  v_exp_f32 v81, v81
  s_waitcnt lgkmcnt(4)
  v_mfma_f32_32x32x16_bf16 v[4:19], v[156:159], v[116:119], v[4:19]
  ds_read_b128 v[180:183], v195 offset:13312
  v_exp_f32 v82, v82
  v_exp_f32 v83, v83
  v_mfma_f32_32x32x16_bf16 v[20:35], v[160:163], v[116:119], v[20:35]
  ds_read_b128 v[184:187], v195 offset:15360
  v_cvt_pk_bf16_f32 v120, v76, v77
  v_cvt_pk_bf16_f32 v121, v78, v79
  v_add_f32 v197, v197, v68
  v_add_f32 v198, v198, v69
  s_waitcnt lgkmcnt(4)
  v_mfma_f32_32x32x16_bf16 v[36:51], v[164:167], v[116:119], v[36:51]
  v_add_u32 v195, 0x8000, v195
  v_subrev_u32 v2, 0x28000, v195
  v_min_u32 v195, v195, v2
  ds_read_b128 v[156:159], v195 offset:0
  v_cvt_pk_bf16_f32 v122, v80, v81
  v_cvt_pk_bf16_f32 v123, v82, v83
  v_mfma_f32_32x32x16_bf16 v[52:67], v[168:171], v[116:119], v[52:67]
  ds_read_b128 v[160:163], v195 offset:1024
  v_add_f32 v197, v197, v70
  v_add_f32 v198, v198, v71
  v_add_f32 v197, v197, v72
  v_add_f32 v198, v198, v73
  s_waitcnt lgkmcnt(4)
  v_mfma_f32_32x32x16_bf16 v[4:19], v[172:175], v[120:123], v[4:19]
  ds_read_b128 v[164:167], v195 offset:2048
  v_add_f32 v197, v197, v74
  v_add_f32 v198, v198, v75
  v_add_f32 v197, v197, v76
  v_add_f32 v198, v198, v77
  v_mfma_f32_32x32x16_bf16 v[20:35], v[176:179], v[120:123], v[20:35]
  ds_read_b128 v[168:171], v195 offset:3072
  v_add_f32 v197, v197, v78
  v_add_f32 v198, v198, v79
  v_add_f32 v197, v197, v80
  v_add_f32 v198, v198, v81
  s_waitcnt lgkmcnt(4)
  v_mfma_f32_32x32x16_bf16 v[36:51], v[180:183], v[120:123], v[36:51]
  ds_read_b128 v[172:175], v195 offset:4096
  v_add_f32 v197, v197, v82
  v_add_f32 v198, v198, v83
  s_cmp_eq_u32 s30, 1
  v_mfma_f32_32x32x16_bf16 v[52:67], v[184:187], v[120:123], v[52:67]
  ds_read_b128 v[176:179], v195 offset:5120
  s_cbranch_scc1 at_kernel_tail1
  s_waitcnt lgkmcnt(4)
  v_mfma_f32_32x32x16_bf16 v[68:83], v[156:159], v[124:127], v[100:115]
  ds_read_b128 v[180:183], v195 offset:6144
  v_exp_f32 v84, v84
  v_exp_f32 v85, v85
  v_mfma_f32_32x32x16_bf16 v[68:83], v[160:163], v[128:131], v[68:83]
  ds_read_b128 v[184:187], v195 offset:7168
  v_exp_f32 v86, v86
  v_exp_f32 v87, v87
  s_waitcnt lgkmcnt(4)
  v_mfma_f32_32x32x16_bf16 v[68:83], v[164:167], v[132:135], v[68:83]
  ds_read_b128 v[156:159], v196 offset:8192
  v_exp_f32 v88, v88
  v_exp_f32 v89, v89
  v_mfma_f32_32x32x16_bf16 v[68:83], v[168:171], v[136:139], v[68:83]
  ds_read_b128 v[160:163], v196 offset:10240
  v_exp_f32 v90, v90
  v_exp_f32 v91, v91
  s_waitcnt lgkmcnt(4)
  v_mfma_f32_32x32x16_bf16 v[68:83], v[172:175], v[140:143], v[68:83]
  ds_read_b128 v[164:167], v196 offset:12288
  v_cvt_pk_bf16_f32 v116, v84, v85
  v_cvt_pk_bf16_f32 v117, v86, v87
  v_exp_f32 v92, v92
  v_mfma_f32_32x32x16_bf16 v[68:83], v[176:179], v[144:147], v[68:83]
  ds_read_b128 v[168:171], v196 offset:14336
  v_cvt_pk_bf16_f32 v118, v88, v89
  v_cvt_pk_bf16_f32 v119, v90, v91
  v_exp_f32 v93, v93
  s_waitcnt lgkmcnt(4)
  v_mfma_f32_32x32x16_bf16 v[68:83], v[180:183], v[148:151], v[68:83]
  ds_read_b128 v[172:175], v196 offset:9216
  v_exp_f32 v94, v94
  v_exp_f32 v95, v95
  v_mfma_f32_32x32x16_bf16 v[68:83], v[184:187], v[152:155], v[68:83]
  ds_read_b128 v[176:179], v196 offset:11264
  v_exp_f32 v96, v96
  v_exp_f32 v97, v97
  s_waitcnt lgkmcnt(4)
  v_mfma_f32_32x32x16_bf16 v[4:19], v[156:159], v[116:119], v[4:19]
  ds_read_b128 v[180:183], v196 offset:13312
  v_exp_f32 v98, v98
  v_exp_f32 v99, v99
  v_mfma_f32_32x32x16_bf16 v[20:35], v[160:163], v[116:119], v[20:35]
  ds_read_b128 v[184:187], v196 offset:15360
  v_cvt_pk_bf16_f32 v120, v92, v93
  v_cvt_pk_bf16_f32 v121, v94, v95
  v_add_f32 v197, v197, v84
  v_add_f32 v198, v198, v85
  s_waitcnt lgkmcnt(4)
  v_mfma_f32_32x32x16_bf16 v[36:51], v[164:167], v[116:119], v[36:51]
  v_add_u32 v196, 0x8000, v196
  v_subrev_u32 v2, 0x28000, v196
  v_min_u32 v196, v196, v2
  ds_read_b128 v[156:159], v196 offset:0
  v_cvt_pk_bf16_f32 v122, v96, v97
  v_cvt_pk_bf16_f32 v123, v98, v99
  v_mfma_f32_32x32x16_bf16 v[52:67], v[168:171], v[116:119], v[52:67]
  ds_read_b128 v[160:163], v196 offset:1024
  v_add_f32 v197, v197, v86
  v_add_f32 v198, v198, v87
  v_add_f32 v197, v197, v88
  v_add_f32 v198, v198, v89
  s_waitcnt lgkmcnt(4)
  v_mfma_f32_32x32x16_bf16 v[4:19], v[172:175], v[120:123], v[4:19]
  ds_read_b128 v[164:167], v196 offset:2048
  v_add_f32 v197, v197, v90
  v_add_f32 v198, v198, v91
  v_add_f32 v197, v197, v92
  v_add_f32 v198, v198, v93
  v_mfma_f32_32x32x16_bf16 v[20:35], v[176:179], v[120:123], v[20:35]
  ds_read_b128 v[168:171], v196 offset:3072
  v_add_f32 v197, v197, v94
  v_add_f32 v198, v198, v95
  v_add_f32 v197, v197, v96
  v_add_f32 v198, v198, v97
  s_waitcnt lgkmcnt(4)
  v_mfma_f32_32x32x16_bf16 v[36:51], v[180:183], v[120:123], v[36:51]
  ds_read_b128 v[172:175], v196 offset:4096
  v_add_f32 v197, v197, v98
  v_add_f32 v198, v198, v99
  s_cmp_eq_u32 s30, 2
  v_mfma_f32_32x32x16_bf16 v[52:67], v[184:187], v[120:123], v[52:67]
  ds_read_b128 v[176:179], v196 offset:5120
  s_cbranch_scc1 at_kernel_tail0
  s_waitcnt lgkmcnt(4)
  v_mfma_f32_32x32x16_bf16 v[84:99], v[156:159], v[124:127], v[100:115]
  ds_read_b128 v[180:183], v196 offset:6144
  v_exp_f32 v68, v68
  v_exp_f32 v69, v69
  v_mfma_f32_32x32x16_bf16 v[84:99], v[160:163], v[128:131], v[84:99]
  ds_read_b128 v[184:187], v196 offset:7168
  v_exp_f32 v70, v70
  v_exp_f32 v71, v71
  s_waitcnt lgkmcnt(4)
  v_mfma_f32_32x32x16_bf16 v[84:99], v[164:167], v[132:135], v[84:99]
  ds_read_b128 v[156:159], v195 offset:8192
  v_exp_f32 v72, v72
  v_exp_f32 v73, v73
  v_mfma_f32_32x32x16_bf16 v[84:99], v[168:171], v[136:139], v[84:99]
  ds_read_b128 v[160:163], v195 offset:10240
  v_exp_f32 v74, v74
  v_exp_f32 v75, v75
  s_waitcnt lgkmcnt(4)
  v_mfma_f32_32x32x16_bf16 v[84:99], v[172:175], v[140:143], v[84:99]
  ds_read_b128 v[164:167], v195 offset:12288
  v_cvt_pk_bf16_f32 v116, v68, v69
  v_cvt_pk_bf16_f32 v117, v70, v71
  v_exp_f32 v76, v76
  v_mfma_f32_32x32x16_bf16 v[84:99], v[176:179], v[144:147], v[84:99]
  ds_read_b128 v[168:171], v195 offset:14336
  v_cvt_pk_bf16_f32 v118, v72, v73
  v_cvt_pk_bf16_f32 v119, v74, v75
  v_exp_f32 v77, v77
  s_waitcnt lgkmcnt(4)
  v_mfma_f32_32x32x16_bf16 v[84:99], v[180:183], v[148:151], v[84:99]
  ds_read_b128 v[172:175], v195 offset:9216
  v_exp_f32 v78, v78
  v_exp_f32 v79, v79
  v_mfma_f32_32x32x16_bf16 v[84:99], v[184:187], v[152:155], v[84:99]
  ds_read_b128 v[176:179], v195 offset:11264
  v_exp_f32 v80, v80
  v_exp_f32 v81, v81
  s_waitcnt lgkmcnt(4)
  v_mfma_f32_32x32x16_bf16 v[4:19], v[156:159], v[116:119], v[4:19]
  ds_read_b128 v[180:183], v195 offset:13312
  v_exp_f32 v82, v82
  v_exp_f32 v83, v83
  v_mfma_f32_32x32x16_bf16 v[20:35], v[160:163], v[116:119], v[20:35]
  ds_read_b128 v[184:187], v195 offset:15360
  v_cvt_pk_bf16_f32 v120, v76, v77
  v_cvt_pk_bf16_f32 v121, v78, v79
  v_add_f32 v197, v197, v68
  v_add_f32 v198, v198, v69
  s_waitcnt lgkmcnt(4)
  v_mfma_f32_32x32x16_bf16 v[36:51], v[164:167], v[116:119], v[36:51]
  v_add_u32 v195, 0x8000, v195
  v_subrev_u32 v2, 0x28000, v195
  v_min_u32 v195, v195, v2
  ds_read_b128 v[156:159], v195 offset:0
  v_cvt_pk_bf16_f32 v122, v80, v81
  v_cvt_pk_bf16_f32 v123, v82, v83
  v_mfma_f32_32x32x16_bf16 v[52:67], v[168:171], v[116:119], v[52:67]
  ds_read_b128 v[160:163], v195 offset:1024
  v_add_f32 v197, v197, v70
  v_add_f32 v198, v198, v71
  v_add_f32 v197, v197, v72
  v_add_f32 v198, v198, v73
  s_waitcnt lgkmcnt(4)
  v_mfma_f32_32x32x16_bf16 v[4:19], v[172:175], v[120:123], v[4:19]
  ds_read_b128 v[164:167], v195 offset:2048
  v_add_f32 v197, v197, v74
  v_add_f32 v198, v198, v75
  v_add_f32 v197, v197, v76
  v_add_f32 v198, v198, v77
  v_mfma_f32_32x32x16_bf16 v[20:35], v[176:179], v[120:123], v[20:35]
  ds_read_b128 v[168:171], v195 offset:3072
  v_add_f32 v197, v197, v78
  v_add_f32 v198, v198, v79
  v_add_f32 v197, v197, v80
  v_add_f32 v198, v198, v81
  s_waitcnt lgkmcnt(4)
  v_mfma_f32_32x32x16_bf16 v[36:51], v[180:183], v[120:123], v[36:51]
  ds_read_b128 v[172:175], v195 offset:4096
  v_add_f32 v197, v197, v82
  v_add_f32 v198, v198, v83
  v_mfma_f32_32x32x16_bf16 v[52:67], v[184:187], v[120:123], v[52:67]
  ds_read_b128 v[176:179], v195 offset:5120
at_kernel_tail1:
  ds_read_b128 v[156:159], v196 offset:8192
  ds_read_b128 v[160:163], v196 offset:10240
  ds_read_b128 v[164:167], v196 offset:12288
  ds_read_b128 v[168:171], v196 offset:14336
  ds_read_b128 v[172:175], v196 offset:9216
  ds_read_b128 v[176:179], v196 offset:11264
  ds_read_b128 v[180:183], v196 offset:13312
  ds_read_b128 v[184:187], v196 offset:15360
  v_cmp_le_i32 vcc, 0, v200
  s_nop 1
  v_cndmask_b32 v84, v201, v84, vcc
  v_cmp_le_i32 vcc, 1, v200
  s_nop 1
  v_cndmask_b32 v85, v201, v85, vcc
  v_cmp_le_i32 vcc, 2, v200
  s_nop 1
  v_cndmask_b32 v86, v201, v86, vcc
  v_cmp_le_i32 vcc, 3, v200
  s_nop 1
  v_cndmask_b32 v87, v201, v87, vcc
  v_cmp_le_i32 vcc, 8, v200
  s_nop 1
  v_cndmask_b32 v88, v201, v88, vcc
  v_cmp_le_i32 vcc, 9, v200
  s_nop 1
  v_cndmask_b32 v89, v201, v89, vcc
  v_cmp_le_i32 vcc, 10, v200
  s_nop 1
  v_cndmask_b32 v90, v201, v90, vcc
  v_cmp_le_i32 vcc, 11, v200
  s_nop 1
  v_cndmask_b32 v91, v201, v91, vcc
  v_cmp_le_i32 vcc, 16, v200
  s_nop 1
  v_cndmask_b32 v92, v201, v92, vcc
  v_cmp_le_i32 vcc, 17, v200
  s_nop 1
  v_cndmask_b32 v93, v201, v93, vcc
  v_cmp_le_i32 vcc, 18, v200
  s_nop 1
  v_cndmask_b32 v94, v201, v94, vcc
  v_cmp_le_i32 vcc, 19, v200
  s_nop 1
  v_cndmask_b32 v95, v201, v95, vcc
  v_cmp_le_i32 vcc, 24, v200
  s_nop 1
  v_cndmask_b32 v96, v201, v96, vcc
  v_cmp_le_i32 vcc, 25, v200
  s_nop 1
  v_cndmask_b32 v97, v201, v97, vcc
  v_cmp_le_i32 vcc, 26, v200
  s_nop 1
  v_cndmask_b32 v98, v201, v98, vcc
  v_cmp_le_i32 vcc, 27, v200
  s_nop 1
  v_cndmask_b32 v99, v201, v99, vcc
  v_exp_f32 v84, v84
  v_exp_f32 v85, v85
  v_exp_f32 v86, v86
  v_exp_f32 v87, v87
  v_exp_f32 v88, v88
  v_exp_f32 v89, v89
  v_exp_f32 v90, v90
  v_exp_f32 v91, v91
  v_exp_f32 v92, v92
  v_exp_f32 v93, v93
  v_exp_f32 v94, v94
  v_exp_f32 v95, v95
  v_exp_f32 v96, v96
  v_exp_f32 v97, v97
  v_exp_f32 v98, v98
  v_exp_f32 v99, v99
  v_cvt_pk_bf16_f32 v116, v84, v85
  v_cvt_pk_bf16_f32 v117, v86, v87
  v_cvt_pk_bf16_f32 v118, v88, v89
  v_cvt_pk_bf16_f32 v119, v90, v91
  v_cvt_pk_bf16_f32 v120, v92, v93
  v_cvt_pk_bf16_f32 v121, v94, v95
  v_cvt_pk_bf16_f32 v122, v96, v97
  v_cvt_pk_bf16_f32 v123, v98, v99
  s_waitcnt lgkmcnt(7)
  v_mfma_f32_32x32x16_bf16 v[4:19], v[156:159], v[116:119], v[4:19]
  v_add_f32 v197, v197, v84
  v_add_f32 v198, v198, v85
  s_waitcnt lgkmcnt(6)
  v_mfma_f32_32x32x16_bf16 v[20:35], v[160:163], v[116:119], v[20:35]
  v_add_f32 v197, v197, v86
  v_add_f32 v198, v198, v87
  s_waitcnt lgkmcnt(5)
  v_mfma_f32_32x32x16_bf16 v[36:51], v[164:167], v[116:119], v[36:51]
  v_add_f32 v197, v197, v88
  v_add_f32 v198, v198, v89
  s_waitcnt lgkmcnt(4)
  v_mfma_f32_32x32x16_bf16 v[52:67], v[168:171], v[116:119], v[52:67]
  v_add_f32 v197, v197, v90
  v_add_f32 v198, v198, v91
  s_waitcnt lgkmcnt(3)
  v_mfma_f32_32x32x16_bf16 v[4:19], v[172:175], v[120:123], v[4:19]
  v_add_f32 v197, v197, v92
  v_add_f32 v198, v198, v93
  s_waitcnt lgkmcnt(2)
  v_mfma_f32_32x32x16_bf16 v[20:35], v[176:179], v[120:123], v[20:35]
  v_add_f32 v197, v197, v94
  v_add_f32 v198, v198, v95
  s_waitcnt lgkmcnt(1)
  v_mfma_f32_32x32x16_bf16 v[36:51], v[180:183], v[120:123], v[36:51]
  v_add_f32 v197, v197, v96
  v_add_f32 v198, v198, v97
  s_waitcnt lgkmcnt(0)
  v_mfma_f32_32x32x16_bf16 v[52:67], v[184:187], v[120:123], v[52:67]
  v_add_f32 v197, v197, v98
  v_add_f32 v198, v198, v99
  s_branch at_kernel_tailend
at_kernel_tail0:
  ds_read_b128 v[156:159], v195 offset:8192
  ds_read_b128 v[160:163], v195 offset:10240
  ds_read_b128 v[164:167], v195 offset:12288
  ds_read_b128 v[168:171], v195 offset:14336
  ds_read_b128 v[172:175], v195 offset:9216
  ds_read_b128 v[176:179], v195 offset:11264
  ds_read_b128 v[180:183], v195 offset:13312
  ds_read_b128 v[184:187], v195 offset:15360
  v_cmp_le_i32 vcc, 0, v200
  s_nop 1
  v_cndmask_b32 v68, v201, v68, vcc
  v_cmp_le_i32 vcc, 1, v200
  s_nop 1
  v_cndmask_b32 v69, v201, v69, vcc
  v_cmp_le_i32 vcc, 2, v200
  s_nop 1
  v_cndmask_b32 v70, v201, v70, vcc
  v_cmp_le_i32 vcc, 3, v200
  s_nop 1
  v_cndmask_b32 v71, v201, v71, vcc
  v_cmp_le_i32 vcc, 8, v200
  s_nop 1
  v_cndmask_b32 v72, v201, v72, vcc
  v_cmp_le_i32 vcc, 9, v200
  s_nop 1
  v_cndmask_b32 v73, v201, v73, vcc
  v_cmp_le_i32 vcc, 10, v200
  s_nop 1
  v_cndmask_b32 v74, v201, v74, vcc
  v_cmp_le_i32 vcc, 11, v200
  s_nop 1
  v_cndmask_b32 v75, v201, v75, vcc
  v_cmp_le_i32 vcc, 16, v200
  s_nop 1
  v_cndmask_b32 v76, v201, v76, vcc
  v_cmp_le_i32 vcc, 17, v200
  s_nop 1
  v_cndmask_b32 v77, v201, v77, vcc
  v_cmp_le_i32 vcc, 18, v200
  s_nop 1
  v_cndmask_b32 v78, v201, v78, vcc
  v_cmp_le_i32 vcc, 19, v200
  s_nop 1
  v_cndmask_b32 v79, v201, v79, vcc
  v_cmp_le_i32 vcc, 24, v200
  s_nop 1
  v_cndmask_b32 v80, v201, v80, vcc
  v_cmp_le_i32 vcc, 25, v200
  s_nop 1
  v_cndmask_b32 v81, v201, v81, vcc
  v_cmp_le_i32 vcc, 26, v200
  s_nop 1
  v_cndmask_b32 v82, v201, v82, vcc
  v_cmp_le_i32 vcc, 27, v200
  s_nop 1
  v_cndmask_b32 v83, v201, v83, vcc
  v_exp_f32 v68, v68
  v_exp_f32 v69, v69
  v_exp_f32 v70, v70
  v_exp_f32 v71, v71
  v_exp_f32 v72, v72
  v_exp_f32 v73, v73
  v_exp_f32 v74, v74
  v_exp_f32 v75, v75
  v_exp_f32 v76, v76
  v_exp_f32 v77, v77
  v_exp_f32 v78, v78
  v_exp_f32 v79, v79
  v_exp_f32 v80, v80
  v_exp_f32 v81, v81
  v_exp_f32 v82, v82
  v_exp_f32 v83, v83
  v_cvt_pk_bf16_f32 v116, v68, v69
  v_cvt_pk_bf16_f32 v117, v70, v71
  v_cvt_pk_bf16_f32 v118, v72, v73
  v_cvt_pk_bf16_f32 v119, v74, v75
  v_cvt_pk_bf16_f32 v120, v76, v77
  v_cvt_pk_bf16_f32 v121, v78, v79
  v_cvt_pk_bf16_f32 v122, v80, v81
  v_cvt_pk_bf16_f32 v123, v82, v83
  s_waitcnt lgkmcnt(7)
  v_mfma_f32_32x32x16_bf16 v[4:19], v[156:159], v[116:119], v[4:19]
  v_add_f32 v197, v197, v68
  v_add_f32 v198, v198, v69
  s_waitcnt lgkmcnt(6)
  v_mfma_f32_32x32x16_bf16 v[20:35], v[160:163], v[116:119], v[20:35]
  v_add_f32 v197, v197, v70
  v_add_f32 v198, v198, v71
  s_waitcnt lgkmcnt(5)
  v_mfma_f32_32x32x16_bf16 v[36:51], v[164:167], v[116:119], v[36:51]
  v_add_f32 v197, v197, v72
  v_add_f32 v198, v198, v73
  s_waitcnt lgkmcnt(4)
  v_mfma_f32_32x32x16_bf16 v[52:67], v[168:171], v[116:119], v[52:67]
  v_add_f32 v197, v197, v74
  v_add_f32 v198, v198, v75
  s_waitcnt lgkmcnt(3)
  v_mfma_f32_32x32x16_bf16 v[4:19], v[172:175], v[120:123], v[4:19]
  v_add_f32 v197, v197, v76
  v_add_f32 v198, v198, v77
  s_waitcnt lgkmcnt(2)
  v_mfma_f32_32x32x16_bf16 v[20:35], v[176:179], v[120:123], v[20:35]
  v_add_f32 v197, v197, v78
  v_add_f32 v198, v198, v79
  s_waitcnt lgkmcnt(1)
  v_mfma_f32_32x32x16_bf16 v[36:51], v[180:183], v[120:123], v[36:51]
  v_add_f32 v197, v197, v80
  v_add_f32 v198, v198, v81
  s_waitcnt lgkmcnt(0)
  v_mfma_f32_32x32x16_bf16 v[52:67], v[184:187], v[120:123], v[52:67]
  v_add_f32 v197, v197, v82
  v_add_f32 v198, v198, v83
at_kernel_tailend:
  s_cmp_ge_u32 s10, 4
  s_cbranch_scc1 at_kernel_broleend
  v_add_f32 v197, v197, v198
  v_mov_b32 v2, v197
  s_nop 1
  v_permlane32_swap_b32 v2, v197
  v_add_f32 v197, v197, v2
  v_mov_b32 v2, 0x53800000
  v_cmp_nlt_f32 vcc, v197, v2
  s_cmp_lg_u64 vcc, 0
  s_cselect_b32 s37, 1, 0
  s_mov_b32 s48, s8
  s_mov_b32 s49, s9
  s_mov_b32 s50, 1835008
  s_mov_b32 s51, 0x20000
  s_branch at_kernel_chk
at_kernel_broleend:
  s_sub_u32 s26, s26, s25
  s_add_u32 s26, s26, s33
  s_sub_u32 s27, s27, s23
  s_add_u32 s27, s27, s34
  s_add_u32 s28, s34, 163840
  s_add_u32 s17, s17, 2
  s_waitcnt vmcnt(0)
  s_barrier
  s_cmp_ge_u32 s17, s15
  s_cbranch_scc1 at_kernel_idle_n0
  s_min_u32 s19, s26, s36
  s_mov_b32 m0, s27
  s_nop 0
  buffer_load_dwordx4 v190, s[56:59], s19 offen lds
  buffer_load_dwordx4 v190, s[56:59], s19 offen offset:1024 lds
  buffer_load_dwordx4 v190, s[56:59], s19 offen offset:2048 lds
  buffer_load_dwordx4 v190, s[56:59], s19 offen offset:3072 lds
  s_add_u32 s26, s26, 16384
  s_add_u32 s27, s27, 16384
  s_cmp_eq_u32 s27, s28
  s_cselect_b32 s27, s34, s27
  s_min_u32 s19, s26, s36
  s_mov_b32 m0, s27
  s_nop 0
  buffer_load_dwordx4 v190, s[56:59], s19 offen lds
  buffer_load_dwordx4 v190, s[56:59], s19 offen offset:1024 lds
  buffer_load_dwordx4 v190, s[56:59], s19 offen offset:2048 lds
  buffer_load_dwordx4 v190, s[56:59], s19 offen offset:3072 lds
  s_add_u32 s26, s26, 16384
  s_add_u32 s27, s27, 16384
  s_cmp_eq_u32 s27, s28
  s_cselect_b32 s27, s34, s27
  s_min_u32 s19, s26, s36
  s_mov_b32 m0, s27
  s_nop 0
  buffer_load_dwordx4 v190, s[56:59], s19 offen lds
  buffer_load_dwordx4 v190, s[56:59], s19 offen offset:1024 lds
  buffer_load_dwordx4 v190, s[56:59], s19 offen offset:2048 lds
  buffer_load_dwordx4 v190, s[56:59], s19 offen offset:3072 lds
  s_add_u32 s26, s26, 16384
  s_add_u32 s27, s27, 16384
  s_cmp_eq_u32 s27, s28
  s_cselect_b32 s27, s34, s27
  s_min_u32 s19, s26, s36
  s_mov_b32 m0, s27
  s_nop 0
  buffer_load_dwordx4 v190, s[56:59], s19 offen lds
  buffer_load_dwordx4 v190, s[56:59], s19 offen offset:1024 lds
  buffer_load_dwordx4 v190, s[56:59], s19 offen offset:2048 lds
  buffer_load_dwordx4 v190, s[56:59], s19 offen offset:3072 lds
  s_add_u32 s26, s26, 16384
  s_add_u32 s27, s27, 16384
  s_cmp_eq_u32 s27, s28
  s_cselect_b32 s27, s34, s27
at_kernel_idle_n0:
  s_load_dwordx2 s[6:7], s[0:1], 40
  s_load_dwordx2 s[68:69], s[0:1], 80
  s_lshl_b32 s70, s2, 2
  s_add_u32 s70, s70, s10
  s_sub_u32 s70, s70, 4
  v_lshrrev_b32 v2, 3, v1
  v_and_b32 v3, 7, v1
  v_lshlrev_b32 v3, 4, v3
  v_lshl_add_u32 v254, v2, 19, v3
  s_mov_b32 s19, 229376
  v_mad_u32_u24 v255, v2, s19, v3
  s_waitcnt lgkmcnt(0)
  s_mov_b32 s48, s6
  s_mov_b32 s49, s7
  s_mov_b32 s50, 4194304
  s_mov_b32 s51, 0x20000
  s_mov_b32 s52, s68
  s_mov_b32 s53, s69
  s_mov_b32 s54, 1835008
  s_mov_b32 s55, 0x20000
  s_lshl_b32 s19, s70, 12
  buffer_load_dwordx4 v[156:159], v190, s[48:51], s19 offen offset:0
  buffer_load_dwordx4 v[160:163], v190, s[48:51], s19 offen offset:1024
  buffer_load_dwordx4 v[164:167], v190, s[48:51], s19 offen offset:2048
  buffer_load_dwordx4 v[168:171], v190, s[48:51], s19 offen offset:3072
  s_cmp_ge_u32 s70, 896
  s_cbranch_scc1 at_kernel_rl_skl
  s_lshl_b32 s19, s70, 11
  buffer_load_dwordx4 v[172:175], v190, s[52:55], s19 offen offset:0
  buffer_load_dwordx4 v[176:179], v190, s[52:55], s19 offen offset:1024
at_kernel_rl_skl:
  v_add_f32 v197, v197, v198
  v_mov_b32 v2, v197
  s_nop 1
  v_permlane32_swap_b32 v2, v197
  v_add_f32 v197, v197, v2
  v_mov_b32 v2, 0x53800000
  v_cmp_nlt_f32 vcc, v197, v2
  s_cmp_lg_u64 vcc, 0
  s_cselect_b32 s37, 1, 0
  v_rcp_f32 v199, v197
  s_lshl_b32 s19, s13, 18
  s_lshl_b32 s20, s11, 12
  s_add_u32 s19, s19, s20
  v_mov_b32 v252, v199
  v_mov_b32 v253, v199
  v_pk_mul_f32 v[4:5], v[4:5], v[252:253]
  v_pk_mul_f32 v[6:7], v[6:7], v[252:253]
  v_pk_mul_f32 v[8:9], v[8:9], v[252:253]
  v_pk_mul_f32 v[10:11], v[10:11], v[252:253]
  v_pk_mul_f32 v[12:13], v[12:13], v[252:253]
  v_pk_mul_f32 v[14:15], v[14:15], v[252:253]
  v_pk_mul_f32 v[16:17], v[16:17], v[252:253]
  v_pk_mul_f32 v[18:19], v[18:19], v[252:253]
  v_cvt_pk_bf16_f32 v68, v4, v5
  v_cvt_pk_bf16_f32 v69, v6, v7
  v_cvt_pk_bf16_f32 v70, v8, v9
  v_cvt_pk_bf16_f32 v71, v10, v11
  buffer_store_dwordx4 v[68:71], v202, s[60:63], s19 offen offset:0 sc1
  v_cvt_pk_bf16_f32 v72, v12, v13
  v_cvt_pk_bf16_f32 v73, v14, v15
  v_cvt_pk_bf16_f32 v74, v16, v17
  v_cvt_pk_bf16_f32 v75, v18, v19
  buffer_store_dwordx4 v[72:75], v202, s[60:63], s19 offen offset:512 sc1
  v_pk_mul_f32 v[20:21], v[20:21], v[252:253]
  v_pk_mul_f32 v[22:23], v[22:23], v[252:253]
  v_pk_mul_f32 v[24:25], v[24:25], v[252:253]
  v_pk_mul_f32 v[26:27], v[26:27], v[252:253]
  v_pk_mul_f32 v[28:29], v[28:29], v[252:253]
  v_pk_mul_f32 v[30:31], v[30:31], v[252:253]
  v_pk_mul_f32 v[32:33], v[32:33], v[252:253]
  v_pk_mul_f32 v[34:35], v[34:35], v[252:253]
  v_cvt_pk_bf16_f32 v76, v20, v21
  v_cvt_pk_bf16_f32 v77, v22, v23
  v_cvt_pk_bf16_f32 v78, v24, v25
  v_cvt_pk_bf16_f32 v79, v26, v27
  buffer_store_dwordx4 v[76:79], v202, s[60:63], s19 offen offset:1024 sc1
  v_cvt_pk_bf16_f32 v80, v28, v29
  v_cvt_pk_bf16_f32 v81, v30, v31
  v_cvt_pk_bf16_f32 v82, v32, v33
  v_cvt_pk_bf16_f32 v83, v34, v35
  buffer_store_dwordx4 v[80:83], v202, s[60:63], s19 offen offset:1536 sc1
  v_pk_mul_f32 v[36:37], v[36:37], v[252:253]
  v_pk_mul_f32 v[38:39], v[38:39], v[252:253]
  v_pk_mul_f32 v[40:41], v[40:41], v[252:253]
  v_pk_mul_f32 v[42:43], v[42:43], v[252:253]
  v_pk_mul_f32 v[44:45], v[44:45], v[252:253]
  v_pk_mul_f32 v[46:47], v[46:47], v[252:253]
  v_pk_mul_f32 v[48:49], v[48:49], v[252:253]
  v_pk_mul_f32 v[50:51], v[50:51], v[252:253]
  v_cvt_pk_bf16_f32 v84, v36, v37
  v_cvt_pk_bf16_f32 v85, v38, v39
  v_cvt_pk_bf16_f32 v86, v40, v41
  v_cvt_pk_bf16_f32 v87, v42, v43
  buffer_store_dwordx4 v[84:87], v202, s[60:63], s19 offen offset:2048 sc1
  v_cvt_pk_bf16_f32 v88, v44, v45
  v_cvt_pk_bf16_f32 v89, v46, v47
  v_cvt_pk_bf16_f32 v90, v48, v49
  v_cvt_pk_bf16_f32 v91, v50, v51
  buffer_store_dwordx4 v[88:91], v202, s[60:63], s19 offen offset:2560 sc1
  v_pk_mul_f32 v[52:53], v[52:53], v[252:253]
  v_pk_mul_f32 v[54:55], v[54:55], v[252:253]
  v_pk_mul_f32 v[56:57], v[56:57], v[252:253]
  v_pk_mul_f32 v[58:59], v[58:59], v[252:253]
  v_pk_mul_f32 v[60:61], v[60:61], v[252:253]
  v_pk_mul_f32 v[62:63], v[62:63], v[252:253]
  v_pk_mul_f32 v[64:65], v[64:65], v[252:253]
  v_pk_mul_f32 v[66:67], v[66:67], v[252:253]
  v_cvt_pk_bf16_f32 v92, v52, v53
  v_cvt_pk_bf16_f32 v93, v54, v55
  v_cvt_pk_bf16_f32 v94, v56, v57
  v_cvt_pk_bf16_f32 v95, v58, v59
  buffer_store_dwordx4 v[92:95], v202, s[60:63], s19 offen offset:3072 sc1
  v_cvt_pk_bf16_f32 v96, v60, v61
  v_cvt_pk_bf16_f32 v97, v62, v63
  v_cvt_pk_bf16_f32 v98, v64, v65
  v_cvt_pk_bf16_f32 v99, v66, v67
  buffer_store_dwordx4 v[96:99], v202, s[60:63], s19 offen offset:3584 sc1
  s_add_u32 s17, s17, 1
  s_cmp_gt_u32 s17, s15
  s_cbranch_scc1 at_kernel_rl_only
  s_waitcnt vmcnt(0)
  s_barrier
  s_cmp_ge_u32 s17, s15
  s_cbranch_scc1 at_kernel_idle_n2
  s_min_u32 s19, s26, s36
  s_mov_b32 m0, s27
  s_nop 0
  buffer_load_dwordx4 v190, s[56:59], s19 offen lds
  buffer_load_dwordx4 v190, s[56:59], s19 offen offset:1024 lds
  buffer_load_dwordx4 v190, s[56:59], s19 offen offset:2048 lds
  buffer_load_dwordx4 v190, s[56:59], s19 offen offset:3072 lds
  s_add_u32 s26, s26, 16384
  s_add_u32 s27, s27, 16384
  s_cmp_eq_u32 s27, s28
  s_cselect_b32 s27, s34, s27
  s_min_u32 s19, s26, s36
  s_mov_b32 m0, s27
  s_nop 0
  buffer_load_dwordx4 v190, s[56:59], s19 offen lds
  buffer_load_dwordx4 v190, s[56:59], s19 offen offset:1024 lds
  buffer_load_dwordx4 v190, s[56:59], s19 offen offset:2048 lds
  buffer_load_dwordx4 v190, s[56:59], s19 offen offset:3072 lds
  s_add_u32 s26, s26, 16384
  s_add_u32 s27, s27, 16384
  s_cmp_eq_u32 s27, s28
  s_cselect_b32 s27, s34, s27
  s_min_u32 s19, s26, s36
  s_mov_b32 m0, s27
  s_nop 0
  buffer_load_dwordx4 v190, s[56:59], s19 offen lds
  buffer_load_dwordx4 v190, s[56:59], s19 offen offset:1024 lds
  buffer_load_dwordx4 v190, s[56:59], s19 offen offset:2048 lds
  buffer_load_dwordx4 v190, s[56:59], s19 offen offset:3072 lds
  s_add_u32 s26, s26, 16384
  s_add_u32 s27, s27, 16384
  s_cmp_eq_u32 s27, s28
  s_cselect_b32 s27, s34, s27
  s_min_u32 s19, s26, s36
  s_mov_b32 m0, s27
  s_nop 0
  buffer_load_dwordx4 v190, s[56:59], s19 offen lds
  buffer_load_dwordx4 v190, s[56:59], s19 offen offset:1024 lds
  buffer_load_dwordx4 v190, s[56:59], s19 offen offset:2048 lds
  buffer_load_dwordx4 v190, s[56:59], s19 offen offset:3072 lds
  s_add_u32 s26, s26, 16384
  s_add_u32 s27, s27, 16384
  s_cmp_eq_u32 s27, s28
  s_cselect_b32 s27, s34, s27
at_kernel_idle_n2:
  s_add_u32 s48, s4, 100663296
  s_addc_u32 s49, s5, 0
  s_mov_b32 s50, 4194304
  s_mov_b32 s51, 0x20000
  s_add_u32 s52, s4, 104857600
  s_addc_u32 s53, s5, 0
  s_mov_b32 s54, 1835008
  s_mov_b32 s55, 0x20000
  s_lshl_b32 s19, s70, 9
  buffer_store_dwordx4 v[156:159], v254, s[48:51], s19 offen offset:0 sc1
  buffer_store_dwordx4 v[160:163], v254, s[48:51], s19 offen offset:128 sc1
  buffer_store_dwordx4 v[164:167], v254, s[48:51], s19 offen offset:256 sc1
  buffer_store_dwordx4 v[168:171], v254, s[48:51], s19 offen offset:384 sc1
  s_cmp_ge_u32 s70, 896
  s_cbranch_scc1 at_kernel_rl_sksa
  s_lshl_b32 s19, s70, 8
  buffer_store_dwordx4 v[172:175], v255, s[52:55], s19 offen offset:0 sc1
  buffer_store_dwordx4 v[176:179], v255, s[52:55], s19 offen offset:128 sc1
at_kernel_rl_sksa:
  s_add_u32 s48, s4, 71303168
  s_addc_u32 s49, s5, 0
  s_mov_b32 s50, 8388608
  s_mov_b32 s51, 0x20000
  v_mov_b32 v180, -1
  v_mov_b32 v181, -1
  v_mov_b32 v182, -1
  v_mov_b32 v183, -1
  s_lshl_b32 s19, s70, 13
  s_add_u32 s20, s19, 4096
  buffer_store_dwordx4 v[180:183], v190, s[48:51], s19 offen offset:0 sc1
  buffer_store_dwordx4 v[180:183], v190, s[48:51], s20 offen offset:0 sc1
  buffer_store_dwordx4 v[180:183], v190, s[48:51], s19 offen offset:1024 sc1
  buffer_store_dwordx4 v[180:183], v190, s[48:51], s20 offen offset:1024 sc1
  buffer_store_dwordx4 v[180:183], v190, s[48:51], s19 offen offset:2048 sc1
  buffer_store_dwordx4 v[180:183], v190, s[48:51], s20 offen offset:2048 sc1
  buffer_store_dwordx4 v[180:183], v190, s[48:51], s19 offen offset:3072 sc1
  buffer_store_dwordx4 v[180:183], v190, s[48:51], s20 offen offset:3072 sc1
at_kernel_rl_skpa:
  s_add_u32 s52, s4, 41943040
  s_addc_u32 s53, s5, 0
  s_mov_b32 s54, 2097152
  s_mov_b32 s55, 0x20000
  buffer_load_dwordx4 v[212:215], v190, s[52:55], s40 offen offset:0
  s_add_u32 s19, s40, 16384
  buffer_load_dwordx4 v[216:219], v190, s[52:55], s19 offen offset:0
  buffer_load_dwordx4 v[220:223], v190, s[52:55], s40 offen offset:2048
  s_add_u32 s19, s40, 16384
  buffer_load_dwordx4 v[224:227], v190, s[52:55], s19 offen offset:2048
  s_add_u32 s19, s40, 4096
  buffer_load_dwordx4 v[228:231], v190, s[52:55], s19 offen offset:0
  s_add_u32 s19, s40, 20480
  buffer_load_dwordx4 v[232:235], v190, s[52:55], s19 offen offset:0
  s_add_u32 s19, s40, 4096
  buffer_load_dwordx4 v[236:239], v190, s[52:55], s19 offen offset:2048
  s_add_u32 s19, s40, 20480
  buffer_load_dwordx4 v[240:243], v190, s[52:55], s19 offen offset:2048
  s_add_u32 s19, s40, 8192
  buffer_load_dwordx4 v[244:247], v190, s[52:55], s19 offen offset:0
  s_add_u32 s19, s40, 24576
  buffer_load_dwordx4 v[248:251], v190, s[52:55], s19 offen offset:0
at_kernel_idle_l:
  s_add_u32 s17, s17, 1
  s_cmp_gt_u32 s17, s15
  s_cbranch_scc1 at_kernel_chk
  s_cmp_eq_u32 s17, s15
  s_cbranch_scc1 at_kernel_idle_last
  s_waitcnt vmcnt(0)
  s_barrier
  s_cmp_ge_u32 s17, s15
  s_cbranch_scc1 at_kernel_idle_n1
  s_min_u32 s19, s26, s36
  s_mov_b32 m0, s27
  s_nop 0
  buffer_load_dwordx4 v190, s[56:59], s19 offen lds
  buffer_load_dwordx4 v190, s[56:59], s19 offen offset:1024 lds
  buffer_load_dwordx4 v190, s[56:59], s19 offen offset:2048 lds
  buffer_load_dwordx4 v190, s[56:59], s19 offen offset:3072 lds
  s_add_u32 s26, s26, 16384
  s_add_u32 s27, s27, 16384
  s_cmp_eq_u32 s27, s28
  s_cselect_b32 s27, s34, s27
  s_min_u32 s19, s26, s36
  s_mov_b32 m0, s27
  s_nop 0
  buffer_load_dwordx4 v190, s[56:59], s19 offen lds
  buffer_load_dwordx4 v190, s[56:59], s19 offen offset:1024 lds
  buffer_load_dwordx4 v190, s[56:59], s19 offen offset:2048 lds
  buffer_load_dwordx4 v190, s[56:59], s19 offen offset:3072 lds
  s_add_u32 s26, s26, 16384
  s_add_u32 s27, s27, 16384
  s_cmp_eq_u32 s27, s28
  s_cselect_b32 s27, s34, s27
  s_min_u32 s19, s26, s36
  s_mov_b32 m0, s27
  s_nop 0
  buffer_load_dwordx4 v190, s[56:59], s19 offen lds
  buffer_load_dwordx4 v190, s[56:59], s19 offen offset:1024 lds
  buffer_load_dwordx4 v190, s[56:59], s19 offen offset:2048 lds
  buffer_load_dwordx4 v190, s[56:59], s19 offen offset:3072 lds
  s_add_u32 s26, s26, 16384
  s_add_u32 s27, s27, 16384
  s_cmp_eq_u32 s27, s28
  s_cselect_b32 s27, s34, s27
  s_min_u32 s19, s26, s36
  s_mov_b32 m0, s27
  s_nop 0
  buffer_load_dwordx4 v190, s[56:59], s19 offen lds
  buffer_load_dwordx4 v190, s[56:59], s19 offen offset:1024 lds
  buffer_load_dwordx4 v190, s[56:59], s19 offen offset:2048 lds
  buffer_load_dwordx4 v190, s[56:59], s19 offen offset:3072 lds
  s_add_u32 s26, s26, 16384
  s_add_u32 s27, s27, 16384
  s_cmp_eq_u32 s27, s28
  s_cselect_b32 s27, s34, s27
at_kernel_idle_n1:
  s_branch at_kernel_idle_l
at_kernel_idle_last:
  s_mov_b32 s48, s8
  s_mov_b32 s49, s9
  s_mov_b32 s50, 1835008
  s_mov_b32 s51, 0x20000
  s_mov_b32 s43, s42
  s_sub_u32 s44, s10, 4
  s_lshl_b32 s44, s44, 1
  s_waitcnt vmcnt(0)
  s_barrier
  s_add_u32 s19, s44, 0
  s_lshl_b32 s20, s19, 11
  s_add_u32 m0, s20, s43
  s_mul_i32 s19, s19, 28672
  s_add_u32 s19, s19, s41
  buffer_load_dwordx4 v207, s[48:51], s19 offen lds
  buffer_load_dwordx4 v208, s[48:51], s19 offen offset:1024 lds
  s_add_u32 s19, s44, 1
  s_lshl_b32 s20, s19, 11
  s_add_u32 m0, s20, s43
  s_mul_i32 s19, s19, 28672
  s_add_u32 s19, s19, s41
  buffer_load_dwordx4 v207, s[48:51], s19 offen lds
  buffer_load_dwordx4 v208, s[48:51], s19 offen offset:1024 lds
  s_add_u32 s43, s43, 16384
  s_cmp_eq_u32 s43, 163840
  s_cselect_b32 s43, 0, s43
  s_add_u32 s19, s44, 0
  s_lshl_b32 s20, s19, 11
  s_add_u32 m0, s20, s43
  s_mul_i32 s19, s19, 28672
  s_add_u32 s19, s19, s41
  s_add_u32 s19, s19, 229376
  buffer_load_dwordx4 v207, s[48:51], s19 offen lds
  buffer_load_dwordx4 v208, s[48:51], s19 offen offset:1024 lds
  s_add_u32 s19, s44, 1
  s_lshl_b32 s20, s19, 11
  s_add_u32 m0, s20, s43
  s_mul_i32 s19, s19, 28672
  s_add_u32 s19, s19, s41
  s_add_u32 s19, s19, 229376
  buffer_load_dwordx4 v207, s[48:51], s19 offen lds
  buffer_load_dwordx4 v208, s[48:51], s19 offen offset:1024 lds
  s_add_u32 s43, s43, 16384
  s_cmp_eq_u32 s43, 163840
  s_cselect_b32 s43, 0, s43
  s_add_u32 s19, s44, 0
  s_lshl_b32 s20, s19, 11
  s_add_u32 m0, s20, s43
  s_mul_i32 s19, s19, 28672
  s_add_u32 s19, s19, s41
  s_add_u32 s19, s19, 458752
  buffer_load_dwordx4 v207, s[48:51], s19 offen lds
  buffer_load_dwordx4 v208, s[48:51], s19 offen offset:1024 lds
  s_add_u32 s19, s44, 1
  s_lshl_b32 s20, s19, 11
  s_add_u32 m0, s20, s43
  s_mul_i32 s19, s19, 28672
  s_add_u32 s19, s19, s41
  s_add_u32 s19, s19, 458752
  buffer_load_dwordx4 v207, s[48:51], s19 offen lds
  buffer_load_dwordx4 v208, s[48:51], s19 offen offset:1024 lds
  s_add_u32 s43, s43, 16384
  s_cmp_eq_u32 s43, 163840
  s_cselect_b32 s43, 0, s43
  s_add_u32 s19, s44, 0
  s_lshl_b32 s20, s19, 11
  s_add_u32 m0, s20, s43
  s_mul_i32 s19, s19, 28672
  s_add_u32 s19, s19, s41
  s_add_u32 s19, s19, 688128
  buffer_load_dwordx4 v207, s[48:51], s19 offen lds
  buffer_load_dwordx4 v208, s[48:51], s19 offen offset:1024 lds
  s_add_u32 s19, s44, 1
  s_lshl_b32 s20, s19, 11
  s_add_u32 m0, s20, s43
  s_mul_i32 s19, s19, 28672
  s_add_u32 s19, s19, s41
  s_add_u32 s19, s19, 688128
  buffer_load_dwordx4 v207, s[48:51], s19 offen lds
  buffer_load_dwordx4 v208, s[48:51], s19 offen offset:1024 lds
  s_add_u32 s43, s43, 16384
  s_cmp_eq_u32 s43, 163840
  s_cselect_b32 s43, 0, s43
  s_add_u32 s19, s44, 0
  s_lshl_b32 s20, s19, 11
  s_add_u32 m0, s20, s43
  s_mul_i32 s19, s19, 28672
  s_add_u32 s19, s19, s41
  s_add_u32 s19, s19, 917504
  buffer_load_dwordx4 v207, s[48:51], s19 offen lds
  buffer_load_dwordx4 v208, s[48:51], s19 offen offset:1024 lds
  s_add_u32 s19, s44, 1
  s_lshl_b32 s20, s19, 11
  s_add_u32 m0, s20, s43
  s_mul_i32 s19, s19, 28672
  s_add_u32 s19, s19, s41
  s_add_u32 s19, s19, 917504
  buffer_load_dwordx4 v207, s[48:51], s19 offen lds
  buffer_load_dwordx4 v208, s[48:51], s19 offen offset:1024 lds
  s_add_u32 s43, s43, 16384
  s_cmp_eq_u32 s43, 163840
  s_cselect_b32 s43, 0, s43
  s_waitcnt vmcnt(0)
  s_branch at_kernel_chk
at_kernel_rl_only:
  s_add_u32 s48, s4, 100663296
  s_addc_u32 s49, s5, 0
  s_mov_b32 s50, 4194304
  s_mov_b32 s51, 0x20000
  s_add_u32 s52, s4, 104857600
  s_addc_u32 s53, s5, 0
  s_mov_b32 s54, 1835008
  s_mov_b32 s55, 0x20000
  s_lshl_b32 s19, s70, 9
  s_waitcnt vmcnt(11)
  buffer_store_dwordx4 v[156:159], v254, s[48:51], s19 offen offset:0 sc1
  s_waitcnt vmcnt(11)
  buffer_store_dwordx4 v[160:163], v254, s[48:51], s19 offen offset:128 sc1
  s_waitcnt vmcnt(11)
  buffer_store_dwordx4 v[164:167], v254, s[48:51], s19 offen offset:256 sc1
  s_waitcnt vmcnt(11)
  buffer_store_dwordx4 v[168:171], v254, s[48:51], s19 offen offset:384 sc1
  s_cmp_ge_u32 s70, 896
  s_cbranch_scc1 at_kernel_rl_sksb
  s_lshl_b32 s19, s70, 8
  buffer_store_dwordx4 v[172:175], v255, s[52:55], s19 offen offset:0 sc1
  buffer_store_dwordx4 v[176:179], v255, s[52:55], s19 offen offset:128 sc1
at_kernel_rl_sksb:
  s_add_u32 s48, s4, 71303168
  s_addc_u32 s49, s5, 0
  s_mov_b32 s50, 8388608
  s_mov_b32 s51, 0x20000
  v_mov_b32 v180, -1
  v_mov_b32 v181, -1
  v_mov_b32 v182, -1
  v_mov_b32 v183, -1
  s_lshl_b32 s19, s70, 13
  s_add_u32 s20, s19, 4096
  buffer_store_dwordx4 v[180:183], v190, s[48:51], s19 offen offset:0 sc1
  buffer_store_dwordx4 v[180:183], v190, s[48:51], s20 offen offset:0 sc1
  buffer_store_dwordx4 v[180:183], v190, s[48:51], s19 offen offset:1024 sc1
  buffer_store_dwordx4 v[180:183], v190, s[48:51], s20 offen offset:1024 sc1
  buffer_store_dwordx4 v[180:183], v190, s[48:51], s19 offen offset:2048 sc1
  buffer_store_dwordx4 v[180:183], v190, s[48:51], s20 offen offset:2048 sc1
  buffer_store_dwordx4 v[180:183], v190, s[48:51], s19 offen offset:3072 sc1
  buffer_store_dwordx4 v[180:183], v190, s[48:51], s20 offen offset:3072 sc1
at_kernel_rl_skpb:
at_kernel_chk:
  s_barrier
  v_mov_b32 v2, s37
  s_lshl_b32 s20, s10, 2
  s_add_u32 s20, s20, s45
  v_mov_b32 v3, s20
  ds_write_b32 v3, v2
  s_waitcnt lgkmcnt(0)
  s_barrier
  v_and_b32 v3, 7, v1
  v_lshlrev_b32 v3, 2, v3
  v_add_u32 v3, s45, v3
  ds_read_b32 v2, v3
  s_waitcnt lgkmcnt(0)
  v_cmp_ne_u32 vcc, 0, v2
  s_cmp_lg_u64 vcc, 0
  s_cbranch_scc1 at_kernel_safe
  s_cmp_eq_u32 s12, 7
  s_cbranch_scc0 at_kernel_b3pre
  s_cmp_ge_u32 s10, 4
  s_cbranch_scc1 at_kernel_fin
  v_rcp_f32 v199, v197
  s_lshl_b32 s19, s13, 18
  s_lshl_b32 s20, s11, 12
  s_add_u32 s19, s19, s20
  v_mov_b32 v252, v199
  v_mov_b32 v253, v199
  v_pk_mul_f32 v[4:5], v[4:5], v[252:253]
  v_pk_mul_f32 v[6:7], v[6:7], v[252:253]
  v_pk_mul_f32 v[8:9], v[8:9], v[252:253]
  v_pk_mul_f32 v[10:11], v[10:11], v[252:253]
  v_pk_mul_f32 v[12:13], v[12:13], v[252:253]
  v_pk_mul_f32 v[14:15], v[14:15], v[252:253]
  v_pk_mul_f32 v[16:17], v[16:17], v[252:253]
  v_pk_mul_f32 v[18:19], v[18:19], v[252:253]
  v_cvt_pk_bf16_f32 v68, v4, v5
  v_cvt_pk_bf16_f32 v69, v6, v7
  v_cvt_pk_bf16_f32 v70, v8, v9
  v_cvt_pk_bf16_f32 v71, v10, v11
  buffer_store_dwordx4 v[68:71], v202, s[60:63], s19 offen offset:0 sc1
  v_cvt_pk_bf16_f32 v72, v12, v13
  v_cvt_pk_bf16_f32 v73, v14, v15
  v_cvt_pk_bf16_f32 v74, v16, v17
  v_cvt_pk_bf16_f32 v75, v18, v19
  buffer_store_dwordx4 v[72:75], v202, s[60:63], s19 offen offset:512 sc1
  v_pk_mul_f32 v[20:21], v[20:21], v[252:253]
  v_pk_mul_f32 v[22:23], v[22:23], v[252:253]
  v_pk_mul_f32 v[24:25], v[24:25], v[252:253]
  v_pk_mul_f32 v[26:27], v[26:27], v[252:253]
  v_pk_mul_f32 v[28:29], v[28:29], v[252:253]
  v_pk_mul_f32 v[30:31], v[30:31], v[252:253]
  v_pk_mul_f32 v[32:33], v[32:33], v[252:253]
  v_pk_mul_f32 v[34:35], v[34:35], v[252:253]
  v_cvt_pk_bf16_f32 v76, v20, v21
  v_cvt_pk_bf16_f32 v77, v22, v23
  v_cvt_pk_bf16_f32 v78, v24, v25
  v_cvt_pk_bf16_f32 v79, v26, v27
  buffer_store_dwordx4 v[76:79], v202, s[60:63], s19 offen offset:1024 sc1
  v_cvt_pk_bf16_f32 v80, v28, v29
  v_cvt_pk_bf16_f32 v81, v30, v31
  v_cvt_pk_bf16_f32 v82, v32, v33
  v_cvt_pk_bf16_f32 v83, v34, v35
  buffer_store_dwordx4 v[80:83], v202, s[60:63], s19 offen offset:1536 sc1
  v_pk_mul_f32 v[36:37], v[36:37], v[252:253]
  v_pk_mul_f32 v[38:39], v[38:39], v[252:253]
  v_pk_mul_f32 v[40:41], v[40:41], v[252:253]
  v_pk_mul_f32 v[42:43], v[42:43], v[252:253]
  v_pk_mul_f32 v[44:45], v[44:45], v[252:253]
  v_pk_mul_f32 v[46:47], v[46:47], v[252:253]
  v_pk_mul_f32 v[48:49], v[48:49], v[252:253]
  v_pk_mul_f32 v[50:51], v[50:51], v[252:253]
  v_cvt_pk_bf16_f32 v84, v36, v37
  v_cvt_pk_bf16_f32 v85, v38, v39
  v_cvt_pk_bf16_f32 v86, v40, v41
  v_cvt_pk_bf16_f32 v87, v42, v43
  buffer_store_dwordx4 v[84:87], v202, s[60:63], s19 offen offset:2048 sc1
  v_cvt_pk_bf16_f32 v88, v44, v45
  v_cvt_pk_bf16_f32 v89, v46, v47
  v_cvt_pk_bf16_f32 v90, v48, v49
  v_cvt_pk_bf16_f32 v91, v50, v51
  buffer_store_dwordx4 v[88:91], v202, s[60:63], s19 offen offset:2560 sc1
  v_pk_mul_f32 v[52:53], v[52:53], v[252:253]
  v_pk_mul_f32 v[54:55], v[54:55], v[252:253]
  v_pk_mul_f32 v[56:57], v[56:57], v[252:253]
  v_pk_mul_f32 v[58:59], v[58:59], v[252:253]
  v_pk_mul_f32 v[60:61], v[60:61], v[252:253]
  v_pk_mul_f32 v[62:63], v[62:63], v[252:253]
  v_pk_mul_f32 v[64:65], v[64:65], v[252:253]
  v_pk_mul_f32 v[66:67], v[66:67], v[252:253]
  v_cvt_pk_bf16_f32 v92, v52, v53
  v_cvt_pk_bf16_f32 v93, v54, v55
  v_cvt_pk_bf16_f32 v94, v56, v57
  v_cvt_pk_bf16_f32 v95, v58, v59
  buffer_store_dwordx4 v[92:95], v202, s[60:63], s19 offen offset:3072 sc1
  v_cvt_pk_bf16_f32 v96, v60, v61
  v_cvt_pk_bf16_f32 v97, v62, v63
  v_cvt_pk_bf16_f32 v98, v64, v65
  v_cvt_pk_bf16_f32 v99, v66, v67
  buffer_store_dwordx4 v[96:99], v202, s[60:63], s19 offen offset:3584 sc1
  s_branch at_kernel_fin
at_kernel_b3pre:
  s_cmp_ge_u32 s10, 4
  s_cbranch_scc1 at_kernel_nopack
  v_rcp_f32 v199, v197
  s_lshl_b32 s19, s13, 18
  s_lshl_b32 s20, s11, 12
  s_add_u32 s31, s19, s20
  v_mov_b32 v252, v199
  v_mov_b32 v253, v199
  v_pk_mul_f32 v[4:5], v[4:5], v[252:253]
  v_pk_mul_f32 v[6:7], v[6:7], v[252:253]
  v_pk_mul_f32 v[8:9], v[8:9], v[252:253]
  v_pk_mul_f32 v[10:11], v[10:11], v[252:253]
  v_pk_mul_f32 v[12:13], v[12:13], v[252:253]
  v_pk_mul_f32 v[14:15], v[14:15], v[252:253]
  v_pk_mul_f32 v[16:17], v[16:17], v[252:253]
  v_pk_mul_f32 v[18:19], v[18:19], v[252:253]
  v_cvt_pk_bf16_f32 v140, v4, v5
  v_cvt_pk_bf16_f32 v141, v6, v7
  v_cvt_pk_bf16_f32 v142, v8, v9
  v_cvt_pk_bf16_f32 v143, v10, v11
  v_cvt_pk_bf16_f32 v144, v12, v13
  v_cvt_pk_bf16_f32 v145, v14, v15
  v_cvt_pk_bf16_f32 v146, v16, v17
  v_cvt_pk_bf16_f32 v147, v18, v19
  v_pk_mul_f32 v[20:21], v[20:21], v[252:253]
  v_pk_mul_f32 v[22:23], v[22:23], v[252:253]
  v_pk_mul_f32 v[24:25], v[24:25], v[252:253]
  v_pk_mul_f32 v[26:27], v[26:27], v[252:253]
  v_pk_mul_f32 v[28:29], v[28:29], v[252:253]
  v_pk_mul_f32 v[30:31], v[30:31], v[252:253]
  v_pk_mul_f32 v[32:33], v[32:33], v[252:253]
  v_pk_mul_f32 v[34:35], v[34:35], v[252:253]
  v_cvt_pk_bf16_f32 v148, v20, v21
  v_cvt_pk_bf16_f32 v149, v22, v23
  v_cvt_pk_bf16_f32 v150, v24, v25
  v_cvt_pk_bf16_f32 v151, v26, v27
  v_cvt_pk_bf16_f32 v152, v28, v29
  v_cvt_pk_bf16_f32 v153, v30, v31
  v_cvt_pk_bf16_f32 v154, v32, v33
  v_cvt_pk_bf16_f32 v155, v34, v35
  v_pk_mul_f32 v[36:37], v[36:37], v[252:253]
  v_pk_mul_f32 v[38:39], v[38:39], v[252:253]
  v_pk_mul_f32 v[40:41], v[40:41], v[252:253]
  v_pk_mul_f32 v[42:43], v[42:43], v[252:253]
  v_pk_mul_f32 v[44:45], v[44:45], v[252:253]
  v_pk_mul_f32 v[46:47], v[46:47], v[252:253]
  v_pk_mul_f32 v[48:49], v[48:49], v[252:253]
  v_pk_mul_f32 v[50:51], v[50:51], v[252:253]
  v_cvt_pk_bf16_f32 v180, v36, v37
  v_cvt_pk_bf16_f32 v181, v38, v39
  v_cvt_pk_bf16_f32 v182, v40, v41
  v_cvt_pk_bf16_f32 v183, v42, v43
  v_cvt_pk_bf16_f32 v184, v44, v45
  v_cvt_pk_bf16_f32 v185, v46, v47
  v_cvt_pk_bf16_f32 v186, v48, v49
  v_cvt_pk_bf16_f32 v187, v50, v51
  v_pk_mul_f32 v[52:53], v[52:53], v[252:253]
  v_pk_mul_f32 v[54:55], v[54:55], v[252:253]
  v_pk_mul_f32 v[56:57], v[56:57], v[252:253]
  v_pk_mul_f32 v[58:59], v[58:59], v[252:253]
  v_pk_mul_f32 v[60:61], v[60:61], v[252:253]
  v_pk_mul_f32 v[62:63], v[62:63], v[252:253]
  v_pk_mul_f32 v[64:65], v[64:65], v[252:253]
  v_pk_mul_f32 v[66:67], v[66:67], v[252:253]
  v_cvt_pk_bf16_f32 v120, v52, v53
  v_cvt_pk_bf16_f32 v121, v54, v55
  v_cvt_pk_bf16_f32 v122, v56, v57
  v_cvt_pk_bf16_f32 v123, v58, v59
  v_cvt_pk_bf16_f32 v252, v60, v61
  v_cvt_pk_bf16_f32 v253, v62, v63
  v_cvt_pk_bf16_f32 v254, v64, v65
  v_cvt_pk_bf16_f32 v255, v66, v67
  s_branch at_kernel_b3go
at_kernel_nopack:
  v_mov_b32 v202, 0x40000000
  s_mov_b32 s31, 0
at_kernel_b3go:
  v_and_b32 v195, 15, v1
  v_lshrrev_b32 v196, 4, v1
  s_lshr_b32 s29, s10, 2
  s_add_u32 s56, s4, 44040192
  s_addc_u32 s57, s5, 0
  s_mov_b32 s58, 262144
  s_mov_b32 s59, 0x20000
  v_lshlrev_b32 v2, 7, v195
  v_lshl_add_u32 v2, v196, 5, v2
  s_lshl_b32 s19, s39, 11
  buffer_load_dwordx4 v[124:127], v2, s[56:59], s19 offen offset:0
  buffer_load_dwordx4 v[128:131], v2, s[56:59], s19 offen offset:16
  buffer_load_dwordx4 v[132:135], v2, s[56:59], s19 offen offset:2048
  buffer_load_dwordx4 v[136:139], v2, s[56:59], s19 offen offset:2064
  v_lshrrev_b32 v2, 2, v195
  v_lshl_add_u32 v2, v196, 2, v2
  v_and_b32 v3, 7, v2
  v_xor_b32 v3, s10, v3
  v_lshlrev_b32 v2, 8, v2
  v_and_b32 v100, 3, v1
  v_lshl_add_u32 v2, v100, 3, v2
  s_mul_i32 s19, s29, 8192
  s_add_u32 s19, s19, s42
  v_add_u32 v2, s19, v2
  v_xor_b32 v100, 0, v3
  v_lshl_add_u32 v100, v100, 5, v2
  v_xor_b32 v101, 1, v3
  v_lshl_add_u32 v101, v101, 5, v2
  v_xor_b32 v102, 2, v3
  v_lshl_add_u32 v102, v102, 5, v2
  v_xor_b32 v103, 3, v3
  v_lshl_add_u32 v103, v103, 5, v2
  v_xor_b32 v104, 4, v3
  v_lshl_add_u32 v104, v104, 5, v2
  v_xor_b32 v105, 5, v3
  v_lshl_add_u32 v105, v105, 5, v2
  v_xor_b32 v106, 6, v3
  v_lshl_add_u32 v106, v106, 5, v2
  v_xor_b32 v107, 7, v3
  v_lshl_add_u32 v107, v107, 5, v2
  v_mov_b32 v116, 0x3f803f80
  v_mov_b32 v117, 0x3f803f80
  v_mov_b32 v118, 0x3f803f80
  v_mov_b32 v119, 0x3f803f80
  s_mov_b32 s43, s42
  s_add_u32 s26, s42, 81920
  s_sub_u32 s19, s26, 163840
  s_cmp_ge_u32 s26, 163840
  s_cselect_b32 s26, s19, s26
  s_add_u32 s27, s42, 98304
  s_sub_u32 s19, s27, 163840
  s_cmp_ge_u32 s27, 163840
  s_cselect_b32 s27, s19, s27
  s_add_u32 s28, s42, 114688
  s_sub_u32 s19, s28, 163840
  s_cmp_ge_u32 s28, 163840
  s_cselect_b32 s28, s19, s28
  ds_read_b64_tr_b16 v[68:69], v100 offset:0
  ds_read_b64_tr_b16 v[70:71], v100 offset:4096
  ds_read_b64_tr_b16 v[72:73], v101 offset:0
  ds_read_b64_tr_b16 v[74:75], v101 offset:4096
  ds_read_b64_tr_b16 v[76:77], v102 offset:0
  ds_read_b64_tr_b16 v[78:79], v102 offset:4096
  ds_read_b64_tr_b16 v[80:81], v103 offset:0
  ds_read_b64_tr_b16 v[82:83], v103 offset:4096
  ds_read_b64_tr_b16 v[84:85], v104 offset:0
  ds_read_b64_tr_b16 v[86:87], v104 offset:4096
  ds_read_b64_tr_b16 v[88:89], v105 offset:0
  ds_read_b64_tr_b16 v[90:91], v105 offset:4096
  ds_read_b64_tr_b16 v[92:93], v106 offset:0
  ds_read_b64_tr_b16 v[94:95], v106 offset:4096
  s_waitcnt vmcnt(13) lgkmcnt(12)
  v_mfma_f32_16x16x32_bf16 v[4:7], v[68:71], v[212:215], 0
  s_waitcnt vmcnt(12)
  v_mfma_f32_16x16x32_bf16 v[36:39], v[68:71], v[216:219], 0
  v_mfma_f32_16x16x32_bf16 v[108:111], v[68:71], v[116:119], 0
  ds_read_b64_tr_b16 v[96:97], v107 offset:0
  ds_read_b64_tr_b16 v[98:99], v107 offset:4096
  s_waitcnt lgkmcnt(12)
  v_mfma_f32_16x16x32_bf16 v[8:11], v[72:75], v[212:215], 0
  v_mfma_f32_16x16x32_bf16 v[40:43], v[72:75], v[216:219], 0
  s_mov_b32 s44, s43
  s_add_u32 s43, s43, 16384
  s_cmp_eq_u32 s43, 163840
  s_cselect_b32 s43, 0, s43
  s_sub_u32 s44, s43, s44
  v_add_u32 v100, s44, v100
  v_add_u32 v101, s44, v101
  v_add_u32 v102, s44, v102
  v_add_u32 v103, s44, v103
  v_add_u32 v104, s44, v104
  v_add_u32 v105, s44, v105
  v_add_u32 v106, s44, v106
  v_add_u32 v107, s44, v107
  ds_read_b64_tr_b16 v[68:69], v100 offset:0
  ds_read_b64_tr_b16 v[70:71], v100 offset:4096
  s_add_u32 s19, s10, 0
  s_lshl_b32 s20, s19, 11
  s_add_u32 m0, s20, s26
  s_mul_i32 s19, s19, 28672
  s_add_u32 s19, s19, s41
  s_add_u32 s19, s19, 1146880
  buffer_load_dwordx4 v207, s[48:51], s19 offen lds
  buffer_load_dwordx4 v208, s[48:51], s19 offen offset:1024 lds
  s_waitcnt lgkmcnt(12)
  v_mfma_f32_16x16x32_bf16 v[12:15], v[76:79], v[212:215], 0
  v_mfma_f32_16x16x32_bf16 v[44:47], v[76:79], v[216:219], 0
  ds_read_b64_tr_b16 v[72:73], v101 offset:0
  ds_read_b64_tr_b16 v[74:75], v101 offset:4096
  s_waitcnt lgkmcnt(12)
  v_mfma_f32_16x16x32_bf16 v[16:19], v[80:83], v[212:215], 0
  v_mfma_f32_16x16x32_bf16 v[48:51], v[80:83], v[216:219], 0
  ds_read_b64_tr_b16 v[76:77], v102 offset:0
  ds_read_b64_tr_b16 v[78:79], v102 offset:4096
  s_waitcnt lgkmcnt(12)
  v_mfma_f32_16x16x32_bf16 v[20:23], v[84:87], v[212:215], 0
  v_mfma_f32_16x16x32_bf16 v[52:55], v[84:87], v[216:219], 0
  v_mfma_f32_16x16x32_bf16 v[112:115], v[84:87], v[116:119], 0
  ds_read_b64_tr_b16 v[80:81], v103 offset:0
  ds_read_b64_tr_b16 v[82:83], v103 offset:4096
  s_add_u32 s19, s40, 8192
  buffer_load_dwordx4 v[156:159], v190, s[52:55], s19 offen offset:2048
  s_waitcnt lgkmcnt(12)
  v_mfma_f32_16x16x32_bf16 v[24:27], v[88:91], v[212:215], 0
  v_mfma_f32_16x16x32_bf16 v[56:59], v[88:91], v[216:219], 0
  ds_read_b64_tr_b16 v[84:85], v104 offset:0
  ds_read_b64_tr_b16 v[86:87], v104 offset:4096
  s_waitcnt lgkmcnt(12)
  v_mfma_f32_16x16x32_bf16 v[28:31], v[92:95], v[212:215], 0
  v_mfma_f32_16x16x32_bf16 v[60:63], v[92:95], v[216:219], 0
  ds_read_b64_tr_b16 v[88:89], v105 offset:0
  ds_read_b64_tr_b16 v[90:91], v105 offset:4096
  s_add_u32 s19, s40, 24576
  buffer_load_dwordx4 v[160:163], v190, s[52:55], s19 offen offset:2048
  s_waitcnt lgkmcnt(12)
  v_mfma_f32_16x16x32_bf16 v[32:35], v[96:99], v[212:215], 0
  v_mfma_f32_16x16x32_bf16 v[64:67], v[96:99], v[216:219], 0
  ds_read_b64_tr_b16 v[92:93], v106 offset:0
  ds_read_b64_tr_b16 v[94:95], v106 offset:4096
  s_waitcnt vmcnt(15) lgkmcnt(12)
  v_mfma_f32_16x16x32_bf16 v[4:7], v[68:71], v[220:223], v[4:7]
  s_waitcnt vmcnt(14)
  v_mfma_f32_16x16x32_bf16 v[36:39], v[68:71], v[224:227], v[36:39]
  v_mfma_f32_16x16x32_bf16 v[108:111], v[68:71], v[116:119], v[108:111]
  ds_read_b64_tr_b16 v[96:97], v107 offset:0
  ds_read_b64_tr_b16 v[98:99], v107 offset:4096
  s_waitcnt lgkmcnt(12)
  v_mfma_f32_16x16x32_bf16 v[8:11], v[72:75], v[220:223], v[8:11]
  v_mfma_f32_16x16x32_bf16 v[40:43], v[72:75], v[224:227], v[40:43]
  s_mov_b32 s44, s43
  s_add_u32 s43, s43, 16384
  s_cmp_eq_u32 s43, 163840
  s_cselect_b32 s43, 0, s43
  s_sub_u32 s44, s43, s44
  v_add_u32 v100, s44, v100
  v_add_u32 v101, s44, v101
  v_add_u32 v102, s44, v102
  v_add_u32 v103, s44, v103
  v_add_u32 v104, s44, v104
  v_add_u32 v105, s44, v105
  v_add_u32 v106, s44, v106
  v_add_u32 v107, s44, v107
  ds_read_b64_tr_b16 v[68:69], v100 offset:0
  ds_read_b64_tr_b16 v[70:71], v100 offset:4096
  s_add_u32 s19, s10, 0
  s_lshl_b32 s20, s19, 11
  s_add_u32 m0, s20, s27
  s_mul_i32 s19, s19, 28672
  s_add_u32 s19, s19, s41
  s_add_u32 s19, s19, 1376256
  buffer_load_dwordx4 v207, s[48:51], s19 offen lds
  buffer_load_dwordx4 v208, s[48:51], s19 offen offset:1024 lds
  s_waitcnt lgkmcnt(12)
  v_mfma_f32_16x16x32_bf16 v[12:15], v[76:79], v[220:223], v[12:15]
  v_mfma_f32_16x16x32_bf16 v[44:47], v[76:79], v[224:227], v[44:47]
  ds_read_b64_tr_b16 v[72:73], v101 offset:0
  ds_read_b64_tr_b16 v[74:75], v101 offset:4096
  s_waitcnt lgkmcnt(12)
  v_mfma_f32_16x16x32_bf16 v[16:19], v[80:83], v[220:223], v[16:19]
  v_mfma_f32_16x16x32_bf16 v[48:51], v[80:83], v[224:227], v[48:51]
  ds_read_b64_tr_b16 v[76:77], v102 offset:0
  ds_read_b64_tr_b16 v[78:79], v102 offset:4096
  s_waitcnt lgkmcnt(12)
  v_mfma_f32_16x16x32_bf16 v[20:23], v[84:87], v[220:223], v[20:23]
  v_mfma_f32_16x16x32_bf16 v[52:55], v[84:87], v[224:227], v[52:55]
  v_mfma_f32_16x16x32_bf16 v[112:115], v[84:87], v[116:119], v[112:115]
  ds_read_b64_tr_b16 v[80:81], v103 offset:0
  ds_read_b64_tr_b16 v[82:83], v103 offset:4096
  s_add_u32 s19, s40, 12288
  buffer_load_dwordx4 v[164:167], v190, s[52:55], s19 offen offset:0
  s_waitcnt lgkmcnt(12)
  v_mfma_f32_16x16x32_bf16 v[24:27], v[88:91], v[220:223], v[24:27]
  v_mfma_f32_16x16x32_bf16 v[56:59], v[88:91], v[224:227], v[56:59]
  ds_read_b64_tr_b16 v[84:85], v104 offset:0
  ds_read_b64_tr_b16 v[86:87], v104 offset:4096
  s_waitcnt lgkmcnt(12)
  v_mfma_f32_16x16x32_bf16 v[28:31], v[92:95], v[220:223], v[28:31]
  v_mfma_f32_16x16x32_bf16 v[60:63], v[92:95], v[224:227], v[60:63]
  ds_read_b64_tr_b16 v[88:89], v105 offset:0
  ds_read_b64_tr_b16 v[90:91], v105 offset:4096
  s_add_u32 s19, s40, 28672
  buffer_load_dwordx4 v[168:171], v190, s[52:55], s19 offen offset:0
  s_waitcnt lgkmcnt(12)
  v_mfma_f32_16x16x32_bf16 v[32:35], v[96:99], v[220:223], v[32:35]
  v_mfma_f32_16x16x32_bf16 v[64:67], v[96:99], v[224:227], v[64:67]
  ds_read_b64_tr_b16 v[92:93], v106 offset:0
  ds_read_b64_tr_b16 v[94:95], v106 offset:4096
  s_waitcnt vmcnt(11)
  v_add_f32 v199, v124, v126
  s_waitcnt vmcnt(9)
  v_add_f32 v198, v132, v134
  s_waitcnt lgkmcnt(12)
  v_mfma_f32_16x16x32_bf16 v[4:7], v[68:71], v[228:231], v[4:7]
  v_mfma_f32_16x16x32_bf16 v[36:39], v[68:71], v[232:235], v[36:39]
  v_mfma_f32_16x16x32_bf16 v[108:111], v[68:71], v[116:119], v[108:111]
  ds_read_b64_tr_b16 v[96:97], v107 offset:0
  ds_read_b64_tr_b16 v[98:99], v107 offset:4096
  v_add_f32 v199, v199, v128
  s_waitcnt vmcnt(8)
  v_add_f32 v198, v198, v136
  s_waitcnt lgkmcnt(12)
  v_mfma_f32_16x16x32_bf16 v[8:11], v[72:75], v[228:231], v[8:11]
  v_mfma_f32_16x16x32_bf16 v[40:43], v[72:75], v[232:235], v[40:43]
  s_mov_b32 s44, s43
  s_add_u32 s43, s43, 16384
  s_cmp_eq_u32 s43, 163840
  s_cselect_b32 s43, 0, s43
  s_sub_u32 s44, s43, s44
  v_add_u32 v100, s44, v100
  v_add_u32 v101, s44, v101
  v_add_u32 v102, s44, v102
  v_add_u32 v103, s44, v103
  v_add_u32 v104, s44, v104
  v_add_u32 v105, s44, v105
  v_add_u32 v106, s44, v106
  v_add_u32 v107, s44, v107
  ds_read_b64_tr_b16 v[68:69], v100 offset:0
  ds_read_b64_tr_b16 v[70:71], v100 offset:4096
  s_add_u32 s19, s10, 0
  s_lshl_b32 s20, s19, 11
  s_add_u32 m0, s20, s28
  s_mul_i32 s19, s19, 28672
  s_add_u32 s19, s19, s41
  s_add_u32 s19, s19, 1605632
  buffer_load_dwordx4 v207, s[48:51], s19 offen lds
  buffer_load_dwordx4 v208, s[48:51], s19 offen offset:1024 lds
  v_add_f32 v199, v199, v130
  v_add_f32 v198, v198, v138
  s_waitcnt lgkmcnt(12)
  v_mfma_f32_16x16x32_bf16 v[12:15], v[76:79], v[228:231], v[12:15]
  v_mfma_f32_16x16x32_bf16 v[44:47], v[76:79], v[232:235], v[44:47]
  ds_read_b64_tr_b16 v[72:73], v101 offset:0
  ds_read_b64_tr_b16 v[74:75], v101 offset:4096
  v_mov_b32 v2, v199
  v_mov_b32 v3, v198
  s_waitcnt lgkmcnt(12)
  v_mfma_f32_16x16x32_bf16 v[16:19], v[80:83], v[228:231], v[16:19]
  v_mfma_f32_16x16x32_bf16 v[48:51], v[80:83], v[232:235], v[48:51]
  ds_read_b64_tr_b16 v[76:77], v102 offset:0
  ds_read_b64_tr_b16 v[78:79], v102 offset:4096
  v_permlane16_swap_b32 v2, v199
  v_permlane16_swap_b32 v3, v198
  s_waitcnt lgkmcnt(12)
  v_mfma_f32_16x16x32_bf16 v[20:23], v[84:87], v[228:231], v[20:23]
  v_mfma_f32_16x16x32_bf16 v[52:55], v[84:87], v[232:235], v[52:55]
  v_mfma_f32_16x16x32_bf16 v[112:115], v[84:87], v[116:119], v[112:115]
  ds_read_b64_tr_b16 v[80:81], v103 offset:0
  ds_read_b64_tr_b16 v[82:83], v103 offset:4096
  s_add_u32 s19, s40, 12288
  buffer_load_dwordx4 v[172:175], v190, s[52:55], s19 offen offset:2048
  v_add_f32 v199, v199, v2
  v_add_f32 v198, v198, v3
  s_waitcnt lgkmcnt(12)
  v_mfma_f32_16x16x32_bf16 v[24:27], v[88:91], v[228:231], v[24:27]
  v_mfma_f32_16x16x32_bf16 v[56:59], v[88:91], v[232:235], v[56:59]
  ds_read_b64_tr_b16 v[84:85], v104 offset:0
  ds_read_b64_tr_b16 v[86:87], v104 offset:4096
  v_mov_b32 v2, v199
  v_mov_b32 v3, v198
  s_waitcnt lgkmcnt(12)
  v_mfma_f32_16x16x32_bf16 v[28:31], v[92:95], v[228:231], v[28:31]
  v_mfma_f32_16x16x32_bf16 v[60:63], v[92:95], v[232:235], v[60:63]
  ds_read_b64_tr_b16 v[88:89], v105 offset:0
  ds_read_b64_tr_b16 v[90:91], v105 offset:4096
  s_add_u32 s19, s40, 28672
  buffer_load_dwordx4 v[176:179], v190, s[52:55], s19 offen offset:2048
  v_permlane32_swap_b32 v2, v199
  v_permlane32_swap_b32 v3, v198
  s_waitcnt lgkmcnt(12)
  v_mfma_f32_16x16x32_bf16 v[32:35], v[96:99], v[228:231], v[32:35]
  v_mfma_f32_16x16x32_bf16 v[64:67], v[96:99], v[232:235], v[64:67]
  ds_read_b64_tr_b16 v[92:93], v106 offset:0
  ds_read_b64_tr_b16 v[94:95], v106 offset:4096
  v_add_f32 v199, v199, v2
  v_add_f32 v198, v198, v3
  s_waitcnt lgkmcnt(12)
  v_mfma_f32_16x16x32_bf16 v[4:7], v[68:71], v[236:239], v[4:7]
  v_mfma_f32_16x16x32_bf16 v[36:39], v[68:71], v[240:243], v[36:39]
  v_mfma_f32_16x16x32_bf16 v[108:111], v[68:71], v[116:119], v[108:111]
  ds_read_b64_tr_b16 v[96:97], v107 offset:0
  ds_read_b64_tr_b16 v[98:99], v107 offset:4096
  v_mul_f32 v199, 0xbd800000, v199
  v_mul_f32 v198, 0xbd800000, v198
  s_waitcnt lgkmcnt(12)
  v_mfma_f32_16x16x32_bf16 v[8:11], v[72:75], v[236:239], v[8:11]
  v_mfma_f32_16x16x32_bf16 v[40:43], v[72:75], v[240:243], v[40:43]
  s_mov_b32 s44, s43
  s_add_u32 s43, s43, 16384
  s_cmp_eq_u32 s43, 163840
  s_cselect_b32 s43, 0, s43
  s_sub_u32 s44, s43, s44
  v_add_u32 v100, s44, v100
  v_add_u32 v101, s44, v101
  v_add_u32 v102, s44, v102
  v_add_u32 v103, s44, v103
  v_add_u32 v104, s44, v104
  v_add_u32 v105, s44, v105
  v_add_u32 v106, s44, v106
  v_add_u32 v107, s44, v107
  ds_read_b64_tr_b16 v[68:69], v100 offset:0
  ds_read_b64_tr_b16 v[70:71], v100 offset:4096
  v_add_f32 v124, v124, v199
  v_add_f32 v132, v132, v198
  s_waitcnt lgkmcnt(12)
  v_mfma_f32_16x16x32_bf16 v[12:15], v[76:79], v[236:239], v[12:15]
  v_mfma_f32_16x16x32_bf16 v[44:47], v[76:79], v[240:243], v[44:47]
  ds_read_b64_tr_b16 v[72:73], v101 offset:0
  ds_read_b64_tr_b16 v[74:75], v101 offset:4096
  buffer_store_dwordx4 v[140:143], v202, s[60:63], s31 offen offset:0 sc1
  v_add_f32 v126, v126, v199
  v_add_f32 v134, v134, v198
  s_waitcnt lgkmcnt(12)
  v_mfma_f32_16x16x32_bf16 v[16:19], v[80:83], v[236:239], v[16:19]
  v_mfma_f32_16x16x32_bf16 v[48:51], v[80:83], v[240:243], v[48:51]
  ds_read_b64_tr_b16 v[76:77], v102 offset:0
  ds_read_b64_tr_b16 v[78:79], v102 offset:4096
  v_add_f32 v128, v128, v199
  v_add_f32 v136, v136, v198
  s_waitcnt lgkmcnt(12)
  v_mfma_f32_16x16x32_bf16 v[20:23], v[84:87], v[236:239], v[20:23]
  v_mfma_f32_16x16x32_bf16 v[52:55], v[84:87], v[240:243], v[52:55]
  v_mfma_f32_16x16x32_bf16 v[112:115], v[84:87], v[116:119], v[112:115]
  ds_read_b64_tr_b16 v[80:81], v103 offset:0
  ds_read_b64_tr_b16 v[82:83], v103 offset:4096
  v_add_f32 v130, v130, v199
  v_add_f32 v138, v138, v198
  s_waitcnt lgkmcnt(12)
  v_mfma_f32_16x16x32_bf16 v[24:27], v[88:91], v[236:239], v[24:27]
  v_mfma_f32_16x16x32_bf16 v[56:59], v[88:91], v[240:243], v[56:59]
  ds_read_b64_tr_b16 v[84:85], v104 offset:0
  ds_read_b64_tr_b16 v[86:87], v104 offset:4096
  v_mul_f32 v197, v124, v124
  v_mul_f32 v201, v132, v132
  s_waitcnt lgkmcnt(12)
  v_mfma_f32_16x16x32_bf16 v[28:31], v[92:95], v[236:239], v[28:31]
  v_mfma_f32_16x16x32_bf16 v[60:63], v[92:95], v[240:243], v[60:63]
  ds_read_b64_tr_b16 v[88:89], v105 offset:0
  ds_read_b64_tr_b16 v[90:91], v105 offset:4096
  buffer_store_dwordx4 v[144:147], v202, s[60:63], s31 offen offset:512 sc1
  v_fmac_f32 v197, v126, v126
  v_fmac_f32 v201, v134, v134
  s_waitcnt lgkmcnt(12)
  v_mfma_f32_16x16x32_bf16 v[32:35], v[96:99], v[236:239], v[32:35]
  v_mfma_f32_16x16x32_bf16 v[64:67], v[96:99], v[240:243], v[64:67]
  ds_read_b64_tr_b16 v[92:93], v106 offset:0
  ds_read_b64_tr_b16 v[94:95], v106 offset:4096
  v_fmac_f32 v197, v128, v128
  v_fmac_f32 v201, v136, v136
  s_waitcnt lgkmcnt(12)
  v_mfma_f32_16x16x32_bf16 v[4:7], v[68:71], v[244:247], v[4:7]
  v_mfma_f32_16x16x32_bf16 v[36:39], v[68:71], v[248:251], v[36:39]
  v_mfma_f32_16x16x32_bf16 v[108:111], v[68:71], v[116:119], v[108:111]
  ds_read_b64_tr_b16 v[96:97], v107 offset:0
  ds_read_b64_tr_b16 v[98:99], v107 offset:4096
  v_fmac_f32 v197, v130, v130
  v_fmac_f32 v201, v138, v138
  s_waitcnt lgkmcnt(12)
  v_mfma_f32_16x16x32_bf16 v[8:11], v[72:75], v[244:247], v[8:11]
  v_mfma_f32_16x16x32_bf16 v[40:43], v[72:75], v[248:251], v[40:43]
  s_waitcnt vmcnt(12)
  s_barrier
  s_mov_b32 s44, s43
  s_add_u32 s43, s43, 16384
  s_cmp_eq_u32 s43, 163840
  s_cselect_b32 s43, 0, s43
  s_sub_u32 s44, s43, s44
  v_add_u32 v100, s44, v100
  v_add_u32 v101, s44, v101
  v_add_u32 v102, s44, v102
  v_add_u32 v103, s44, v103
  v_add_u32 v104, s44, v104
  v_add_u32 v105, s44, v105
  v_add_u32 v106, s44, v106
  v_add_u32 v107, s44, v107
  ds_read_b64_tr_b16 v[68:69], v100 offset:0
  ds_read_b64_tr_b16 v[70:71], v100 offset:4096
  v_mul_f32 v197, 0x42000000, v197
  v_mul_f32 v201, 0x42000000, v201
  s_waitcnt lgkmcnt(12)
  v_mfma_f32_16x16x32_bf16 v[12:15], v[76:79], v[244:247], v[12:15]
  v_mfma_f32_16x16x32_bf16 v[44:47], v[76:79], v[248:251], v[44:47]
  ds_read_b64_tr_b16 v[72:73], v101 offset:0
  ds_read_b64_tr_b16 v[74:75], v101 offset:4096
  buffer_store_dwordx4 v[148:151], v202, s[60:63], s31 offen offset:1024 sc1
  v_add_f32 v197, v197, v125
  v_add_f32 v201, v201, v133
  s_waitcnt lgkmcnt(12)
  v_mfma_f32_16x16x32_bf16 v[16:19], v[80:83], v[244:247], v[16:19]
  v_mfma_f32_16x16x32_bf16 v[48:51], v[80:83], v[248:251], v[48:51]
  ds_read_b64_tr_b16 v[76:77], v102 offset:0
  ds_read_b64_tr_b16 v[78:79], v102 offset:4096
  v_add_f32 v197, v197, v127
  v_add_f32 v201, v201, v135
  s_waitcnt lgkmcnt(12)
  v_mfma_f32_16x16x32_bf16 v[20:23], v[84:87], v[244:247], v[20:23]
  v_mfma_f32_16x16x32_bf16 v[52:55], v[84:87], v[248:251], v[52:55]
  v_mfma_f32_16x16x32_bf16 v[112:115], v[84:87], v[116:119], v[112:115]
  ds_read_b64_tr_b16 v[80:81], v103 offset:0
  ds_read_b64_tr_b16 v[82:83], v103 offset:4096
  v_add_f32 v197, v197, v129
  v_add_f32 v201, v201, v137
  s_waitcnt lgkmcnt(12)
  v_mfma_f32_16x16x32_bf16 v[24:27], v[88:91], v[244:247], v[24:27]
  v_mfma_f32_16x16x32_bf16 v[56:59], v[88:91], v[248:251], v[56:59]
  ds_read_b64_tr_b16 v[84:85], v104 offset:0
  ds_read_b64_tr_b16 v[86:87], v104 offset:4096
  v_add_f32 v197, v197, v131
  v_add_f32 v201, v201, v139
  s_waitcnt lgkmcnt(12)
  v_mfma_f32_16x16x32_bf16 v[28:31], v[92:95], v[244:247], v[28:31]
  v_mfma_f32_16x16x32_bf16 v[60:63], v[92:95], v[248:251], v[60:63]
  ds_read_b64_tr_b16 v[88:89], v105 offset:0
  ds_read_b64_tr_b16 v[90:91], v105 offset:4096
  buffer_store_dwordx4 v[152:155], v202, s[60:63], s31 offen offset:1536 sc1
  v_mov_b32 v2, v197
  v_mov_b32 v3, v201
  s_waitcnt lgkmcnt(12)
  v_mfma_f32_16x16x32_bf16 v[32:35], v[96:99], v[244:247], v[32:35]
  v_mfma_f32_16x16x32_bf16 v[64:67], v[96:99], v[248:251], v[64:67]
  ds_read_b64_tr_b16 v[92:93], v106 offset:0
  ds_read_b64_tr_b16 v[94:95], v106 offset:4096
  v_permlane16_swap_b32 v2, v197
  v_permlane16_swap_b32 v3, v201
  s_waitcnt vmcnt(13) lgkmcnt(12)
  v_mfma_f32_16x16x32_bf16 v[4:7], v[68:71], v[156:159], v[4:7]
  s_waitcnt vmcnt(12)
  v_mfma_f32_16x16x32_bf16 v[36:39], v[68:71], v[160:163], v[36:39]
  v_mfma_f32_16x16x32_bf16 v[108:111], v[68:71], v[116:119], v[108:111]
  ds_read_b64_tr_b16 v[96:97], v107 offset:0
  ds_read_b64_tr_b16 v[98:99], v107 offset:4096
  v_add_f32 v197, v197, v2
  v_add_f32 v201, v201, v3
  s_waitcnt lgkmcnt(12)
  v_mfma_f32_16x16x32_bf16 v[8:11], v[72:75], v[156:159], v[8:11]
  v_mfma_f32_16x16x32_bf16 v[40:43], v[72:75], v[160:163], v[40:43]
  s_waitcnt vmcnt(10)
  s_barrier
  s_mov_b32 s44, s43
  s_add_u32 s43, s43, 16384
  s_cmp_eq_u32 s43, 163840
  s_cselect_b32 s43, 0, s43
  s_sub_u32 s44, s43, s44
  v_add_u32 v100, s44, v100
  v_add_u32 v101, s44, v101
  v_add_u32 v102, s44, v102
  v_add_u32 v103, s44, v103
  v_add_u32 v104, s44, v104
  v_add_u32 v105, s44, v105
  v_add_u32 v106, s44, v106
  v_add_u32 v107, s44, v107
  ds_read_b64_tr_b16 v[68:69], v100 offset:0
  ds_read_b64_tr_b16 v[70:71], v100 offset:4096
  v_mov_b32 v2, v197
  v_mov_b32 v3, v201
  s_waitcnt lgkmcnt(12)
  v_mfma_f32_16x16x32_bf16 v[12:15], v[76:79], v[156:159], v[12:15]
  v_mfma_f32_16x16x32_bf16 v[44:47], v[76:79], v[160:163], v[44:47]
  ds_read_b64_tr_b16 v[72:73], v101 offset:0
  ds_read_b64_tr_b16 v[74:75], v101 offset:4096
  v_permlane32_swap_b32 v2, v197
  v_permlane32_swap_b32 v3, v201
  s_waitcnt lgkmcnt(12)
  v_mfma_f32_16x16x32_bf16 v[16:19], v[80:83], v[156:159], v[16:19]
  v_mfma_f32_16x16x32_bf16 v[48:51], v[80:83], v[160:163], v[48:51]
  ds_read_b64_tr_b16 v[76:77], v102 offset:0
  ds_read_b64_tr_b16 v[78:79], v102 offset:4096
  buffer_store_dwordx4 v[180:183], v202, s[60:63], s31 offen offset:2048 sc1
  v_add_f32 v197, v197, v2
  v_add_f32 v201, v201, v3
  s_waitcnt lgkmcnt(12)
  v_mfma_f32_16x16x32_bf16 v[20:23], v[84:87], v[156:159], v[20:23]
  v_mfma_f32_16x16x32_bf16 v[52:55], v[84:87], v[160:163], v[52:55]
  v_mfma_f32_16x16x32_bf16 v[112:115], v[84:87], v[116:119], v[112:115]
  ds_read_b64_tr_b16 v[80:81], v103 offset:0
  ds_read_b64_tr_b16 v[82:83], v103 offset:4096
  v_mov_b32 v2, 0x3727c5ac
  v_mov_b32 v3, 0x3727c5ac
  s_waitcnt lgkmcnt(12)
  v_mfma_f32_16x16x32_bf16 v[24:27], v[88:91], v[156:159], v[24:27]
  v_mfma_f32_16x16x32_bf16 v[56:59], v[88:91], v[160:163], v[56:59]
  ds_read_b64_tr_b16 v[84:85], v104 offset:0
  ds_read_b64_tr_b16 v[86:87], v104 offset:4096
  v_fmac_f32 v2, 0x3b000000, v197
  v_fmac_f32 v3, 0x3b000000, v201
  s_waitcnt lgkmcnt(12)
  v_mfma_f32_16x16x32_bf16 v[28:31], v[92:95], v[156:159], v[28:31]
  v_mfma_f32_16x16x32_bf16 v[60:63], v[92:95], v[160:163], v[60:63]
  ds_read_b64_tr_b16 v[88:89], v105 offset:0
  ds_read_b64_tr_b16 v[90:91], v105 offset:4096
  v_rsq_f32 v197, v2
  v_rsq_f32 v201, v3
  s_waitcnt lgkmcnt(12)
  v_mfma_f32_16x16x32_bf16 v[32:35], v[96:99], v[156:159], v[32:35]
  v_mfma_f32_16x16x32_bf16 v[64:67], v[96:99], v[160:163], v[64:67]
  ds_read_b64_tr_b16 v[92:93], v106 offset:0
  ds_read_b64_tr_b16 v[94:95], v106 offset:4096
  v_mov_b32 v124, v199
  v_mov_b32 v132, v198
  s_waitcnt vmcnt(10) lgkmcnt(12)
  v_mfma_f32_16x16x32_bf16 v[4:7], v[68:71], v[164:167], v[4:7]
  s_waitcnt vmcnt(9)
  v_mfma_f32_16x16x32_bf16 v[36:39], v[68:71], v[168:171], v[36:39]
  v_mfma_f32_16x16x32_bf16 v[108:111], v[68:71], v[116:119], v[108:111]
  ds_read_b64_tr_b16 v[96:97], v107 offset:0
  ds_read_b64_tr_b16 v[98:99], v107 offset:4096
  v_mov_b32 v125, v199
  v_mov_b32 v133, v198
  s_waitcnt lgkmcnt(12)
  v_mfma_f32_16x16x32_bf16 v[8:11], v[72:75], v[164:167], v[8:11]
  v_mfma_f32_16x16x32_bf16 v[40:43], v[72:75], v[168:171], v[40:43]
  s_waitcnt vmcnt(7)
  s_barrier
  s_mov_b32 s44, s43
  s_add_u32 s43, s43, 16384
  s_cmp_eq_u32 s43, 163840
  s_cselect_b32 s43, 0, s43
  s_sub_u32 s44, s43, s44
  v_add_u32 v100, s44, v100
  v_add_u32 v101, s44, v101
  v_add_u32 v102, s44, v102
  v_add_u32 v103, s44, v103
  v_add_u32 v104, s44, v104
  v_add_u32 v105, s44, v105
  v_add_u32 v106, s44, v106
  v_add_u32 v107, s44, v107
  ds_read_b64_tr_b16 v[68:69], v100 offset:0
  ds_read_b64_tr_b16 v[70:71], v100 offset:4096
  v_mov_b32 v126, v197
  v_mov_b32 v134, v201
  s_waitcnt lgkmcnt(12)
  v_mfma_f32_16x16x32_bf16 v[12:15], v[76:79], v[164:167], v[12:15]
  v_mfma_f32_16x16x32_bf16 v[44:47], v[76:79], v[168:171], v[44:47]
  ds_read_b64_tr_b16 v[72:73], v101 offset:0
  ds_read_b64_tr_b16 v[74:75], v101 offset:4096
  v_mov_b32 v127, v197
  v_mov_b32 v135, v201
  s_waitcnt lgkmcnt(12)
  v_mfma_f32_16x16x32_bf16 v[16:19], v[80:83], v[164:167], v[16:19]
  v_mfma_f32_16x16x32_bf16 v[48:51], v[80:83], v[168:171], v[48:51]
  ds_read_b64_tr_b16 v[76:77], v102 offset:0
  ds_read_b64_tr_b16 v[78:79], v102 offset:4096
  buffer_store_dwordx4 v[184:187], v202, s[60:63], s31 offen offset:2560 sc1
  v_mov_b32 v128, 1.0
  v_mov_b32 v129, 1.0
  s_waitcnt lgkmcnt(12)
  v_mfma_f32_16x16x32_bf16 v[20:23], v[84:87], v[164:167], v[20:23]
  v_mfma_f32_16x16x32_bf16 v[52:55], v[84:87], v[168:171], v[52:55]
  v_mfma_f32_16x16x32_bf16 v[112:115], v[84:87], v[116:119], v[112:115]
  ds_read_b64_tr_b16 v[80:81], v103 offset:0
  ds_read_b64_tr_b16 v[82:83], v103 offset:4096
  v_mov_b32 v130, 0xc0135761
  v_mov_b32 v131, 0xc0135761
  s_waitcnt lgkmcnt(12)
  v_mfma_f32_16x16x32_bf16 v[24:27], v[88:91], v[164:167], v[24:27]
  v_mfma_f32_16x16x32_bf16 v[56:59], v[88:91], v[168:171], v[56:59]
  ds_read_b64_tr_b16 v[84:85], v104 offset:0
  ds_read_b64_tr_b16 v[86:87], v104 offset:4096
  v_mov_b32 v136, 0xbdd2d3e8
  v_mov_b32 v137, 0xbdd2d3e8
  s_waitcnt lgkmcnt(12)
  v_mfma_f32_16x16x32_bf16 v[28:31], v[92:95], v[164:167], v[28:31]
  v_mfma_f32_16x16x32_bf16 v[60:63], v[92:95], v[168:171], v[60:63]
  ds_read_b64_tr_b16 v[88:89], v105 offset:0
  ds_read_b64_tr_b16 v[90:91], v105 offset:4096
  s_waitcnt lgkmcnt(12)
  v_mfma_f32_16x16x32_bf16 v[32:35], v[96:99], v[164:167], v[32:35]
  v_mfma_f32_16x16x32_bf16 v[64:67], v[96:99], v[168:171], v[64:67]
  ds_read_b64_tr_b16 v[92:93], v106 offset:0
  ds_read_b64_tr_b16 v[94:95], v106 offset:4096
  s_waitcnt vmcnt(7) lgkmcnt(12)
  v_mfma_f32_16x16x32_bf16 v[4:7], v[68:71], v[172:175], v[4:7]
  s_waitcnt vmcnt(6)
  v_mfma_f32_16x16x32_bf16 v[36:39], v[68:71], v[176:179], v[36:39]
  v_mfma_f32_16x16x32_bf16 v[108:111], v[68:71], v[116:119], v[108:111]
  ds_read_b64_tr_b16 v[96:97], v107 offset:0
  ds_read_b64_tr_b16 v[98:99], v107 offset:4096
  s_waitcnt lgkmcnt(12)
  v_mfma_f32_16x16x32_bf16 v[8:11], v[72:75], v[172:175], v[8:11]
  v_mfma_f32_16x16x32_bf16 v[40:43], v[72:75], v[176:179], v[40:43]
  buffer_store_dwordx4 v[120:123], v202, s[60:63], s31 offen offset:3072 sc1
  s_waitcnt lgkmcnt(10)
  v_mfma_f32_16x16x32_bf16 v[12:15], v[76:79], v[172:175], v[12:15]
  v_mfma_f32_16x16x32_bf16 v[44:47], v[76:79], v[176:179], v[44:47]
  s_waitcnt lgkmcnt(8)
  v_mfma_f32_16x16x32_bf16 v[16:19], v[80:83], v[172:175], v[16:19]
  v_mfma_f32_16x16x32_bf16 v[48:51], v[80:83], v[176:179], v[48:51]
  s_waitcnt lgkmcnt(6)
  v_mfma_f32_16x16x32_bf16 v[20:23], v[84:87], v[172:175], v[20:23]
  v_mfma_f32_16x16x32_bf16 v[52:55], v[84:87], v[176:179], v[52:55]
  v_mfma_f32_16x16x32_bf16 v[112:115], v[84:87], v[116:119], v[112:115]
  buffer_store_dwordx4 v[252:255], v202, s[60:63], s31 offen offset:3584 sc1
  s_waitcnt lgkmcnt(4)
  v_mfma_f32_16x16x32_bf16 v[24:27], v[88:91], v[172:175], v[24:27]
  v_mfma_f32_16x16x32_bf16 v[56:59], v[88:91], v[176:179], v[56:59]
  s_waitcnt lgkmcnt(2)
  v_mfma_f32_16x16x32_bf16 v[28:31], v[92:95], v[172:175], v[28:31]
  v_mfma_f32_16x16x32_bf16 v[60:63], v[92:95], v[176:179], v[60:63]
  s_waitcnt lgkmcnt(0)
  v_mfma_f32_16x16x32_bf16 v[32:35], v[96:99], v[172:175], v[32:35]
  v_mfma_f32_16x16x32_bf16 v[64:67], v[96:99], v[176:179], v[64:67]
  s_lshr_b32 s19, s10, 1
  s_lshl_b32 s19, s19, 14
  s_add_u32 s19, s19, s42
  s_sub_u32 s44, s19, 163840
  s_cmp_ge_u32 s19, 163840
  s_cselect_b32 s19, s44, s19
  s_and_b32 s44, s10, 1
  s_lshl_b32 s44, s44, 13
  s_add_u32 s19, s19, s44
  v_add_u32 v200, s19, v190
  ds_write_b128 v200, v[20:23] offset:0
  ds_write_b128 v200, v[24:27] offset:1024
  ds_write_b128 v200, v[28:31] offset:2048
  ds_write_b128 v200, v[32:35] offset:3072
  ds_write_b128 v200, v[52:55] offset:4096
  ds_write_b128 v200, v[56:59] offset:5120
  ds_write_b128 v200, v[60:63] offset:6144
  ds_write_b128 v200, v[64:67] offset:7168
  s_mov_b32 s43, 65536
  s_add_u32 s43, s43, s42
  s_sub_u32 s44, s43, 163840
  s_cmp_ge_u32 s43, 163840
  s_cselect_b32 s43, s44, s43
  s_lshl_b32 s19, s29, 9
  s_lshl_b32 s20, s10, 6
  s_add_u32 s19, s19, s20
  s_add_u32 s19, s19, s43
  v_lshlrev_b32 v2, 4, v196
  v_add_u32 v2, s19, v2
  v_subrev_u32 v3, s43, v2
  v_xor_b32 v3, 256, v3
  v_add_u32 v3, s43, v3
  ds_write_b128 v2, v[108:111]
  ds_write_b128 v3, v[112:115]
  s_xor_b32 s20, s10, 4
  s_lshr_b32 s19, s20, 1
  s_lshl_b32 s19, s19, 14
  s_add_u32 s19, s19, s42
  s_sub_u32 s44, s19, 163840
  s_cmp_ge_u32 s19, 163840
  s_cselect_b32 s19, s44, s19
  s_and_b32 s44, s20, 1
  s_lshl_b32 s44, s44, 13
  s_add_u32 s19, s19, s44
  v_add_u32 v200, s19, v190
  v_lshlrev_b32 v2, 4, v196
  v_add_u32 v2, s43, v2
  s_add_u32 s60, s4, 46137344
  s_addc_u32 s61, s5, 0
  s_mov_b32 s62, 7340032
  s_mov_b32 s63, 0x20000
  s_and_b32 s19, s10, 1
  s_cmp_eq_u32 s19, 1
  s_cselect_b64 vcc, -1, 0
  s_waitcnt lgkmcnt(0)
  s_barrier
  s_xor_b32 s19, s10, 0
  s_lshl_b32 s19, s19, 6
  v_add_u32 v3, s19, v2
  ds_read_b128 v[156:159], v3
  ds_read_b128 v[172:175], v3 offset:512
  s_xor_b32 s19, s10, 1
  s_lshl_b32 s19, s19, 6
  v_add_u32 v3, s19, v2
  ds_read_b128 v[160:163], v3
  ds_read_b128 v[176:179], v3 offset:512
  ds_read_b128 v[212:215], v200 offset:0
  ds_read_b128 v[216:219], v200 offset:1024
  ds_read_b128 v[220:223], v200 offset:2048
  ds_read_b128 v[224:227], v200 offset:3072
  s_xor_b32 s19, s10, 2
  s_lshl_b32 s19, s19, 6
  v_add_u32 v3, s19, v2
  ds_read_b128 v[164:167], v3
  ds_read_b128 v[180:183], v3 offset:512
  s_xor_b32 s19, s10, 3
  s_lshl_b32 s19, s19, 6
  v_add_u32 v3, s19, v2
  ds_read_b128 v[168:171], v3
  ds_read_b128 v[184:187], v3 offset:512
  ds_read_b128 v[228:231], v200 offset:4096
  ds_read_b128 v[232:235], v200 offset:5120
  ds_read_b128 v[236:239], v200 offset:6144
  ds_read_b128 v[240:243], v200 offset:7168
  s_waitcnt lgkmcnt(14)
  v_pk_add_f32 v[156:157], v[156:157], v[172:173]
  v_pk_add_f32 v[158:159], v[158:159], v[174:175]
  s_waitcnt lgkmcnt(12)
  v_pk_add_f32 v[160:161], v[160:161], v[176:177]
  v_pk_add_f32 v[162:163], v[162:163], v[178:179]
  s_waitcnt lgkmcnt(6)
  v_pk_add_f32 v[164:165], v[164:165], v[180:181]
  v_pk_add_f32 v[166:167], v[166:167], v[182:183]
  s_waitcnt lgkmcnt(4)
  v_pk_add_f32 v[168:169], v[168:169], v[184:185]
  v_pk_add_f32 v[170:171], v[170:171], v[186:187]
  v_pk_add_f32 v[4:5], v[4:5], v[212:213]
  v_pk_add_f32 v[6:7], v[6:7], v[214:215]
  v_pk_add_f32 v[8:9], v[8:9], v[216:217]
  v_pk_add_f32 v[10:11], v[10:11], v[218:219]
  v_pk_add_f32 v[12:13], v[12:13], v[220:221]
  v_pk_add_f32 v[14:15], v[14:15], v[222:223]
  v_pk_add_f32 v[16:17], v[16:17], v[224:225]
  v_pk_add_f32 v[18:19], v[18:19], v[226:227]
  v_pk_fma_f32 v[4:5], v[124:125], v[156:157], v[4:5]
  v_pk_fma_f32 v[6:7], v[124:125], v[158:159], v[6:7]
  v_pk_fma_f32 v[8:9], v[124:125], v[160:161], v[8:9]
  v_pk_fma_f32 v[10:11], v[124:125], v[162:163], v[10:11]
  v_pk_fma_f32 v[12:13], v[124:125], v[164:165], v[12:13]
  v_pk_fma_f32 v[14:15], v[124:125], v[166:167], v[14:15]
  v_pk_fma_f32 v[16:17], v[124:125], v[168:169], v[16:17]
  v_pk_fma_f32 v[18:19], v[124:125], v[170:171], v[18:19]
  v_pk_mul_f32 v[4:5], v[4:5], v[126:127]
  v_pk_mul_f32 v[6:7], v[6:7], v[126:127]
  v_pk_mul_f32 v[8:9], v[8:9], v[126:127]
  v_pk_mul_f32 v[10:11], v[10:11], v[126:127]
  v_pk_mul_f32 v[12:13], v[12:13], v[126:127]
  v_pk_mul_f32 v[14:15], v[14:15], v[126:127]
  v_pk_mul_f32 v[16:17], v[16:17], v[126:127]
  v_pk_mul_f32 v[18:19], v[18:19], v[126:127]
  v_pk_mul_f32 v[72:73], v[4:5], v[4:5]
  v_pk_mul_f32 v[74:75], v[6:7], v[6:7]
  v_pk_mul_f32 v[76:77], v[8:9], v[8:9]
  v_pk_mul_f32 v[78:79], v[10:11], v[10:11]
  v_pk_mul_f32 v[80:81], v[12:13], v[12:13]
  v_pk_mul_f32 v[82:83], v[14:15], v[14:15]
  v_pk_mul_f32 v[84:85], v[16:17], v[16:17]
  v_pk_mul_f32 v[86:87], v[18:19], v[18:19]
  v_pk_fma_f32 v[72:73], v[72:73], v[136:137], v[130:131]
  v_pk_fma_f32 v[74:75], v[74:75], v[136:137], v[130:131]
  v_pk_fma_f32 v[76:77], v[76:77], v[136:137], v[130:131]
  v_pk_fma_f32 v[78:79], v[78:79], v[136:137], v[130:131]
  v_pk_fma_f32 v[80:81], v[80:81], v[136:137], v[130:131]
  v_pk_fma_f32 v[82:83], v[82:83], v[136:137], v[130:131]
  v_pk_fma_f32 v[84:85], v[84:85], v[136:137], v[130:131]
  v_pk_fma_f32 v[86:87], v[86:87], v[136:137], v[130:131]
  v_pk_mul_f32 v[72:73], v[4:5], v[72:73]
  v_pk_mul_f32 v[74:75], v[6:7], v[74:75]
  v_pk_mul_f32 v[76:77], v[8:9], v[76:77]
  v_pk_mul_f32 v[78:79], v[10:11], v[78:79]
  v_pk_mul_f32 v[80:81], v[12:13], v[80:81]
  v_pk_mul_f32 v[82:83], v[14:15], v[82:83]
  v_pk_mul_f32 v[84:85], v[16:17], v[84:85]
  v_pk_mul_f32 v[86:87], v[18:19], v[86:87]
  v_exp_f32 v72, v72
  v_exp_f32 v73, v73
  v_exp_f32 v74, v74
  v_exp_f32 v75, v75
  v_exp_f32 v76, v76
  v_exp_f32 v77, v77
  v_exp_f32 v78, v78
  v_exp_f32 v79, v79
  v_exp_f32 v80, v80
  v_exp_f32 v81, v81
  v_exp_f32 v82, v82
  v_exp_f32 v83, v83
  v_exp_f32 v84, v84
  v_exp_f32 v85, v85
  v_exp_f32 v86, v86
  v_exp_f32 v87, v87
  v_pk_add_f32 v[72:73], v[72:73], v[128:129]
  v_pk_add_f32 v[74:75], v[74:75], v[128:129]
  v_pk_add_f32 v[76:77], v[76:77], v[128:129]
  v_pk_add_f32 v[78:79], v[78:79], v[128:129]
  v_pk_add_f32 v[80:81], v[80:81], v[128:129]
  v_pk_add_f32 v[82:83], v[82:83], v[128:129]
  v_pk_add_f32 v[84:85], v[84:85], v[128:129]
  v_pk_add_f32 v[86:87], v[86:87], v[128:129]
  v_rcp_f32 v72, v72
  v_rcp_f32 v73, v73
  v_rcp_f32 v74, v74
  v_rcp_f32 v75, v75
  v_rcp_f32 v76, v76
  v_rcp_f32 v77, v77
  v_rcp_f32 v78, v78
  v_rcp_f32 v79, v79
  v_rcp_f32 v80, v80
  v_rcp_f32 v81, v81
  v_rcp_f32 v82, v82
  v_rcp_f32 v83, v83
  v_rcp_f32 v84, v84
  v_rcp_f32 v85, v85
  v_rcp_f32 v86, v86
  v_rcp_f32 v87, v87
  v_pk_mul_f32 v[4:5], v[4:5], v[72:73]
  v_pk_mul_f32 v[6:7], v[6:7], v[74:75]
  v_pk_mul_f32 v[8:9], v[8:9], v[76:77]
  v_pk_mul_f32 v[10:11], v[10:11], v[78:79]
  v_pk_mul_f32 v[12:13], v[12:13], v[80:81]
  v_pk_mul_f32 v[14:15], v[14:15], v[82:83]
  v_pk_mul_f32 v[16:17], v[16:17], v[84:85]
  v_pk_mul_f32 v[18:19], v[18:19], v[86:87]
  v_cvt_pk_bf16_f32 v88, v4, v5
  v_cvt_pk_bf16_f32 v89, v6, v7
  v_cvt_pk_bf16_f32 v90, v8, v9
  v_cvt_pk_bf16_f32 v91, v10, v11
  v_cndmask_b32 v92, v88, v90, vcc
  v_cndmask_b32 v93, v89, v91, vcc
  v_cndmask_b32 v94, v90, v88, vcc
  v_cndmask_b32 v95, v91, v89, vcc
  s_lshr_b32 s19, s10, 1
  s_xor_b32 s19, s19, 0
  s_lshl_b32 s20, s38, 2
  s_add_u32 s19, s19, s20
  s_add_u32 s20, s39, 0
  s_mul_i32 s20, s20, 56
  s_add_u32 s19, s19, s20
  s_lshl_b32 s19, s19, 10
  buffer_store_dwordx4 v[92:95], v190, s[60:63], s19 offen sc1
  v_cvt_pk_bf16_f32 v96, v12, v13
  v_cvt_pk_bf16_f32 v97, v14, v15
  v_cvt_pk_bf16_f32 v98, v16, v17
  v_cvt_pk_bf16_f32 v99, v18, v19
  v_cndmask_b32 v100, v96, v98, vcc
  v_cndmask_b32 v101, v97, v99, vcc
  v_cndmask_b32 v102, v98, v96, vcc
  v_cndmask_b32 v103, v99, v97, vcc
  s_lshr_b32 s19, s10, 1
  s_xor_b32 s19, s19, 1
  s_lshl_b32 s20, s38, 2
  s_add_u32 s19, s19, s20
  s_add_u32 s20, s39, 0
  s_mul_i32 s20, s20, 56
  s_add_u32 s19, s19, s20
  s_lshl_b32 s19, s19, 10
  buffer_store_dwordx4 v[100:103], v190, s[60:63], s19 offen sc1
  s_waitcnt lgkmcnt(3)
  v_pk_add_f32 v[36:37], v[36:37], v[228:229]
  v_pk_add_f32 v[38:39], v[38:39], v[230:231]
  s_waitcnt lgkmcnt(2)
  v_pk_add_f32 v[40:41], v[40:41], v[232:233]
  v_pk_add_f32 v[42:43], v[42:43], v[234:235]
  s_waitcnt lgkmcnt(1)
  v_pk_add_f32 v[44:45], v[44:45], v[236:237]
  v_pk_add_f32 v[46:47], v[46:47], v[238:239]
  s_waitcnt lgkmcnt(0)
  v_pk_add_f32 v[48:49], v[48:49], v[240:241]
  v_pk_add_f32 v[50:51], v[50:51], v[242:243]
  v_pk_fma_f32 v[36:37], v[132:133], v[156:157], v[36:37]
  v_pk_fma_f32 v[38:39], v[132:133], v[158:159], v[38:39]
  v_pk_fma_f32 v[40:41], v[132:133], v[160:161], v[40:41]
  v_pk_fma_f32 v[42:43], v[132:133], v[162:163], v[42:43]
  v_pk_fma_f32 v[44:45], v[132:133], v[164:165], v[44:45]
  v_pk_fma_f32 v[46:47], v[132:133], v[166:167], v[46:47]
  v_pk_fma_f32 v[48:49], v[132:133], v[168:169], v[48:49]
  v_pk_fma_f32 v[50:51], v[132:133], v[170:171], v[50:51]
  v_pk_mul_f32 v[36:37], v[36:37], v[134:135]
  v_pk_mul_f32 v[38:39], v[38:39], v[134:135]
  v_pk_mul_f32 v[40:41], v[40:41], v[134:135]
  v_pk_mul_f32 v[42:43], v[42:43], v[134:135]
  v_pk_mul_f32 v[44:45], v[44:45], v[134:135]
  v_pk_mul_f32 v[46:47], v[46:47], v[134:135]
  v_pk_mul_f32 v[48:49], v[48:49], v[134:135]
  v_pk_mul_f32 v[50:51], v[50:51], v[134:135]
  v_pk_mul_f32 v[72:73], v[36:37], v[36:37]
  v_pk_mul_f32 v[74:75], v[38:39], v[38:39]
  v_pk_mul_f32 v[76:77], v[40:41], v[40:41]
  v_pk_mul_f32 v[78:79], v[42:43], v[42:43]
  v_pk_mul_f32 v[80:81], v[44:45], v[44:45]
  v_pk_mul_f32 v[82:83], v[46:47], v[46:47]
  v_pk_mul_f32 v[84:85], v[48:49], v[48:49]
  v_pk_mul_f32 v[86:87], v[50:51], v[50:51]
  v_pk_fma_f32 v[72:73], v[72:73], v[136:137], v[130:131]
  v_pk_fma_f32 v[74:75], v[74:75], v[136:137], v[130:131]
  v_pk_fma_f32 v[76:77], v[76:77], v[136:137], v[130:131]
  v_pk_fma_f32 v[78:79], v[78:79], v[136:137], v[130:131]
  v_pk_fma_f32 v[80:81], v[80:81], v[136:137], v[130:131]
  v_pk_fma_f32 v[82:83], v[82:83], v[136:137], v[130:131]
  v_pk_fma_f32 v[84:85], v[84:85], v[136:137], v[130:131]
  v_pk_fma_f32 v[86:87], v[86:87], v[136:137], v[130:131]
  v_pk_mul_f32 v[72:73], v[36:37], v[72:73]
  v_pk_mul_f32 v[74:75], v[38:39], v[74:75]
  v_pk_mul_f32 v[76:77], v[40:41], v[76:77]
  v_pk_mul_f32 v[78:79], v[42:43], v[78:79]
  v_pk_mul_f32 v[80:81], v[44:45], v[80:81]
  v_pk_mul_f32 v[82:83], v[46:47], v[82:83]
  v_pk_mul_f32 v[84:85], v[48:49], v[84:85]
  v_pk_mul_f32 v[86:87], v[50:51], v[86:87]
  v_exp_f32 v72, v72
  v_exp_f32 v73, v73
  v_exp_f32 v74, v74
  v_exp_f32 v75, v75
  v_exp_f32 v76, v76
  v_exp_f32 v77, v77
  v_exp_f32 v78, v78
  v_exp_f32 v79, v79
  v_exp_f32 v80, v80
  v_exp_f32 v81, v81
  v_exp_f32 v82, v82
  v_exp_f32 v83, v83
  v_exp_f32 v84, v84
  v_exp_f32 v85, v85
  v_exp_f32 v86, v86
  v_exp_f32 v87, v87
  v_pk_add_f32 v[72:73], v[72:73], v[128:129]
  v_pk_add_f32 v[74:75], v[74:75], v[128:129]
  v_pk_add_f32 v[76:77], v[76:77], v[128:129]
  v_pk_add_f32 v[78:79], v[78:79], v[128:129]
  v_pk_add_f32 v[80:81], v[80:81], v[128:129]
  v_pk_add_f32 v[82:83], v[82:83], v[128:129]
  v_pk_add_f32 v[84:85], v[84:85], v[128:129]
  v_pk_add_f32 v[86:87], v[86:87], v[128:129]
  v_rcp_f32 v72, v72
  v_rcp_f32 v73, v73
  v_rcp_f32 v74, v74
  v_rcp_f32 v75, v75
  v_rcp_f32 v76, v76
  v_rcp_f32 v77, v77
  v_rcp_f32 v78, v78
  v_rcp_f32 v79, v79
  v_rcp_f32 v80, v80
  v_rcp_f32 v81, v81
  v_rcp_f32 v82, v82
  v_rcp_f32 v83, v83
  v_rcp_f32 v84, v84
  v_rcp_f32 v85, v85
  v_rcp_f32 v86, v86
  v_rcp_f32 v87, v87
  v_pk_mul_f32 v[36:37], v[36:37], v[72:73]
  v_pk_mul_f32 v[38:39], v[38:39], v[74:75]
  v_pk_mul_f32 v[40:41], v[40:41], v[76:77]
  v_pk_mul_f32 v[42:43], v[42:43], v[78:79]
  v_pk_mul_f32 v[44:45], v[44:45], v[80:81]
  v_pk_mul_f32 v[46:47], v[46:47], v[82:83]
  v_pk_mul_f32 v[48:49], v[48:49], v[84:85]
  v_pk_mul_f32 v[50:51], v[50:51], v[86:87]
  v_cvt_pk_bf16_f32 v88, v36, v37
  v_cvt_pk_bf16_f32 v89, v38, v39
  v_cvt_pk_bf16_f32 v90, v40, v41
  v_cvt_pk_bf16_f32 v91, v42, v43
  v_cndmask_b32 v92, v88, v90, vcc
  v_cndmask_b32 v93, v89, v91, vcc
  v_cndmask_b32 v94, v90, v88, vcc
  v_cndmask_b32 v95, v91, v89, vcc
  s_lshr_b32 s19, s10, 1
  s_xor_b32 s19, s19, 0
  s_lshl_b32 s20, s38, 2
  s_add_u32 s19, s19, s20
  s_add_u32 s20, s39, 1
  s_mul_i32 s20, s20, 56
  s_add_u32 s19, s19, s20
  s_lshl_b32 s19, s19, 10
  buffer_store_dwordx4 v[92:95], v190, s[60:63], s19 offen sc1
  v_cvt_pk_bf16_f32 v96, v44, v45
  v_cvt_pk_bf16_f32 v97, v46, v47
  v_cvt_pk_bf16_f32 v98, v48, v49
  v_cvt_pk_bf16_f32 v99, v50, v51
  v_cndmask_b32 v100, v96, v98, vcc
  v_cndmask_b32 v101, v97, v99, vcc
  v_cndmask_b32 v102, v98, v96, vcc
  v_cndmask_b32 v103, v99, v97, vcc
  s_lshr_b32 s19, s10, 1
  s_xor_b32 s19, s19, 1
  s_lshl_b32 s20, s38, 2
  s_add_u32 s19, s19, s20
  s_add_u32 s20, s39, 1
  s_mul_i32 s20, s20, 56
  s_add_u32 s19, s19, s20
  s_lshl_b32 s19, s19, 10
  buffer_store_dwordx4 v[100:103], v190, s[60:63], s19 offen sc1
at_kernel_fin:
at_kernel_done:
  s_endpgm
at_kernel_safe:
  s_waitcnt vmcnt(0)
  s_barrier
  v_pk_mov_b32 v[4:5], v[204:205], v[204:205]
  v_pk_mov_b32 v[6:7], v[204:205], v[204:205]
  v_pk_mov_b32 v[8:9], v[204:205], v[204:205]
  v_pk_mov_b32 v[10:11], v[204:205], v[204:205]
  v_pk_mov_b32 v[12:13], v[204:205], v[204:205]
  v_pk_mov_b32 v[14:15], v[204:205], v[204:205]
  v_pk_mov_b32 v[16:17], v[204:205], v[204:205]
  v_pk_mov_b32 v[18:19], v[204:205], v[204:205]
  v_pk_mov_b32 v[20:21], v[204:205], v[204:205]
  v_pk_mov_b32 v[22:23], v[204:205], v[204:205]
  v_pk_mov_b32 v[24:25], v[204:205], v[204:205]
  v_pk_mov_b32 v[26:27], v[204:205], v[204:205]
  v_pk_mov_b32 v[28:29], v[204:205], v[204:205]
  v_pk_mov_b32 v[30:31], v[204:205], v[204:205]
  v_pk_mov_b32 v[32:33], v[204:205], v[204:205]
  v_pk_mov_b32 v[34:35], v[204:205], v[204:205]
  v_pk_mov_b32 v[36:37], v[204:205], v[204:205]
  v_pk_mov_b32 v[38:39], v[204:205], v[204:205]
  v_pk_mov_b32 v[40:41], v[204:205], v[204:205]
  v_pk_mov_b32 v[42:43], v[204:205], v[204:205]
  v_pk_mov_b32 v[44:45], v[204:205], v[204:205]
  v_pk_mov_b32 v[46:47], v[204:205], v[204:205]
  v_pk_mov_b32 v[48:49], v[204:205], v[204:205]
  v_pk_mov_b32 v[50:51], v[204:205], v[204:205]
  v_pk_mov_b32 v[52:53], v[204:205], v[204:205]
  v_pk_mov_b32 v[54:55], v[204:205], v[204:205]
  v_pk_mov_b32 v[56:57], v[204:205], v[204:205]
  v_pk_mov_b32 v[58:59], v[204:205], v[204:205]
  v_pk_mov_b32 v[60:61], v[204:205], v[204:205]
  v_pk_mov_b32 v[62:63], v[204:205], v[204:205]
  v_pk_mov_b32 v[64:65], v[204:205], v[204:205]
  v_pk_mov_b32 v[66:67], v[204:205], v[204:205]
  v_mov_b32 v197, 0
  v_mov_b32 v198, 0
  v_mov_b32 v199, v201
  s_sub_u32 s26, s32, 1
  s_lshl_b32 s26, s26, 14
  s_mov_b32 s27, s23
  v_mov_b32 v195, v190
  s_max_i32 s19, s26, 0
  s_add_u32 s19, s19, s25
  s_mov_b32 m0, s27
  s_nop 0
  buffer_load_dwordx4 v190, s[56:59], s19 offen lds
  buffer_load_dwordx4 v190, s[56:59], s19 offen offset:1024 lds
  s_sub_u32 s26, s26, 16384
  s_add_u32 s27, s27, 16384
  s_and_b32 s27, s27, 0x1ffff
  s_max_i32 s19, s26, 0
  s_add_u32 s19, s19, s25
  s_mov_b32 m0, s27
  s_nop 0
  buffer_load_dwordx4 v190, s[56:59], s19 offen lds
  buffer_load_dwordx4 v190, s[56:59], s19 offen offset:1024 lds
  s_sub_u32 s26, s26, 16384
  s_add_u32 s27, s27, 16384
  s_and_b32 s27, s27, 0x1ffff
  s_max_i32 s19, s26, 0
  s_add_u32 s19, s19, s25
  s_mov_b32 m0, s27
  s_nop 0
  buffer_load_dwordx4 v190, s[56:59], s19 offen lds
  buffer_load_dwordx4 v190, s[56:59], s19 offen offset:1024 lds
  s_sub_u32 s26, s26, 16384
  s_add_u32 s27, s27, 16384
  s_and_b32 s27, s27, 0x1ffff
  s_max_i32 s19, s26, 0
  s_add_u32 s19, s19, s25
  s_mov_b32 m0, s27
  s_nop 0
  buffer_load_dwordx4 v190, s[56:59], s19 offen lds
  buffer_load_dwordx4 v190, s[56:59], s19 offen offset:1024 lds
  s_sub_u32 s26, s26, 16384
  s_add_u32 s27, s27, 16384
  s_and_b32 s27, s27, 0x1ffff
  s_max_i32 s19, s26, 0
  s_add_u32 s19, s19, s25
  s_mov_b32 m0, s27
  s_nop 0
  buffer_load_dwordx4 v190, s[56:59], s19 offen lds
  buffer_load_dwordx4 v190, s[56:59], s19 offen offset:1024 lds
  s_sub_u32 s26, s26, 16384
  s_add_u32 s27, s27, 16384
  s_and_b32 s27, s27, 0x1ffff
  s_max_i32 s19, s26, 0
  s_add_u32 s19, s19, s25
  s_mov_b32 m0, s27
  s_nop 0
  buffer_load_dwordx4 v190, s[56:59], s19 offen lds
  buffer_load_dwordx4 v190, s[56:59], s19 offen offset:1024 lds
  s_sub_u32 s26, s26, 16384
  s_add_u32 s27, s27, 16384
  s_and_b32 s27, s27, 0x1ffff
  s_mov_b32 s17, 0
at_kernel_sloop:
  s_waitcnt vmcnt(10)
  s_barrier
  s_max_i32 s19, s26, 0
  s_add_u32 s19, s19, s25
  s_mov_b32 m0, s27
  s_nop 0
  buffer_load_dwordx4 v190, s[56:59], s19 offen lds
  buffer_load_dwordx4 v190, s[56:59], s19 offen offset:1024 lds
  s_sub_u32 s26, s26, 16384
  s_add_u32 s27, s27, 16384
  s_and_b32 s27, s27, 0x1ffff
  s_cmp_lt_u32 s17, s31
  s_cbranch_scc1 at_kernel_snext
  ds_read_b128 v[156:159], v195 offset:0
  ds_read_b128 v[160:163], v195 offset:1024
  ds_read_b128 v[164:167], v195 offset:2048
  ds_read_b128 v[168:171], v195 offset:3072
  ds_read_b128 v[172:175], v195 offset:4096
  ds_read_b128 v[176:179], v195 offset:5120
  ds_read_b128 v[180:183], v195 offset:6144
  ds_read_b128 v[184:187], v195 offset:7168
  s_waitcnt lgkmcnt(7)
  v_mfma_f32_32x32x16_bf16 v[68:83], v[156:159], v[124:127], 0
  s_waitcnt lgkmcnt(6)
  v_mfma_f32_32x32x16_bf16 v[68:83], v[160:163], v[128:131], v[68:83]
  s_waitcnt lgkmcnt(5)
  v_mfma_f32_32x32x16_bf16 v[68:83], v[164:167], v[132:135], v[68:83]
  s_waitcnt lgkmcnt(4)
  v_mfma_f32_32x32x16_bf16 v[68:83], v[168:171], v[136:139], v[68:83]
  s_waitcnt lgkmcnt(3)
  v_mfma_f32_32x32x16_bf16 v[68:83], v[172:175], v[140:143], v[68:83]
  s_waitcnt lgkmcnt(2)
  v_mfma_f32_32x32x16_bf16 v[68:83], v[176:179], v[144:147], v[68:83]
  s_waitcnt lgkmcnt(1)
  v_mfma_f32_32x32x16_bf16 v[68:83], v[180:183], v[148:151], v[68:83]
  s_waitcnt lgkmcnt(0)
  v_mfma_f32_32x32x16_bf16 v[68:83], v[184:187], v[152:155], v[68:83]
  s_cmp_lg_u32 s17, s31
  s_cbranch_scc1 at_kernel_snomask
  v_cmp_le_i32 vcc, 0, v200
  s_nop 8
  v_cndmask_b32 v68, v201, v68, vcc
  v_cmp_le_i32 vcc, 1, v200
  s_nop 1
  v_cndmask_b32 v69, v201, v69, vcc
  v_cmp_le_i32 vcc, 2, v200
  s_nop 1
  v_cndmask_b32 v70, v201, v70, vcc
  v_cmp_le_i32 vcc, 3, v200
  s_nop 1
  v_cndmask_b32 v71, v201, v71, vcc
  v_cmp_le_i32 vcc, 8, v200
  s_nop 1
  v_cndmask_b32 v72, v201, v72, vcc
  v_cmp_le_i32 vcc, 9, v200
  s_nop 1
  v_cndmask_b32 v73, v201, v73, vcc
  v_cmp_le_i32 vcc, 10, v200
  s_nop 1
  v_cndmask_b32 v74, v201, v74, vcc
  v_cmp_le_i32 vcc, 11, v200
  s_nop 1
  v_cndmask_b32 v75, v201, v75, vcc
  v_cmp_le_i32 vcc, 16, v200
  s_nop 1
  v_cndmask_b32 v76, v201, v76, vcc
  v_cmp_le_i32 vcc, 17, v200
  s_nop 1
  v_cndmask_b32 v77, v201, v77, vcc
  v_cmp_le_i32 vcc, 18, v200
  s_nop 1
  v_cndmask_b32 v78, v201, v78, vcc
  v_cmp_le_i32 vcc, 19, v200
  s_nop 1
  v_cndmask_b32 v79, v201, v79, vcc
  v_cmp_le_i32 vcc, 24, v200
  s_nop 1
  v_cndmask_b32 v80, v201, v80, vcc
  v_cmp_le_i32 vcc, 25, v200
  s_nop 1
  v_cndmask_b32 v81, v201, v81, vcc
  v_cmp_le_i32 vcc, 26, v200
  s_nop 1
  v_cndmask_b32 v82, v201, v82, vcc
  v_cmp_le_i32 vcc, 27, v200
  s_nop 1
  v_cndmask_b32 v83, v201, v83, vcc
at_kernel_snomask:
  s_nop 9
  v_max3_f32 v84, v68, v69, v70
  v_max3_f32 v84, v84, v71, v72
  v_max3_f32 v84, v84, v73, v74
  v_max3_f32 v84, v84, v75, v76
  v_max3_f32 v84, v84, v77, v78
  v_max3_f32 v84, v84, v79, v80
  v_max3_f32 v84, v84, v81, v82
  v_max_f32 v84, v84, v83
  v_mov_b32 v2, v84
  s_nop 1
  v_permlane32_swap_b32 v2, v84
  v_max_f32 v84, v84, v2
  v_max_f32 v84, v84, v199
  v_sub_f32 v85, v199, v84
  v_exp_f32 v85, v85
  v_mov_b32 v199, v84
  v_mul_f32 v4, v4, v85
  v_mul_f32 v5, v5, v85
  v_mul_f32 v6, v6, v85
  v_mul_f32 v7, v7, v85
  v_mul_f32 v8, v8, v85
  v_mul_f32 v9, v9, v85
  v_mul_f32 v10, v10, v85
  v_mul_f32 v11, v11, v85
  v_mul_f32 v12, v12, v85
  v_mul_f32 v13, v13, v85
  v_mul_f32 v14, v14, v85
  v_mul_f32 v15, v15, v85
  v_mul_f32 v16, v16, v85
  v_mul_f32 v17, v17, v85
  v_mul_f32 v18, v18, v85
  v_mul_f32 v19, v19, v85
  v_mul_f32 v20, v20, v85
  v_mul_f32 v21, v21, v85
  v_mul_f32 v22, v22, v85
  v_mul_f32 v23, v23, v85
  v_mul_f32 v24, v24, v85
  v_mul_f32 v25, v25, v85
  v_mul_f32 v26, v26, v85
  v_mul_f32 v27, v27, v85
  v_mul_f32 v28, v28, v85
  v_mul_f32 v29, v29, v85
  v_mul_f32 v30, v30, v85
  v_mul_f32 v31, v31, v85
  v_mul_f32 v32, v32, v85
  v_mul_f32 v33, v33, v85
  v_mul_f32 v34, v34, v85
  v_mul_f32 v35, v35, v85
  v_mul_f32 v36, v36, v85
  v_mul_f32 v37, v37, v85
  v_mul_f32 v38, v38, v85
  v_mul_f32 v39, v39, v85
  v_mul_f32 v40, v40, v85
  v_mul_f32 v41, v41, v85
  v_mul_f32 v42, v42, v85
  v_mul_f32 v43, v43, v85
  v_mul_f32 v44, v44, v85
  v_mul_f32 v45, v45, v85
  v_mul_f32 v46, v46, v85
  v_mul_f32 v47, v47, v85
  v_mul_f32 v48, v48, v85
  v_mul_f32 v49, v49, v85
  v_mul_f32 v50, v50, v85
  v_mul_f32 v51, v51, v85
  v_mul_f32 v52, v52, v85
  v_mul_f32 v53, v53, v85
  v_mul_f32 v54, v54, v85
  v_mul_f32 v55, v55, v85
  v_mul_f32 v56, v56, v85
  v_mul_f32 v57, v57, v85
  v_mul_f32 v58, v58, v85
  v_mul_f32 v59, v59, v85
  v_mul_f32 v60, v60, v85
  v_mul_f32 v61, v61, v85
  v_mul_f32 v62, v62, v85
  v_mul_f32 v63, v63, v85
  v_mul_f32 v64, v64, v85
  v_mul_f32 v65, v65, v85
  v_mul_f32 v66, v66, v85
  v_mul_f32 v67, v67, v85
  v_mul_f32 v197, v197, v85
  v_mul_f32 v198, v198, v85
  v_sub_f32 v68, v68, v84
  v_sub_f32 v69, v69, v84
  v_sub_f32 v70, v70, v84
  v_sub_f32 v71, v71, v84
  v_sub_f32 v72, v72, v84
  v_sub_f32 v73, v73, v84
  v_sub_f32 v74, v74, v84
  v_sub_f32 v75, v75, v84
  v_sub_f32 v76, v76, v84
  v_sub_f32 v77, v77, v84
  v_sub_f32 v78, v78, v84
  v_sub_f32 v79, v79, v84
  v_sub_f32 v80, v80, v84
  v_sub_f32 v81, v81, v84
  v_sub_f32 v82, v82, v84
  v_sub_f32 v83, v83, v84
  v_exp_f32 v68, v68
  v_exp_f32 v69, v69
  v_exp_f32 v70, v70
  v_exp_f32 v71, v71
  v_exp_f32 v72, v72
  v_exp_f32 v73, v73
  v_exp_f32 v74, v74
  v_exp_f32 v75, v75
  v_exp_f32 v76, v76
  v_exp_f32 v77, v77
  v_exp_f32 v78, v78
  v_exp_f32 v79, v79
  v_exp_f32 v80, v80
  v_exp_f32 v81, v81
  v_exp_f32 v82, v82
  v_exp_f32 v83, v83
  v_cvt_pk_bf16_f32 v116, v68, v69
  v_cvt_pk_bf16_f32 v117, v70, v71
  v_cvt_pk_bf16_f32 v118, v72, v73
  v_cvt_pk_bf16_f32 v119, v74, v75
  v_cvt_pk_bf16_f32 v120, v76, v77
  v_cvt_pk_bf16_f32 v121, v78, v79
  v_cvt_pk_bf16_f32 v122, v80, v81
  v_cvt_pk_bf16_f32 v123, v82, v83
  v_add_f32 v197, v197, v68
  v_add_f32 v198, v198, v69
  v_add_f32 v197, v197, v70
  v_add_f32 v198, v198, v71
  v_add_f32 v197, v197, v72
  v_add_f32 v198, v198, v73
  v_add_f32 v197, v197, v74
  v_add_f32 v198, v198, v75
  v_add_f32 v197, v197, v76
  v_add_f32 v198, v198, v77
  v_add_f32 v197, v197, v78
  v_add_f32 v198, v198, v79
  v_add_f32 v197, v197, v80
  v_add_f32 v198, v198, v81
  v_add_f32 v197, v197, v82
  v_add_f32 v198, v198, v83
  ds_read_b128 v[156:159], v195 offset:8192
  ds_read_b128 v[160:163], v195 offset:10240
  ds_read_b128 v[164:167], v195 offset:12288
  ds_read_b128 v[168:171], v195 offset:14336
  ds_read_b128 v[172:175], v195 offset:9216
  ds_read_b128 v[176:179], v195 offset:11264
  ds_read_b128 v[180:183], v195 offset:13312
  ds_read_b128 v[184:187], v195 offset:15360
  s_waitcnt lgkmcnt(7)
  v_mfma_f32_32x32x16_bf16 v[4:19], v[156:159], v[116:119], v[4:19]
  s_waitcnt lgkmcnt(6)
  v_mfma_f32_32x32x16_bf16 v[20:35], v[160:163], v[116:119], v[20:35]
  s_waitcnt lgkmcnt(5)
  v_mfma_f32_32x32x16_bf16 v[36:51], v[164:167], v[116:119], v[36:51]
  s_waitcnt lgkmcnt(4)
  v_mfma_f32_32x32x16_bf16 v[52:67], v[168:171], v[116:119], v[52:67]
  s_waitcnt lgkmcnt(3)
  v_mfma_f32_32x32x16_bf16 v[4:19], v[172:175], v[120:123], v[4:19]
  s_waitcnt lgkmcnt(2)
  v_mfma_f32_32x32x16_bf16 v[20:35], v[176:179], v[120:123], v[20:35]
  s_waitcnt lgkmcnt(1)
  v_mfma_f32_32x32x16_bf16 v[36:51], v[180:183], v[120:123], v[36:51]
  s_waitcnt lgkmcnt(0)
  v_mfma_f32_32x32x16_bf16 v[52:67], v[184:187], v[120:123], v[52:67]
at_kernel_snext:
  v_add_u32 v195, 0x4000, v195
  v_and_b32 v195, 0x1ffff, v195
  s_add_u32 s17, s17, 1
  s_cmp_lt_u32 s17, s32
  s_cbranch_scc1 at_kernel_sloop
  v_add_f32 v197, v197, v198
  v_mov_b32 v2, v197
  s_nop 1
  v_permlane32_swap_b32 v2, v197
  v_add_f32 v197, v197, v2
  s_waitcnt vmcnt(0)
  v_rcp_f32 v199, v197
  s_lshl_b32 s19, s13, 18
  s_lshl_b32 s20, s11, 12
  s_add_u32 s19, s19, s20
  v_mov_b32 v252, v199
  v_mov_b32 v253, v199
  v_pk_mul_f32 v[4:5], v[4:5], v[252:253]
  v_pk_mul_f32 v[6:7], v[6:7], v[252:253]
  v_pk_mul_f32 v[8:9], v[8:9], v[252:253]
  v_pk_mul_f32 v[10:11], v[10:11], v[252:253]
  v_pk_mul_f32 v[12:13], v[12:13], v[252:253]
  v_pk_mul_f32 v[14:15], v[14:15], v[252:253]
  v_pk_mul_f32 v[16:17], v[16:17], v[252:253]
  v_pk_mul_f32 v[18:19], v[18:19], v[252:253]
  v_cvt_pk_bf16_f32 v68, v4, v5
  v_cvt_pk_bf16_f32 v69, v6, v7
  v_cvt_pk_bf16_f32 v70, v8, v9
  v_cvt_pk_bf16_f32 v71, v10, v11
  buffer_store_dwordx4 v[68:71], v202, s[60:63], s19 offen offset:0 sc1
  v_cvt_pk_bf16_f32 v72, v12, v13
  v_cvt_pk_bf16_f32 v73, v14, v15
  v_cvt_pk_bf16_f32 v74, v16, v17
  v_cvt_pk_bf16_f32 v75, v18, v19
  buffer_store_dwordx4 v[72:75], v202, s[60:63], s19 offen offset:512 sc1
  v_pk_mul_f32 v[20:21], v[20:21], v[252:253]
  v_pk_mul_f32 v[22:23], v[22:23], v[252:253]
  v_pk_mul_f32 v[24:25], v[24:25], v[252:253]
  v_pk_mul_f32 v[26:27], v[26:27], v[252:253]
  v_pk_mul_f32 v[28:29], v[28:29], v[252:253]
  v_pk_mul_f32 v[30:31], v[30:31], v[252:253]
  v_pk_mul_f32 v[32:33], v[32:33], v[252:253]
  v_pk_mul_f32 v[34:35], v[34:35], v[252:253]
  v_cvt_pk_bf16_f32 v76, v20, v21
  v_cvt_pk_bf16_f32 v77, v22, v23
  v_cvt_pk_bf16_f32 v78, v24, v25
  v_cvt_pk_bf16_f32 v79, v26, v27
  buffer_store_dwordx4 v[76:79], v202, s[60:63], s19 offen offset:1024 sc1
  v_cvt_pk_bf16_f32 v80, v28, v29
  v_cvt_pk_bf16_f32 v81, v30, v31
  v_cvt_pk_bf16_f32 v82, v32, v33
  v_cvt_pk_bf16_f32 v83, v34, v35
  buffer_store_dwordx4 v[80:83], v202, s[60:63], s19 offen offset:1536 sc1
  v_pk_mul_f32 v[36:37], v[36:37], v[252:253]
  v_pk_mul_f32 v[38:39], v[38:39], v[252:253]
  v_pk_mul_f32 v[40:41], v[40:41], v[252:253]
  v_pk_mul_f32 v[42:43], v[42:43], v[252:253]
  v_pk_mul_f32 v[44:45], v[44:45], v[252:253]
  v_pk_mul_f32 v[46:47], v[46:47], v[252:253]
  v_pk_mul_f32 v[48:49], v[48:49], v[252:253]
  v_pk_mul_f32 v[50:51], v[50:51], v[252:253]
  v_cvt_pk_bf16_f32 v84, v36, v37
  v_cvt_pk_bf16_f32 v85, v38, v39
  v_cvt_pk_bf16_f32 v86, v40, v41
  v_cvt_pk_bf16_f32 v87, v42, v43
  buffer_store_dwordx4 v[84:87], v202, s[60:63], s19 offen offset:2048 sc1
  v_cvt_pk_bf16_f32 v88, v44, v45
  v_cvt_pk_bf16_f32 v89, v46, v47
  v_cvt_pk_bf16_f32 v90, v48, v49
  v_cvt_pk_bf16_f32 v91, v50, v51
  buffer_store_dwordx4 v[88:91], v202, s[60:63], s19 offen offset:2560 sc1
  v_pk_mul_f32 v[52:53], v[52:53], v[252:253]
  v_pk_mul_f32 v[54:55], v[54:55], v[252:253]
  v_pk_mul_f32 v[56:57], v[56:57], v[252:253]
  v_pk_mul_f32 v[58:59], v[58:59], v[252:253]
  v_pk_mul_f32 v[60:61], v[60:61], v[252:253]
  v_pk_mul_f32 v[62:63], v[62:63], v[252:253]
  v_pk_mul_f32 v[64:65], v[64:65], v[252:253]
  v_pk_mul_f32 v[66:67], v[66:67], v[252:253]
  v_cvt_pk_bf16_f32 v92, v52, v53
  v_cvt_pk_bf16_f32 v93, v54, v55
  v_cvt_pk_bf16_f32 v94, v56, v57
  v_cvt_pk_bf16_f32 v95, v58, v59
  buffer_store_dwordx4 v[92:95], v202, s[60:63], s19 offen offset:3072 sc1
  v_cvt_pk_bf16_f32 v96, v60, v61
  v_cvt_pk_bf16_f32 v97, v62, v63
  v_cvt_pk_bf16_f32 v98, v64, v65
  v_cvt_pk_bf16_f32 v99, v66, v67
  buffer_store_dwordx4 v[96:99], v202, s[60:63], s19 offen offset:3584 sc1
  s_cmp_eq_u32 s12, 7
  s_cbranch_scc1 at_kernel_fin
  s_barrier
  s_mov_b32 s43, s42
  s_add_u32 s19, s10, 0
  s_lshl_b32 s20, s19, 11
  s_add_u32 m0, s20, s43
  s_mul_i32 s19, s19, 28672
  s_add_u32 s19, s19, s41
  buffer_load_dwordx4 v207, s[48:51], s19 offen lds
  buffer_load_dwordx4 v208, s[48:51], s19 offen offset:1024 lds
  s_add_u32 s43, s43, 16384
  s_cmp_eq_u32 s43, 163840
  s_cselect_b32 s43, 0, s43
  s_add_u32 s19, s10, 0
  s_lshl_b32 s20, s19, 11
  s_add_u32 m0, s20, s43
  s_mul_i32 s19, s19, 28672
  s_add_u32 s19, s19, s41
  s_add_u32 s19, s19, 229376
  buffer_load_dwordx4 v207, s[48:51], s19 offen lds
  buffer_load_dwordx4 v208, s[48:51], s19 offen offset:1024 lds
  s_add_u32 s43, s43, 16384
  s_cmp_eq_u32 s43, 163840
  s_cselect_b32 s43, 0, s43
  s_add_u32 s19, s10, 0
  s_lshl_b32 s20, s19, 11
  s_add_u32 m0, s20, s43
  s_mul_i32 s19, s19, 28672
  s_add_u32 s19, s19, s41
  s_add_u32 s19, s19, 458752
  buffer_load_dwordx4 v207, s[48:51], s19 offen lds
  buffer_load_dwordx4 v208, s[48:51], s19 offen offset:1024 lds
  s_add_u32 s43, s43, 16384
  s_cmp_eq_u32 s43, 163840
  s_cselect_b32 s43, 0, s43
  s_add_u32 s19, s10, 0
  s_lshl_b32 s20, s19, 11
  s_add_u32 m0, s20, s43
  s_mul_i32 s19, s19, 28672
  s_add_u32 s19, s19, s41
  s_add_u32 s19, s19, 688128
  buffer_load_dwordx4 v207, s[48:51], s19 offen lds
  buffer_load_dwordx4 v208, s[48:51], s19 offen offset:1024 lds
  s_add_u32 s43, s43, 16384
  s_cmp_eq_u32 s43, 163840
  s_cselect_b32 s43, 0, s43
  s_add_u32 s19, s10, 0
  s_lshl_b32 s20, s19, 11
  s_add_u32 m0, s20, s43
  s_mul_i32 s19, s19, 28672
  s_add_u32 s19, s19, s41
  s_add_u32 s19, s19, 917504
  buffer_load_dwordx4 v207, s[48:51], s19 offen lds
  buffer_load_dwordx4 v208, s[48:51], s19 offen offset:1024 lds
  s_add_u32 s43, s43, 16384
  s_cmp_eq_u32 s43, 163840
  s_cselect_b32 s43, 0, s43
  s_waitcnt vmcnt(0)
  s_barrier
  s_branch at_kernel_nopack
.text
.globl fin_kernel
.p2align 8
.type fin_kernel,@function
fin_kernel:
  s_cmp_ge_u32 s2, 256
  s_cbranch_scc1 fin_kernel_done
  s_load_dwordx2 s[4:5], s[0:1], 104
  s_load_dwordx2 s[6:7], s[0:1], 0
  s_load_dwordx2 s[8:9], s[0:1], 88
  v_and_b32 v1, 63, v0
  v_lshrrev_b32 v2, 6, v0
  s_nop 0
  v_readfirstlane_b32 s10, v2
  v_and_b32 v4, 15, v1
  v_lshrrev_b32 v5, 4, v1
  s_lshr_b32 s11, s10, 2
  s_and_b32 s12, s2, 1
  s_bfe_u32 s16, s2, 0x20001
  s_lshl_b32 s16, s16, 2
  s_bfe_u32 s17, s2, 0x20003
  s_add_u32 s13, s16, s17
  s_lshr_b32 s14, s2, 5
  s_and_b32 s16, s10, 3
  s_lshl_b32 s16, s16, 1
  s_lshl_b32 s15, s13, 3
  s_add_u32 s15, s15, s16
  v_lshrrev_b32 v2, 3, v1
  v_bfe_u32 v3, v1, 1, 2
  v_bfe_u32 v7, v1, 4, 2
  v_xor_b32 v3, v3, v7
  v_lshlrev_b32 v3, 5, v3
  v_and_b32 v7, 1, v1
  v_lshl_add_u32 v3, v7, 4, v3
  v_lshl_add_u32 v6, v2, 7, v3
  v_add_u32 v7, 0, v6
  s_lshl_b32 s18, s10, 11
  s_cmp_eq_u32 s12, 1
  s_lshl_b32 s20, s15, 17
  s_add_u32 s20, s20, 8388608
  s_mul_i32 s16, s15, 57344
  s_cmp_eq_u32 s12, 1
  s_cselect_b32 s19, s16, s20
  s_mul_i32 s16, s12, 36864
  s_add_u32 s16, s16, 57344
  s_add_u32 s20, s20, s16
  s_lshl_b32 s22, s14, 19
  s_add_u32 s22, s22, s18
  s_mul_i32 s16, s14, 229376
  s_add_u32 s16, s16, 4194304
  s_add_u32 s16, s16, s18
  s_cmp_eq_u32 s12, 1
  s_cselect_b32 s21, s16, s22
  s_mul_i32 s16, s12, 147456
  s_add_u32 s16, s16, 229376
  s_add_u32 s22, s22, s16
  s_lshl_b32 s17, s11, 10
  v_lshlrev_b32 v2, 4, v1
  v_add_u32 v2, s17, v2
  s_cmp_eq_u32 s12, 1
  s_cselect_b32 s16, 57344, 0
  v_add_u32 v8, s16, v2
  s_cselect_b32 s16, 0, 131072
  v_add_u32 v9, s16, v2
  v_add_u32 v11, s16, v2
  s_cselect_b32 s16, 131072, 0
  v_add_u32 v10, s16, v2
  s_waitcnt lgkmcnt(0)
  s_add_u32 s24, s4, 100663296
  s_addc_u32 s25, s5, 0
  s_mov_b32 s26, 6029312
  s_mov_b32 s27, 0x20000
  s_add_u32 s28, s4, 46137344
  s_addc_u32 s29, s5, 0
  s_mov_b32 s30, 25165824
  s_mov_b32 s31, 0x20000
  s_add_u32 m0, s18, 0
  s_nop 0
  buffer_load_dwordx4 v6, s[24:27], s21 offen lds
  buffer_load_dwordx4 v7, s[24:27], s21 offen offset:1024 lds
  buffer_load_dwordx4 v[12:15], v8, s[28:31], s19 offen offset:0
  buffer_load_dwordx4 v[16:19], v9, s[28:31], s19 offen offset:0
  buffer_load_dwordx4 v[20:23], v8, s[28:31], s19 offen offset:2048
  buffer_load_dwordx4 v[24:27], v9, s[28:31], s19 offen offset:2048
  s_add_u32 m0, s18, 16384
  s_add_u32 s16, s21, 16384
  buffer_load_dwordx4 v6, s[24:27], s16 offen lds
  buffer_load_dwordx4 v7, s[24:27], s16 offen offset:1024 lds
  s_add_u32 s17, s19, 4096
  buffer_load_dwordx4 v[28:31], v8, s[28:31], s17 offen offset:0
  buffer_load_dwordx4 v[32:35], v9, s[28:31], s17 offen offset:0
  s_add_u32 s17, s19, 4096
  buffer_load_dwordx4 v[36:39], v8, s[28:31], s17 offen offset:2048
  buffer_load_dwordx4 v[40:43], v9, s[28:31], s17 offen offset:2048
  s_add_u32 m0, s18, 32768
  s_add_u32 s16, s21, 32768
  buffer_load_dwordx4 v6, s[24:27], s16 offen lds
  buffer_load_dwordx4 v7, s[24:27], s16 offen offset:1024 lds
  s_add_u32 s17, s19, 8192
  buffer_load_dwordx4 v[44:47], v8, s[28:31], s17 offen offset:0
  buffer_load_dwordx4 v[48:51], v9, s[28:31], s17 offen offset:0
  s_add_u32 s17, s19, 8192
  buffer_load_dwordx4 v[52:55], v8, s[28:31], s17 offen offset:2048
  buffer_load_dwordx4 v[56:59], v9, s[28:31], s17 offen offset:2048
  s_add_u32 m0, s18, 49152
  s_add_u32 s16, s21, 49152
  buffer_load_dwordx4 v6, s[24:27], s16 offen lds
  buffer_load_dwordx4 v7, s[24:27], s16 offen offset:1024 lds
  s_add_u32 m0, s18, 65536
  s_add_u32 s16, s21, 65536
  buffer_load_dwordx4 v6, s[24:27], s16 offen lds
  buffer_load_dwordx4 v7, s[24:27], s16 offen offset:1024 lds
  s_add_u32 m0, s18, 81920
  s_add_u32 s16, s21, 81920
  buffer_load_dwordx4 v6, s[24:27], s16 offen lds
  buffer_load_dwordx4 v7, s[24:27], s16 offen offset:1024 lds
  s_add_u32 m0, s18, 98304
  s_add_u32 s16, s21, 98304
  buffer_load_dwordx4 v6, s[24:27], s16 offen lds
  buffer_load_dwordx4 v7, s[24:27], s16 offen offset:1024 lds
  s_add_u32 m0, s18, 114688
  s_add_u32 s16, s21, 114688
  buffer_load_dwordx4 v6, s[24:27], s16 offen lds
  buffer_load_dwordx4 v7, s[24:27], s16 offen offset:1024 lds
  v_lshrrev_b32 v2, 2, v4
  v_lshl_add_u32 v2, v5, 2, v2
  v_bfe_u32 v3, v2, 1, 2
  s_lshl_b32 s16, s11, 1
  v_xor_b32 v3, s16, v3
  v_lshlrev_b32 v2, 7, v2
  v_and_b32 v188, 3, v1
  v_lshl_add_u32 v2, v188, 3, v2
  s_lshl_b32 s16, s11, 12
  v_add_u32 v2, s16, v2
  v_lshrrev_b32 v196, 1, v5
  v_lshlrev_b32 v196, 10, v196
  s_cmp_eq_u32 s12, 1
  s_cselect_b32 s16, 0, -1
  v_and_b32 v192, s16, v196
  v_add_u32 v2, v192, v2
  s_cselect_b32 s16, -1, 0
  v_and_b32 v196, s16, v196
  s_mul_i32 s17, s12, 1024
  s_add_u32 s17, s17, 1024
  v_xor_b32 v188, 0, v3
  v_lshl_add_u32 v188, v188, 5, v2
  v_add_u32 v192, s17, v188
  v_xor_b32 v189, 1, v3
  v_lshl_add_u32 v189, v189, 5, v2
  v_add_u32 v193, s17, v189
  v_xor_b32 v190, 2, v3
  v_lshl_add_u32 v190, v190, 5, v2
  v_add_u32 v194, s17, v190
  v_xor_b32 v191, 3, v3
  v_lshl_add_u32 v191, v191, 5, v2
  v_add_u32 v195, s17, v191
  s_cmp_eq_u32 s12, 1
  s_cselect_b32 s32, 1024, 0
  v_lshlrev_b32 v216, 4, v1
  s_add_u32 s34, s15, s12
  s_lshl_b32 s33, s34, 14
  s_lshl_b32 s16, s14, 1
  s_add_u32 s16, s16, s11
  s_lshl_b32 s16, s16, 10
  s_add_u32 s33, s33, s16
  s_add_u32 s36, s4, 41943040
  s_addc_u32 s37, s5, 0
  s_mov_b32 s38, 2097152
  s_mov_b32 s39, 0x20000
  s_mov_b32 s40, s6
  s_mov_b32 s41, s7
  s_mov_b32 s42, 2097152
  s_mov_b32 s43, 0x20000
  s_mov_b32 s44, s8
  s_mov_b32 s45, s9
  s_mov_b32 s46, 2097152
  s_mov_b32 s47, 0x20000
  v_and_b32 v2, 1, v5
  v_lshlrev_b32 v2, 5, v2
  v_lshrrev_b32 v3, 1, v5
  v_lshl_add_u32 v2, v3, 4, v2
  v_lshl_add_u32 v217, v4, 10, v2
  s_lshl_b32 s48, s34, 14
  s_lshl_b32 s16, s14, 7
  s_lshl_b32 s17, s11, 6
  s_add_u32 s16, s16, s17
  s_add_u32 s48, s48, s16
  s_add_u32 s52, s4, 71303168
  s_addc_u32 s53, s5, 0
  s_mov_b32 s54, 8388608
  s_mov_b32 s55, 0x20000
  s_lshl_b32 s56, s2, 15
  s_lshl_b32 s16, s10, 12
  s_add_u32 s56, s56, s16
  s_xor_b32 s57, s56, 32768
  s_add_u32 s16, s16, 131072
  v_add_u32 v218, s16, v216
  v_xor_b32 v219, 16384, v218
  s_waitcnt vmcnt(26)
  s_barrier
  ds_read_b64_tr_b16 v[60:61], v188 offset:0
  ds_read_b64_tr_b16 v[62:63], v192 offset:0
  ds_read_b64_tr_b16 v[64:65], v189 offset:0
  ds_read_b64_tr_b16 v[66:67], v193 offset:0
  ds_read_b64_tr_b16 v[68:69], v190 offset:0
  ds_read_b64_tr_b16 v[70:71], v194 offset:0
  ds_read_b64_tr_b16 v[72:73], v191 offset:0
  ds_read_b64_tr_b16 v[74:75], v195 offset:0
  ds_read_b64_tr_b16 v[76:77], v188 offset:8192
  ds_read_b64_tr_b16 v[78:79], v192 offset:8192
  ds_read_b64_tr_b16 v[80:81], v189 offset:8192
  ds_read_b64_tr_b16 v[82:83], v193 offset:8192
  ds_read_b64_tr_b16 v[84:85], v190 offset:8192
  ds_read_b64_tr_b16 v[86:87], v194 offset:8192
  s_waitcnt vmcnt(25) lgkmcnt(12)
  v_mfma_f32_16x16x32_bf16 v[92:95], v[60:63], v[12:15], 0
  s_waitcnt vmcnt(24)
  v_mfma_f32_16x16x32_bf16 v[108:111], v[60:63], v[16:19], 0
  ds_read_b64_tr_b16 v[88:89], v191 offset:8192
  ds_read_b64_tr_b16 v[90:91], v195 offset:8192
  s_waitcnt lgkmcnt(12)
  v_mfma_f32_16x16x32_bf16 v[96:99], v[64:67], v[12:15], 0
  v_mfma_f32_16x16x32_bf16 v[112:115], v[64:67], v[16:19], 0
  s_waitcnt vmcnt(20)
  s_barrier
  ds_read_b64_tr_b16 v[60:61], v188 offset:16384
  ds_read_b64_tr_b16 v[62:63], v192 offset:16384
  s_waitcnt lgkmcnt(12)
  v_mfma_f32_16x16x32_bf16 v[100:103], v[68:71], v[12:15], 0
  v_mfma_f32_16x16x32_bf16 v[116:119], v[68:71], v[16:19], 0
  ds_read_b64_tr_b16 v[64:65], v189 offset:16384
  ds_read_b64_tr_b16 v[66:67], v193 offset:16384
  s_waitcnt lgkmcnt(12)
  v_mfma_f32_16x16x32_bf16 v[104:107], v[72:75], v[12:15], 0
  v_mfma_f32_16x16x32_bf16 v[120:123], v[72:75], v[16:19], 0
  ds_read_b64_tr_b16 v[68:69], v190 offset:16384
  ds_read_b64_tr_b16 v[70:71], v194 offset:16384
  s_add_u32 s17, s19, 12288
  buffer_load_dwordx4 v[12:15], v8, s[28:31], s17 offen offset:0
  buffer_load_dwordx4 v[16:19], v9, s[28:31], s17 offen offset:0
  s_waitcnt lgkmcnt(12)
  v_mfma_f32_16x16x32_bf16 v[92:95], v[76:79], v[20:23], v[92:95]
  v_mfma_f32_16x16x32_bf16 v[108:111], v[76:79], v[24:27], v[108:111]
  ds_read_b64_tr_b16 v[72:73], v191 offset:16384
  ds_read_b64_tr_b16 v[74:75], v195 offset:16384
  s_waitcnt lgkmcnt(12)
  v_mfma_f32_16x16x32_bf16 v[96:99], v[80:83], v[20:23], v[96:99]
  v_mfma_f32_16x16x32_bf16 v[112:115], v[80:83], v[24:27], v[112:115]
  ds_read_b64_tr_b16 v[76:77], v188 offset:24576
  ds_read_b64_tr_b16 v[78:79], v192 offset:24576
  s_waitcnt lgkmcnt(12)
  v_mfma_f32_16x16x32_bf16 v[100:103], v[84:87], v[20:23], v[100:103]
  v_mfma_f32_16x16x32_bf16 v[116:119], v[84:87], v[24:27], v[116:119]
  ds_read_b64_tr_b16 v[80:81], v189 offset:24576
  ds_read_b64_tr_b16 v[82:83], v193 offset:24576
  s_waitcnt lgkmcnt(12)
  v_mfma_f32_16x16x32_bf16 v[104:107], v[88:91], v[20:23], v[104:107]
  v_mfma_f32_16x16x32_bf16 v[120:123], v[88:91], v[24:27], v[120:123]
  ds_read_b64_tr_b16 v[84:85], v190 offset:24576
  ds_read_b64_tr_b16 v[86:87], v194 offset:24576
  s_add_u32 s17, s19, 12288
  buffer_load_dwordx4 v[20:23], v8, s[28:31], s17 offen offset:2048
  buffer_load_dwordx4 v[24:27], v9, s[28:31], s17 offen offset:2048
  s_waitcnt vmcnt(23) lgkmcnt(12)
  v_mfma_f32_16x16x32_bf16 v[92:95], v[60:63], v[28:31], v[92:95]
  s_waitcnt vmcnt(22)
  v_mfma_f32_16x16x32_bf16 v[108:111], v[60:63], v[32:35], v[108:111]
  ds_read_b64_tr_b16 v[88:89], v191 offset:24576
  ds_read_b64_tr_b16 v[90:91], v195 offset:24576
  s_waitcnt lgkmcnt(12)
  v_mfma_f32_16x16x32_bf16 v[96:99], v[64:67], v[28:31], v[96:99]
  v_mfma_f32_16x16x32_bf16 v[112:115], v[64:67], v[32:35], v[112:115]
  s_waitcnt vmcnt(18)
  s_barrier
  ds_read_b64_tr_b16 v[60:61], v188 offset:32768
  ds_read_b64_tr_b16 v[62:63], v192 offset:32768
  s_add_u32 m0, s18, 0
  s_add_u32 s16, s21, 131072
  buffer_load_dwordx4 v6, s[24:27], s16 offen lds
  buffer_load_dwordx4 v7, s[24:27], s16 offen offset:1024 lds
  s_waitcnt lgkmcnt(12)
  v_mfma_f32_16x16x32_bf16 v[100:103], v[68:71], v[28:31], v[100:103]
  v_mfma_f32_16x16x32_bf16 v[116:119], v[68:71], v[32:35], v[116:119]
  ds_read_b64_tr_b16 v[64:65], v189 offset:32768
  ds_read_b64_tr_b16 v[66:67], v193 offset:32768
  s_waitcnt lgkmcnt(12)
  v_mfma_f32_16x16x32_bf16 v[104:107], v[72:75], v[28:31], v[104:107]
  v_mfma_f32_16x16x32_bf16 v[120:123], v[72:75], v[32:35], v[120:123]
  ds_read_b64_tr_b16 v[68:69], v190 offset:32768
  ds_read_b64_tr_b16 v[70:71], v194 offset:32768
  s_add_u32 s17, s19, 16384
  buffer_load_dwordx4 v[28:31], v8, s[28:31], s17 offen offset:0
  buffer_load_dwordx4 v[32:35], v9, s[28:31], s17 offen offset:0
  s_waitcnt lgkmcnt(12)
  v_mfma_f32_16x16x32_bf16 v[92:95], v[76:79], v[36:39], v[92:95]
  v_mfma_f32_16x16x32_bf16 v[108:111], v[76:79], v[40:43], v[108:111]
  ds_read_b64_tr_b16 v[72:73], v191 offset:32768
  ds_read_b64_tr_b16 v[74:75], v195 offset:32768
  s_waitcnt lgkmcnt(12)
  v_mfma_f32_16x16x32_bf16 v[96:99], v[80:83], v[36:39], v[96:99]
  v_mfma_f32_16x16x32_bf16 v[112:115], v[80:83], v[40:43], v[112:115]
  ds_read_b64_tr_b16 v[76:77], v188 offset:40960
  ds_read_b64_tr_b16 v[78:79], v192 offset:40960
  s_waitcnt lgkmcnt(12)
  v_mfma_f32_16x16x32_bf16 v[100:103], v[84:87], v[36:39], v[100:103]
  v_mfma_f32_16x16x32_bf16 v[116:119], v[84:87], v[40:43], v[116:119]
  ds_read_b64_tr_b16 v[80:81], v189 offset:40960
  ds_read_b64_tr_b16 v[82:83], v193 offset:40960
  s_waitcnt lgkmcnt(12)
  v_mfma_f32_16x16x32_bf16 v[104:107], v[88:91], v[36:39], v[104:107]
  v_mfma_f32_16x16x32_bf16 v[120:123], v[88:91], v[40:43], v[120:123]
  ds_read_b64_tr_b16 v[84:85], v190 offset:40960
  ds_read_b64_tr_b16 v[86:87], v194 offset:40960
  s_add_u32 s17, s19, 16384
  buffer_load_dwordx4 v[36:39], v8, s[28:31], s17 offen offset:2048
  buffer_load_dwordx4 v[40:43], v9, s[28:31], s17 offen offset:2048
  s_waitcnt vmcnt(23) lgkmcnt(12)
  v_mfma_f32_16x16x32_bf16 v[92:95], v[60:63], v[44:47], v[92:95]
  s_waitcnt vmcnt(22)
  v_mfma_f32_16x16x32_bf16 v[108:111], v[60:63], v[48:51], v[108:111]
  ds_read_b64_tr_b16 v[88:89], v191 offset:40960
  ds_read_b64_tr_b16 v[90:91], v195 offset:40960
  s_waitcnt lgkmcnt(12)
  v_mfma_f32_16x16x32_bf16 v[96:99], v[64:67], v[44:47], v[96:99]
  v_mfma_f32_16x16x32_bf16 v[112:115], v[64:67], v[48:51], v[112:115]
  s_waitcnt vmcnt(18)
  s_barrier
  ds_read_b64_tr_b16 v[60:61], v188 offset:49152
  ds_read_b64_tr_b16 v[62:63], v192 offset:49152
  s_add_u32 m0, s18, 16384
  s_add_u32 s16, s21, 147456
  buffer_load_dwordx4 v6, s[24:27], s16 offen lds
  buffer_load_dwordx4 v7, s[24:27], s16 offen offset:1024 lds
  s_waitcnt lgkmcnt(12)
  v_mfma_f32_16x16x32_bf16 v[100:103], v[68:71], v[44:47], v[100:103]
  v_mfma_f32_16x16x32_bf16 v[116:119], v[68:71], v[48:51], v[116:119]
  ds_read_b64_tr_b16 v[64:65], v189 offset:49152
  ds_read_b64_tr_b16 v[66:67], v193 offset:49152
  s_waitcnt lgkmcnt(12)
  v_mfma_f32_16x16x32_bf16 v[104:107], v[72:75], v[44:47], v[104:107]
  v_mfma_f32_16x16x32_bf16 v[120:123], v[72:75], v[48:51], v[120:123]
  ds_read_b64_tr_b16 v[68:69], v190 offset:49152
  ds_read_b64_tr_b16 v[70:71], v194 offset:49152
  s_add_u32 s17, s19, 20480
  buffer_load_dwordx4 v[44:47], v8, s[28:31], s17 offen offset:0
  buffer_load_dwordx4 v[48:51], v9, s[28:31], s17 offen offset:0
  s_waitcnt lgkmcnt(12)
  v_mfma_f32_16x16x32_bf16 v[92:95], v[76:79], v[52:55], v[92:95]
  v_mfma_f32_16x16x32_bf16 v[108:111], v[76:79], v[56:59], v[108:111]
  ds_read_b64_tr_b16 v[72:73], v191 offset:49152
  ds_read_b64_tr_b16 v[74:75], v195 offset:49152
  s_waitcnt lgkmcnt(12)
  v_mfma_f32_16x16x32_bf16 v[96:99], v[80:83], v[52:55], v[96:99]
  v_mfma_f32_16x16x32_bf16 v[112:115], v[80:83], v[56:59], v[112:115]
  ds_read_b64_tr_b16 v[76:77], v188 offset:57344
  ds_read_b64_tr_b16 v[78:79], v192 offset:57344
  s_waitcnt lgkmcnt(12)
  v_mfma_f32_16x16x32_bf16 v[100:103], v[84:87], v[52:55], v[100:103]
  v_mfma_f32_16x16x32_bf16 v[116:119], v[84:87], v[56:59], v[116:119]
  ds_read_b64_tr_b16 v[80:81], v189 offset:57344
  ds_read_b64_tr_b16 v[82:83], v193 offset:57344
  s_waitcnt lgkmcnt(12)
  v_mfma_f32_16x16x32_bf16 v[104:107], v[88:91], v[52:55], v[104:107]
  v_mfma_f32_16x16x32_bf16 v[120:123], v[88:91], v[56:59], v[120:123]
  ds_read_b64_tr_b16 v[84:85], v190 offset:57344
  ds_read_b64_tr_b16 v[86:87], v194 offset:57344
  s_add_u32 s17, s19, 20480
  buffer_load_dwordx4 v[52:55], v8, s[28:31], s17 offen offset:2048
  buffer_load_dwordx4 v[56:59], v9, s[28:31], s17 offen offset:2048
  s_waitcnt vmcnt(15) lgkmcnt(12)
  v_mfma_f32_16x16x32_bf16 v[92:95], v[60:63], v[12:15], v[92:95]
  s_waitcnt vmcnt(14)
  v_mfma_f32_16x16x32_bf16 v[108:111], v[60:63], v[16:19], v[108:111]
  ds_read_b64_tr_b16 v[88:89], v191 offset:57344
  ds_read_b64_tr_b16 v[90:91], v195 offset:57344
  s_waitcnt lgkmcnt(12)
  v_mfma_f32_16x16x32_bf16 v[96:99], v[64:67], v[12:15], v[96:99]
  v_mfma_f32_16x16x32_bf16 v[112:115], v[64:67], v[16:19], v[112:115]
  s_barrier
  v_xor_b32 v188, 0x10000, v188
  v_xor_b32 v192, 0x10000, v192
  v_xor_b32 v189, 0x10000, v189
  v_xor_b32 v193, 0x10000, v193
  v_xor_b32 v190, 0x10000, v190
  v_xor_b32 v194, 0x10000, v194
  v_xor_b32 v191, 0x10000, v191
  v_xor_b32 v195, 0x10000, v195
  ds_read_b64_tr_b16 v[60:61], v188 offset:0
  ds_read_b64_tr_b16 v[62:63], v192 offset:0
  s_add_u32 m0, s18, 32768
  s_add_u32 s16, s21, 163840
  buffer_load_dwordx4 v6, s[24:27], s16 offen lds
  buffer_load_dwordx4 v7, s[24:27], s16 offen offset:1024 lds
  s_waitcnt lgkmcnt(12)
  v_mfma_f32_16x16x32_bf16 v[100:103], v[68:71], v[12:15], v[100:103]
  v_mfma_f32_16x16x32_bf16 v[116:119], v[68:71], v[16:19], v[116:119]
  ds_read_b64_tr_b16 v[64:65], v189 offset:0
  ds_read_b64_tr_b16 v[66:67], v193 offset:0
  s_waitcnt lgkmcnt(12)
  v_mfma_f32_16x16x32_bf16 v[104:107], v[72:75], v[12:15], v[104:107]
  v_mfma_f32_16x16x32_bf16 v[120:123], v[72:75], v[16:19], v[120:123]
  ds_read_b64_tr_b16 v[68:69], v190 offset:0
  ds_read_b64_tr_b16 v[70:71], v194 offset:0
  s_add_u32 s17, s19, 24576
  buffer_load_dwordx4 v[12:15], v8, s[28:31], s17 offen offset:0
  buffer_load_dwordx4 v[16:19], v9, s[28:31], s17 offen offset:0
  s_waitcnt vmcnt(17) lgkmcnt(12)
  v_mfma_f32_16x16x32_bf16 v[92:95], v[76:79], v[20:23], v[92:95]
  s_waitcnt vmcnt(16)
  v_mfma_f32_16x16x32_bf16 v[108:111], v[76:79], v[24:27], v[108:111]
  ds_read_b64_tr_b16 v[72:73], v191 offset:0
  ds_read_b64_tr_b16 v[74:75], v195 offset:0
  s_waitcnt lgkmcnt(12)
  v_mfma_f32_16x16x32_bf16 v[96:99], v[80:83], v[20:23], v[96:99]
  v_mfma_f32_16x16x32_bf16 v[112:115], v[80:83], v[24:27], v[112:115]
  ds_read_b64_tr_b16 v[76:77], v188 offset:8192
  ds_read_b64_tr_b16 v[78:79], v192 offset:8192
  s_waitcnt lgkmcnt(12)
  v_mfma_f32_16x16x32_bf16 v[100:103], v[84:87], v[20:23], v[100:103]
  v_mfma_f32_16x16x32_bf16 v[116:119], v[84:87], v[24:27], v[116:119]
  ds_read_b64_tr_b16 v[80:81], v189 offset:8192
  ds_read_b64_tr_b16 v[82:83], v193 offset:8192
  s_waitcnt lgkmcnt(12)
  v_mfma_f32_16x16x32_bf16 v[104:107], v[88:91], v[20:23], v[104:107]
  v_mfma_f32_16x16x32_bf16 v[120:123], v[88:91], v[24:27], v[120:123]
  ds_read_b64_tr_b16 v[84:85], v190 offset:8192
  ds_read_b64_tr_b16 v[86:87], v194 offset:8192
  s_add_u32 s17, s19, 24576
  buffer_load_dwordx4 v[20:23], v8, s[28:31], s17 offen offset:2048
  buffer_load_dwordx4 v[24:27], v9, s[28:31], s17 offen offset:2048
  s_waitcnt vmcnt(15) lgkmcnt(12)
  v_mfma_f32_16x16x32_bf16 v[92:95], v[60:63], v[28:31], v[92:95]
  s_waitcnt vmcnt(14)
  v_mfma_f32_16x16x32_bf16 v[108:111], v[60:63], v[32:35], v[108:111]
  ds_read_b64_tr_b16 v[88:89], v191 offset:8192
  ds_read_b64_tr_b16 v[90:91], v195 offset:8192
  s_waitcnt lgkmcnt(12)
  v_mfma_f32_16x16x32_bf16 v[96:99], v[64:67], v[28:31], v[96:99]
  v_mfma_f32_16x16x32_bf16 v[112:115], v[64:67], v[32:35], v[112:115]
  s_barrier
  ds_read_b64_tr_b16 v[60:61], v188 offset:16384
  ds_read_b64_tr_b16 v[62:63], v192 offset:16384
  s_add_u32 m0, s18, 49152
  s_add_u32 s16, s21, 180224
  buffer_load_dwordx4 v6, s[24:27], s16 offen lds
  buffer_load_dwordx4 v7, s[24:27], s16 offen offset:1024 lds
  s_waitcnt lgkmcnt(12)
  v_mfma_f32_16x16x32_bf16 v[100:103], v[68:71], v[28:31], v[100:103]
  v_mfma_f32_16x16x32_bf16 v[116:119], v[68:71], v[32:35], v[116:119]
  ds_read_b64_tr_b16 v[64:65], v189 offset:16384
  ds_read_b64_tr_b16 v[66:67], v193 offset:16384
  s_waitcnt lgkmcnt(12)
  v_mfma_f32_16x16x32_bf16 v[104:107], v[72:75], v[28:31], v[104:107]
  v_mfma_f32_16x16x32_bf16 v[120:123], v[72:75], v[32:35], v[120:123]
  ds_read_b64_tr_b16 v[68:69], v190 offset:16384
  ds_read_b64_tr_b16 v[70:71], v194 offset:16384
  s_add_u32 s17, s19, 28672
  buffer_load_dwordx4 v[28:31], v8, s[28:31], s17 offen offset:0
  buffer_load_dwordx4 v[32:35], v9, s[28:31], s17 offen offset:0
  s_waitcnt vmcnt(17) lgkmcnt(12)
  v_mfma_f32_16x16x32_bf16 v[92:95], v[76:79], v[36:39], v[92:95]
  s_waitcnt vmcnt(16)
  v_mfma_f32_16x16x32_bf16 v[108:111], v[76:79], v[40:43], v[108:111]
  ds_read_b64_tr_b16 v[72:73], v191 offset:16384
  ds_read_b64_tr_b16 v[74:75], v195 offset:16384
  s_waitcnt lgkmcnt(12)
  v_mfma_f32_16x16x32_bf16 v[96:99], v[80:83], v[36:39], v[96:99]
  v_mfma_f32_16x16x32_bf16 v[112:115], v[80:83], v[40:43], v[112:115]
  ds_read_b64_tr_b16 v[76:77], v188 offset:24576
  ds_read_b64_tr_b16 v[78:79], v192 offset:24576
  s_waitcnt lgkmcnt(12)
  v_mfma_f32_16x16x32_bf16 v[100:103], v[84:87], v[36:39], v[100:103]
  v_mfma_f32_16x16x32_bf16 v[116:119], v[84:87], v[40:43], v[116:119]
  ds_read_b64_tr_b16 v[80:81], v189 offset:24576
  ds_read_b64_tr_b16 v[82:83], v193 offset:24576
  s_waitcnt lgkmcnt(12)
  v_mfma_f32_16x16x32_bf16 v[104:107], v[88:91], v[36:39], v[104:107]
  v_mfma_f32_16x16x32_bf16 v[120:123], v[88:91], v[40:43], v[120:123]
  ds_read_b64_tr_b16 v[84:85], v190 offset:24576
  ds_read_b64_tr_b16 v[86:87], v194 offset:24576
  s_add_u32 s17, s19, 28672
  buffer_load_dwordx4 v[36:39], v8, s[28:31], s17 offen offset:2048
  buffer_load_dwordx4 v[40:43], v9, s[28:31], s17 offen offset:2048
  s_waitcnt vmcnt(15) lgkmcnt(12)
  v_mfma_f32_16x16x32_bf16 v[92:95], v[60:63], v[44:47], v[92:95]
  s_waitcnt vmcnt(14)
  v_mfma_f32_16x16x32_bf16 v[108:111], v[60:63], v[48:51], v[108:111]
  ds_read_b64_tr_b16 v[88:89], v191 offset:24576
  ds_read_b64_tr_b16 v[90:91], v195 offset:24576
  s_waitcnt lgkmcnt(12)
  v_mfma_f32_16x16x32_bf16 v[96:99], v[64:67], v[44:47], v[96:99]
  v_mfma_f32_16x16x32_bf16 v[112:115], v[64:67], v[48:51], v[112:115]
  s_barrier
  ds_read_b64_tr_b16 v[60:61], v188 offset:32768
  ds_read_b64_tr_b16 v[62:63], v192 offset:32768
  s_add_u32 m0, s18, 65536
  s_add_u32 s16, s21, 196608
  buffer_load_dwordx4 v6, s[24:27], s16 offen lds
  buffer_load_dwordx4 v7, s[24:27], s16 offen offset:1024 lds
  s_waitcnt lgkmcnt(12)
  v_mfma_f32_16x16x32_bf16 v[100:103], v[68:71], v[44:47], v[100:103]
  v_mfma_f32_16x16x32_bf16 v[116:119], v[68:71], v[48:51], v[116:119]
  ds_read_b64_tr_b16 v[64:65], v189 offset:32768
  ds_read_b64_tr_b16 v[66:67], v193 offset:32768
  s_waitcnt lgkmcnt(12)
  v_mfma_f32_16x16x32_bf16 v[104:107], v[72:75], v[44:47], v[104:107]
  v_mfma_f32_16x16x32_bf16 v[120:123], v[72:75], v[48:51], v[120:123]
  ds_read_b64_tr_b16 v[68:69], v190 offset:32768
  ds_read_b64_tr_b16 v[70:71], v194 offset:32768
  s_add_u32 s17, s19, 32768
  buffer_load_dwordx4 v[44:47], v8, s[28:31], s17 offen offset:0
  buffer_load_dwordx4 v[48:51], v9, s[28:31], s17 offen offset:0
  s_waitcnt vmcnt(17) lgkmcnt(12)
  v_mfma_f32_16x16x32_bf16 v[92:95], v[76:79], v[52:55], v[92:95]
  s_waitcnt vmcnt(16)
  v_mfma_f32_16x16x32_bf16 v[108:111], v[76:79], v[56:59], v[108:111]
  ds_read_b64_tr_b16 v[72:73], v191 offset:32768
  ds_read_b64_tr_b16 v[74:75], v195 offset:32768
  s_waitcnt lgkmcnt(12)
  v_mfma_f32_16x16x32_bf16 v[96:99], v[80:83], v[52:55], v[96:99]
  v_mfma_f32_16x16x32_bf16 v[112:115], v[80:83], v[56:59], v[112:115]
  ds_read_b64_tr_b16 v[76:77], v188 offset:40960
  ds_read_b64_tr_b16 v[78:79], v192 offset:40960
  s_waitcnt lgkmcnt(12)
  v_mfma_f32_16x16x32_bf16 v[100:103], v[84:87], v[52:55], v[100:103]
  v_mfma_f32_16x16x32_bf16 v[116:119], v[84:87], v[56:59], v[116:119]
  ds_read_b64_tr_b16 v[80:81], v189 offset:40960
  ds_read_b64_tr_b16 v[82:83], v193 offset:40960
  s_waitcnt lgkmcnt(12)
  v_mfma_f32_16x16x32_bf16 v[104:107], v[88:91], v[52:55], v[104:107]
  v_mfma_f32_16x16x32_bf16 v[120:123], v[88:91], v[56:59], v[120:123]
  ds_read_b64_tr_b16 v[84:85], v190 offset:40960
  ds_read_b64_tr_b16 v[86:87], v194 offset:40960
  s_add_u32 s17, s19, 32768
  buffer_load_dwordx4 v[52:55], v8, s[28:31], s17 offen offset:2048
  buffer_load_dwordx4 v[56:59], v9, s[28:31], s17 offen offset:2048
  s_waitcnt vmcnt(15) lgkmcnt(12)
  v_mfma_f32_16x16x32_bf16 v[92:95], v[60:63], v[12:15], v[92:95]
  s_waitcnt vmcnt(14)
  v_mfma_f32_16x16x32_bf16 v[108:111], v[60:63], v[16:19], v[108:111]
  ds_read_b64_tr_b16 v[88:89], v191 offset:40960
  ds_read_b64_tr_b16 v[90:91], v195 offset:40960
  s_waitcnt lgkmcnt(12)
  v_mfma_f32_16x16x32_bf16 v[96:99], v[64:67], v[12:15], v[96:99]
  v_mfma_f32_16x16x32_bf16 v[112:115], v[64:67], v[16:19], v[112:115]
  s_barrier
  ds_read_b64_tr_b16 v[60:61], v188 offset:49152
  ds_read_b64_tr_b16 v[62:63], v192 offset:49152
  s_add_u32 m0, s18, 81920
  s_add_u32 s16, s21, 212992
  buffer_load_dwordx4 v6, s[24:27], s16 offen lds
  buffer_load_dwordx4 v7, s[24:27], s16 offen offset:1024 lds
  s_waitcnt lgkmcnt(12)
  v_mfma_f32_16x16x32_bf16 v[100:103], v[68:71], v[12:15], v[100:103]
  v_mfma_f32_16x16x32_bf16 v[116:119], v[68:71], v[16:19], v[116:119]
  ds_read_b64_tr_b16 v[64:65], v189 offset:49152
  ds_read_b64_tr_b16 v[66:67], v193 offset:49152
  s_waitcnt lgkmcnt(12)
  v_mfma_f32_16x16x32_bf16 v[104:107], v[72:75], v[12:15], v[104:107]
  v_mfma_f32_16x16x32_bf16 v[120:123], v[72:75], v[16:19], v[120:123]
  ds_read_b64_tr_b16 v[68:69], v190 offset:49152
  ds_read_b64_tr_b16 v[70:71], v194 offset:49152
  s_add_u32 s17, s19, 36864
  buffer_load_dwordx4 v[12:15], v8, s[28:31], s17 offen offset:0
  buffer_load_dwordx4 v[16:19], v9, s[28:31], s17 offen offset:0
  s_waitcnt vmcnt(17) lgkmcnt(12)
  v_mfma_f32_16x16x32_bf16 v[92:95], v[76:79], v[20:23], v[92:95]
  s_waitcnt vmcnt(16)
  v_mfma_f32_16x16x32_bf16 v[108:111], v[76:79], v[24:27], v[108:111]
  ds_read_b64_tr_b16 v[72:73], v191 offset:49152
  ds_read_b64_tr_b16 v[74:75], v195 offset:49152
  s_waitcnt lgkmcnt(12)
  v_mfma_f32_16x16x32_bf16 v[96:99], v[80:83], v[20:23], v[96:99]
  v_mfma_f32_16x16x32_bf16 v[112:115], v[80:83], v[24:27], v[112:115]
  ds_read_b64_tr_b16 v[76:77], v188 offset:57344
  ds_read_b64_tr_b16 v[78:79], v192 offset:57344
  s_waitcnt lgkmcnt(12)
  v_mfma_f32_16x16x32_bf16 v[100:103], v[84:87], v[20:23], v[100:103]
  v_mfma_f32_16x16x32_bf16 v[116:119], v[84:87], v[24:27], v[116:119]
  ds_read_b64_tr_b16 v[80:81], v189 offset:57344
  ds_read_b64_tr_b16 v[82:83], v193 offset:57344
  s_waitcnt lgkmcnt(12)
  v_mfma_f32_16x16x32_bf16 v[104:107], v[88:91], v[20:23], v[104:107]
  v_mfma_f32_16x16x32_bf16 v[120:123], v[88:91], v[24:27], v[120:123]
  ds_read_b64_tr_b16 v[84:85], v190 offset:57344
  ds_read_b64_tr_b16 v[86:87], v194 offset:57344
  s_add_u32 s17, s19, 36864
  buffer_load_dwordx4 v[20:23], v8, s[28:31], s17 offen offset:2048
  buffer_load_dwordx4 v[24:27], v9, s[28:31], s17 offen offset:2048
  s_waitcnt vmcnt(15) lgkmcnt(12)
  v_mfma_f32_16x16x32_bf16 v[92:95], v[60:63], v[28:31], v[92:95]
  s_waitcnt vmcnt(14)
  v_mfma_f32_16x16x32_bf16 v[108:111], v[60:63], v[32:35], v[108:111]
  ds_read_b64_tr_b16 v[88:89], v191 offset:57344
  ds_read_b64_tr_b16 v[90:91], v195 offset:57344
  s_waitcnt lgkmcnt(12)
  v_mfma_f32_16x16x32_bf16 v[96:99], v[64:67], v[28:31], v[96:99]
  v_mfma_f32_16x16x32_bf16 v[112:115], v[64:67], v[32:35], v[112:115]
  s_barrier
  v_xor_b32 v188, 0x10000, v188
  v_xor_b32 v192, 0x10000, v192
  v_xor_b32 v189, 0x10000, v189
  v_xor_b32 v193, 0x10000, v193
  v_xor_b32 v190, 0x10000, v190
  v_xor_b32 v194, 0x10000, v194
  v_xor_b32 v191, 0x10000, v191
  v_xor_b32 v195, 0x10000, v195
  ds_read_b64_tr_b16 v[60:61], v188 offset:0
  ds_read_b64_tr_b16 v[62:63], v192 offset:0
  s_add_u32 m0, s18, 98304
  s_nop 0
  buffer_load_dwordx4 v6, s[24:27], s22 offen lds
  buffer_load_dwordx4 v7, s[24:27], s22 offen offset:1024 lds
  s_waitcnt lgkmcnt(12)
  v_mfma_f32_16x16x32_bf16 v[100:103], v[68:71], v[28:31], v[100:103]
  v_mfma_f32_16x16x32_bf16 v[116:119], v[68:71], v[32:35], v[116:119]
  ds_read_b64_tr_b16 v[64:65], v189 offset:0
  ds_read_b64_tr_b16 v[66:67], v193 offset:0
  s_waitcnt lgkmcnt(12)
  v_mfma_f32_16x16x32_bf16 v[104:107], v[72:75], v[28:31], v[104:107]
  v_mfma_f32_16x16x32_bf16 v[120:123], v[72:75], v[32:35], v[120:123]
  ds_read_b64_tr_b16 v[68:69], v190 offset:0
  ds_read_b64_tr_b16 v[70:71], v194 offset:0
  s_add_u32 s17, s19, 40960
  buffer_load_dwordx4 v[28:31], v8, s[28:31], s17 offen offset:0
  buffer_load_dwordx4 v[32:35], v9, s[28:31], s17 offen offset:0
  s_waitcnt vmcnt(17) lgkmcnt(12)
  v_mfma_f32_16x16x32_bf16 v[92:95], v[76:79], v[36:39], v[92:95]
  s_waitcnt vmcnt(16)
  v_mfma_f32_16x16x32_bf16 v[108:111], v[76:79], v[40:43], v[108:111]
  ds_read_b64_tr_b16 v[72:73], v191 offset:0
  ds_read_b64_tr_b16 v[74:75], v195 offset:0
  s_waitcnt lgkmcnt(12)
  v_mfma_f32_16x16x32_bf16 v[96:99], v[80:83], v[36:39], v[96:99]
  v_mfma_f32_16x16x32_bf16 v[112:115], v[80:83], v[40:43], v[112:115]
  ds_read_b64_tr_b16 v[76:77], v188 offset:8192
  ds_read_b64_tr_b16 v[78:79], v192 offset:8192
  s_waitcnt lgkmcnt(12)
  v_mfma_f32_16x16x32_bf16 v[100:103], v[84:87], v[36:39], v[100:103]
  v_mfma_f32_16x16x32_bf16 v[116:119], v[84:87], v[40:43], v[116:119]
  ds_read_b64_tr_b16 v[80:81], v189 offset:8192
  ds_read_b64_tr_b16 v[82:83], v193 offset:8192
  s_waitcnt lgkmcnt(12)
  v_mfma_f32_16x16x32_bf16 v[104:107], v[88:91], v[36:39], v[104:107]
  v_mfma_f32_16x16x32_bf16 v[120:123], v[88:91], v[40:43], v[120:123]
  ds_read_b64_tr_b16 v[84:85], v190 offset:8192
  ds_read_b64_tr_b16 v[86:87], v194 offset:8192
  s_add_u32 s17, s19, 40960
  buffer_load_dwordx4 v[36:39], v8, s[28:31], s17 offen offset:2048
  buffer_load_dwordx4 v[40:43], v9, s[28:31], s17 offen offset:2048
  s_waitcnt vmcnt(15) lgkmcnt(12)
  v_mfma_f32_16x16x32_bf16 v[92:95], v[60:63], v[44:47], v[92:95]
  s_waitcnt vmcnt(14)
  v_mfma_f32_16x16x32_bf16 v[108:111], v[60:63], v[48:51], v[108:111]
  ds_read_b64_tr_b16 v[88:89], v191 offset:8192
  ds_read_b64_tr_b16 v[90:91], v195 offset:8192
  s_waitcnt lgkmcnt(12)
  v_mfma_f32_16x16x32_bf16 v[96:99], v[64:67], v[44:47], v[96:99]
  v_mfma_f32_16x16x32_bf16 v[112:115], v[64:67], v[48:51], v[112:115]
  s_barrier
  ds_read_b64_tr_b16 v[60:61], v188 offset:16384
  ds_read_b64_tr_b16 v[62:63], v192 offset:16384
  s_add_u32 m0, s18, 114688
  s_add_u32 s16, s22, 16384
  buffer_load_dwordx4 v6, s[24:27], s16 offen lds
  buffer_load_dwordx4 v7, s[24:27], s16 offen offset:1024 lds
  s_waitcnt lgkmcnt(12)
  v_mfma_f32_16x16x32_bf16 v[100:103], v[68:71], v[44:47], v[100:103]
  v_mfma_f32_16x16x32_bf16 v[116:119], v[68:71], v[48:51], v[116:119]
  ds_read_b64_tr_b16 v[64:65], v189 offset:16384
  ds_read_b64_tr_b16 v[66:67], v193 offset:16384
  s_waitcnt lgkmcnt(12)
  v_mfma_f32_16x16x32_bf16 v[104:107], v[72:75], v[44:47], v[104:107]
  v_mfma_f32_16x16x32_bf16 v[120:123], v[72:75], v[48:51], v[120:123]
  ds_read_b64_tr_b16 v[68:69], v190 offset:16384
  ds_read_b64_tr_b16 v[70:71], v194 offset:16384
  s_add_u32 s17, s19, 45056
  buffer_load_dwordx4 v[44:47], v8, s[28:31], s17 offen offset:0
  buffer_load_dwordx4 v[48:51], v9, s[28:31], s17 offen offset:0
  s_waitcnt vmcnt(17) lgkmcnt(12)
  v_mfma_f32_16x16x32_bf16 v[92:95], v[76:79], v[52:55], v[92:95]
  s_waitcnt vmcnt(16)
  v_mfma_f32_16x16x32_bf16 v[108:111], v[76:79], v[56:59], v[108:111]
  ds_read_b64_tr_b16 v[72:73], v191 offset:16384
  ds_read_b64_tr_b16 v[74:75], v195 offset:16384
  s_waitcnt lgkmcnt(12)
  v_mfma_f32_16x16x32_bf16 v[96:99], v[80:83], v[52:55], v[96:99]
  v_mfma_f32_16x16x32_bf16 v[112:115], v[80:83], v[56:59], v[112:115]
  ds_read_b64_tr_b16 v[76:77], v188 offset:24576
  ds_read_b64_tr_b16 v[78:79], v192 offset:24576
  s_waitcnt lgkmcnt(12)
  v_mfma_f32_16x16x32_bf16 v[100:103], v[84:87], v[52:55], v[100:103]
  v_mfma_f32_16x16x32_bf16 v[116:119], v[84:87], v[56:59], v[116:119]
  ds_read_b64_tr_b16 v[80:81], v189 offset:24576
  ds_read_b64_tr_b16 v[82:83], v193 offset:24576
  s_waitcnt lgkmcnt(12)
  v_mfma_f32_16x16x32_bf16 v[104:107], v[88:91], v[52:55], v[104:107]
  v_mfma_f32_16x16x32_bf16 v[120:123], v[88:91], v[56:59], v[120:123]
  ds_read_b64_tr_b16 v[84:85], v190 offset:24576
  ds_read_b64_tr_b16 v[86:87], v194 offset:24576
  s_add_u32 s17, s19, 45056
  buffer_load_dwordx4 v[52:55], v8, s[28:31], s17 offen offset:2048
  buffer_load_dwordx4 v[56:59], v9, s[28:31], s17 offen offset:2048
  s_waitcnt vmcnt(15) lgkmcnt(12)
  v_mfma_f32_16x16x32_bf16 v[92:95], v[60:63], v[12:15], v[92:95]
  s_waitcnt vmcnt(14)
  v_mfma_f32_16x16x32_bf16 v[108:111], v[60:63], v[16:19], v[108:111]
  ds_read_b64_tr_b16 v[88:89], v191 offset:24576
  ds_read_b64_tr_b16 v[90:91], v195 offset:24576
  s_waitcnt lgkmcnt(12)
  v_mfma_f32_16x16x32_bf16 v[96:99], v[64:67], v[12:15], v[96:99]
  v_mfma_f32_16x16x32_bf16 v[112:115], v[64:67], v[16:19], v[112:115]
  s_barrier
  ds_read_b64_tr_b16 v[60:61], v188 offset:32768
  ds_read_b64_tr_b16 v[62:63], v192 offset:32768
  s_add_u32 m0, s18, 0
  s_add_u32 s16, s22, 32768
  buffer_load_dwordx4 v6, s[24:27], s16 offen lds
  buffer_load_dwordx4 v7, s[24:27], s16 offen offset:1024 lds
  s_waitcnt lgkmcnt(12)
  v_mfma_f32_16x16x32_bf16 v[100:103], v[68:71], v[12:15], v[100:103]
  v_mfma_f32_16x16x32_bf16 v[116:119], v[68:71], v[16:19], v[116:119]
  ds_read_b64_tr_b16 v[64:65], v189 offset:32768
  ds_read_b64_tr_b16 v[66:67], v193 offset:32768
  s_waitcnt lgkmcnt(12)
  v_mfma_f32_16x16x32_bf16 v[104:107], v[72:75], v[12:15], v[104:107]
  v_mfma_f32_16x16x32_bf16 v[120:123], v[72:75], v[16:19], v[120:123]
  ds_read_b64_tr_b16 v[68:69], v190 offset:32768
  ds_read_b64_tr_b16 v[70:71], v194 offset:32768
  s_add_u32 s17, s19, 49152
  buffer_load_dwordx4 v[12:15], v8, s[28:31], s17 offen offset:0
  buffer_load_dwordx4 v[16:19], v9, s[28:31], s17 offen offset:0
  s_waitcnt vmcnt(17) lgkmcnt(12)
  v_mfma_f32_16x16x32_bf16 v[92:95], v[76:79], v[20:23], v[92:95]
  s_waitcnt vmcnt(16)
  v_mfma_f32_16x16x32_bf16 v[108:111], v[76:79], v[24:27], v[108:111]
  ds_read_b64_tr_b16 v[72:73], v191 offset:32768
  ds_read_b64_tr_b16 v[74:75], v195 offset:32768
  s_waitcnt lgkmcnt(12)
  v_mfma_f32_16x16x32_bf16 v[96:99], v[80:83], v[20:23], v[96:99]
  v_mfma_f32_16x16x32_bf16 v[112:115], v[80:83], v[24:27], v[112:115]
  ds_read_b64_tr_b16 v[76:77], v188 offset:40960
  ds_read_b64_tr_b16 v[78:79], v192 offset:40960
  s_waitcnt lgkmcnt(12)
  v_mfma_f32_16x16x32_bf16 v[100:103], v[84:87], v[20:23], v[100:103]
  v_mfma_f32_16x16x32_bf16 v[116:119], v[84:87], v[24:27], v[116:119]
  ds_read_b64_tr_b16 v[80:81], v189 offset:40960
  ds_read_b64_tr_b16 v[82:83], v193 offset:40960
  s_waitcnt lgkmcnt(12)
  v_mfma_f32_16x16x32_bf16 v[104:107], v[88:91], v[20:23], v[104:107]
  v_mfma_f32_16x16x32_bf16 v[120:123], v[88:91], v[24:27], v[120:123]
  ds_read_b64_tr_b16 v[84:85], v190 offset:40960
  ds_read_b64_tr_b16 v[86:87], v194 offset:40960
  s_add_u32 s17, s19, 49152
  buffer_load_dwordx4 v[20:23], v8, s[28:31], s17 offen offset:2048
  buffer_load_dwordx4 v[24:27], v9, s[28:31], s17 offen offset:2048
  s_waitcnt vmcnt(15) lgkmcnt(12)
  v_mfma_f32_16x16x32_bf16 v[92:95], v[60:63], v[28:31], v[92:95]
  s_waitcnt vmcnt(14)
  v_mfma_f32_16x16x32_bf16 v[108:111], v[60:63], v[32:35], v[108:111]
  ds_read_b64_tr_b16 v[88:89], v191 offset:40960
  ds_read_b64_tr_b16 v[90:91], v195 offset:40960
  s_waitcnt lgkmcnt(12)
  v_mfma_f32_16x16x32_bf16 v[96:99], v[64:67], v[28:31], v[96:99]
  v_mfma_f32_16x16x32_bf16 v[112:115], v[64:67], v[32:35], v[112:115]
  s_barrier
  ds_read_b64_tr_b16 v[60:61], v188 offset:49152
  ds_read_b64_tr_b16 v[62:63], v192 offset:49152
  s_add_u32 m0, s18, 16384
  s_add_u32 s16, s22, 49152
  buffer_load_dwordx4 v6, s[24:27], s16 offen lds
  buffer_load_dwordx4 v7, s[24:27], s16 offen offset:1024 lds
  s_waitcnt lgkmcnt(12)
  v_mfma_f32_16x16x32_bf16 v[100:103], v[68:71], v[28:31], v[100:103]
  v_mfma_f32_16x16x32_bf16 v[116:119], v[68:71], v[32:35], v[116:119]
  ds_read_b64_tr_b16 v[64:65], v189 offset:49152
  ds_read_b64_tr_b16 v[66:67], v193 offset:49152
  s_waitcnt lgkmcnt(12)
  v_mfma_f32_16x16x32_bf16 v[104:107], v[72:75], v[28:31], v[104:107]
  v_mfma_f32_16x16x32_bf16 v[120:123], v[72:75], v[32:35], v[120:123]
  ds_read_b64_tr_b16 v[68:69], v190 offset:49152
  ds_read_b64_tr_b16 v[70:71], v194 offset:49152
  s_add_u32 s17, s19, 53248
  buffer_load_dwordx4 v[28:31], v8, s[28:31], s17 offen offset:0
  buffer_load_dwordx4 v[32:35], v9, s[28:31], s17 offen offset:0
  s_waitcnt vmcnt(17) lgkmcnt(12)
  v_mfma_f32_16x16x32_bf16 v[92:95], v[76:79], v[36:39], v[92:95]
  s_waitcnt vmcnt(16)
  v_mfma_f32_16x16x32_bf16 v[108:111], v[76:79], v[40:43], v[108:111]
  ds_read_b64_tr_b16 v[72:73], v191 offset:49152
  ds_read_b64_tr_b16 v[74:75], v195 offset:49152
  s_waitcnt lgkmcnt(12)
  v_mfma_f32_16x16x32_bf16 v[96:99], v[80:83], v[36:39], v[96:99]
  v_mfma_f32_16x16x32_bf16 v[112:115], v[80:83], v[40:43], v[112:115]
  ds_read_b64_tr_b16 v[76:77], v188 offset:57344
  ds_read_b64_tr_b16 v[78:79], v192 offset:57344
  s_waitcnt lgkmcnt(12)
  v_mfma_f32_16x16x32_bf16 v[100:103], v[84:87], v[36:39], v[100:103]
  v_mfma_f32_16x16x32_bf16 v[116:119], v[84:87], v[40:43], v[116:119]
  ds_read_b64_tr_b16 v[80:81], v189 offset:57344
  ds_read_b64_tr_b16 v[82:83], v193 offset:57344
  s_waitcnt lgkmcnt(12)
  v_mfma_f32_16x16x32_bf16 v[104:107], v[88:91], v[36:39], v[104:107]
  v_mfma_f32_16x16x32_bf16 v[120:123], v[88:91], v[40:43], v[120:123]
  ds_read_b64_tr_b16 v[84:85], v190 offset:57344
  ds_read_b64_tr_b16 v[86:87], v194 offset:57344
  s_add_u32 s17, s19, 53248
  buffer_load_dwordx4 v[36:39], v8, s[28:31], s17 offen offset:2048
  buffer_load_dwordx4 v[40:43], v9, s[28:31], s17 offen offset:2048
  s_waitcnt vmcnt(15) lgkmcnt(12)
  v_mfma_f32_16x16x32_bf16 v[92:95], v[60:63], v[44:47], v[92:95]
  s_waitcnt vmcnt(14)
  v_mfma_f32_16x16x32_bf16 v[108:111], v[60:63], v[48:51], v[108:111]
  ds_read_b64_tr_b16 v[88:89], v191 offset:57344
  ds_read_b64_tr_b16 v[90:91], v195 offset:57344
  s_waitcnt lgkmcnt(12)
  v_mfma_f32_16x16x32_bf16 v[96:99], v[64:67], v[44:47], v[96:99]
  v_mfma_f32_16x16x32_bf16 v[112:115], v[64:67], v[48:51], v[112:115]
  s_barrier
  v_xor_b32 v188, 0x10000, v188
  v_xor_b32 v192, 0x10000, v192
  v_xor_b32 v189, 0x10000, v189
  v_xor_b32 v193, 0x10000, v193
  v_xor_b32 v190, 0x10000, v190
  v_xor_b32 v194, 0x10000, v194
  v_xor_b32 v191, 0x10000, v191
  v_xor_b32 v195, 0x10000, v195
  ds_read_b64_tr_b16 v[60:61], v188 offset:0
  ds_read_b64_tr_b16 v[62:63], v192 offset:0
  s_add_u32 m0, s18, 32768
  s_add_u32 s16, s22, 65536
  buffer_load_dwordx4 v6, s[24:27], s16 offen lds
  buffer_load_dwordx4 v7, s[24:27], s16 offen offset:1024 lds
  s_waitcnt lgkmcnt(12)
  v_mfma_f32_16x16x32_bf16 v[100:103], v[68:71], v[44:47], v[100:103]
  v_mfma_f32_16x16x32_bf16 v[116:119], v[68:71], v[48:51], v[116:119]
  ds_read_b64_tr_b16 v[64:65], v189 offset:0
  ds_read_b64_tr_b16 v[66:67], v193 offset:0
  s_waitcnt lgkmcnt(12)
  v_mfma_f32_16x16x32_bf16 v[104:107], v[72:75], v[44:47], v[104:107]
  v_mfma_f32_16x16x32_bf16 v[120:123], v[72:75], v[48:51], v[120:123]
  ds_read_b64_tr_b16 v[68:69], v190 offset:0
  ds_read_b64_tr_b16 v[70:71], v194 offset:0
  buffer_load_dwordx4 v[44:47], v10, s[28:31], s20 offen offset:0
  buffer_load_dwordx4 v[48:51], v11, s[28:31], s20 offen offset:0
  s_waitcnt vmcnt(17) lgkmcnt(12)
  v_mfma_f32_16x16x32_bf16 v[92:95], v[76:79], v[52:55], v[92:95]
  s_waitcnt vmcnt(16)
  v_mfma_f32_16x16x32_bf16 v[108:111], v[76:79], v[56:59], v[108:111]
  ds_read_b64_tr_b16 v[72:73], v191 offset:0
  ds_read_b64_tr_b16 v[74:75], v195 offset:0
  s_waitcnt lgkmcnt(12)
  v_mfma_f32_16x16x32_bf16 v[96:99], v[80:83], v[52:55], v[96:99]
  v_mfma_f32_16x16x32_bf16 v[112:115], v[80:83], v[56:59], v[112:115]
  ds_read_b64_tr_b16 v[76:77], v188 offset:8192
  ds_read_b64_tr_b16 v[78:79], v192 offset:8192
  s_waitcnt lgkmcnt(12)
  v_mfma_f32_16x16x32_bf16 v[100:103], v[84:87], v[52:55], v[100:103]
  v_mfma_f32_16x16x32_bf16 v[116:119], v[84:87], v[56:59], v[116:119]
  ds_read_b64_tr_b16 v[80:81], v189 offset:8192
  ds_read_b64_tr_b16 v[82:83], v193 offset:8192
  s_waitcnt lgkmcnt(12)
  v_mfma_f32_16x16x32_bf16 v[104:107], v[88:91], v[52:55], v[104:107]
  v_mfma_f32_16x16x32_bf16 v[120:123], v[88:91], v[56:59], v[120:123]
  ds_read_b64_tr_b16 v[84:85], v190 offset:8192
  ds_read_b64_tr_b16 v[86:87], v194 offset:8192
  buffer_load_dwordx4 v[52:55], v10, s[28:31], s20 offen offset:2048
  buffer_load_dwordx4 v[56:59], v11, s[28:31], s20 offen offset:2048
  s_waitcnt vmcnt(15) lgkmcnt(12)
  v_mfma_f32_16x16x32_bf16 v[92:95], v[60:63], v[12:15], v[92:95]
  s_waitcnt vmcnt(14)
  v_mfma_f32_16x16x32_bf16 v[108:111], v[60:63], v[16:19], v[108:111]
  ds_read_b64_tr_b16 v[88:89], v191 offset:8192
  ds_read_b64_tr_b16 v[90:91], v195 offset:8192
  s_waitcnt lgkmcnt(12)
  v_mfma_f32_16x16x32_bf16 v[96:99], v[64:67], v[12:15], v[96:99]
  v_mfma_f32_16x16x32_bf16 v[112:115], v[64:67], v[16:19], v[112:115]
  s_barrier
  ds_read_b64_tr_b16 v[60:61], v188 offset:16384
  ds_read_b64_tr_b16 v[62:63], v192 offset:16384
  s_add_u32 m0, s18, 49152
  s_add_u32 s16, s22, 81920
  buffer_load_dwordx4 v6, s[24:27], s16 offen lds
  buffer_load_dwordx4 v7, s[24:27], s16 offen offset:1024 lds
  s_waitcnt lgkmcnt(12)
  v_mfma_f32_16x16x32_bf16 v[100:103], v[68:71], v[12:15], v[100:103]
  v_mfma_f32_16x16x32_bf16 v[116:119], v[68:71], v[16:19], v[116:119]
  ds_read_b64_tr_b16 v[64:65], v189 offset:16384
  ds_read_b64_tr_b16 v[66:67], v193 offset:16384
  s_waitcnt lgkmcnt(12)
  v_mfma_f32_16x16x32_bf16 v[104:107], v[72:75], v[12:15], v[104:107]
  v_mfma_f32_16x16x32_bf16 v[120:123], v[72:75], v[16:19], v[120:123]
  ds_read_b64_tr_b16 v[68:69], v190 offset:16384
  ds_read_b64_tr_b16 v[70:71], v194 offset:16384
  s_add_u32 s17, s20, 4096
  buffer_load_dwordx4 v[12:15], v10, s[28:31], s17 offen offset:0
  buffer_load_dwordx4 v[16:19], v11, s[28:31], s17 offen offset:0
  s_waitcnt vmcnt(17) lgkmcnt(12)
  v_mfma_f32_16x16x32_bf16 v[92:95], v[76:79], v[20:23], v[92:95]
  s_waitcnt vmcnt(16)
  v_mfma_f32_16x16x32_bf16 v[108:111], v[76:79], v[24:27], v[108:111]
  ds_read_b64_tr_b16 v[72:73], v191 offset:16384
  ds_read_b64_tr_b16 v[74:75], v195 offset:16384
  s_waitcnt lgkmcnt(12)
  v_mfma_f32_16x16x32_bf16 v[96:99], v[80:83], v[20:23], v[96:99]
  v_mfma_f32_16x16x32_bf16 v[112:115], v[80:83], v[24:27], v[112:115]
  ds_read_b64_tr_b16 v[76:77], v188 offset:24576
  ds_read_b64_tr_b16 v[78:79], v192 offset:24576
  s_waitcnt lgkmcnt(12)
  v_mfma_f32_16x16x32_bf16 v[100:103], v[84:87], v[20:23], v[100:103]
  v_mfma_f32_16x16x32_bf16 v[116:119], v[84:87], v[24:27], v[116:119]
  ds_read_b64_tr_b16 v[80:81], v189 offset:24576
  ds_read_b64_tr_b16 v[82:83], v193 offset:24576
  s_waitcnt lgkmcnt(12)
  v_mfma_f32_16x16x32_bf16 v[104:107], v[88:91], v[20:23], v[104:107]
  v_mfma_f32_16x16x32_bf16 v[120:123], v[88:91], v[24:27], v[120:123]
  ds_read_b64_tr_b16 v[84:85], v190 offset:24576
  ds_read_b64_tr_b16 v[86:87], v194 offset:24576
  s_add_u32 s17, s20, 4096
  buffer_load_dwordx4 v[20:23], v10, s[28:31], s17 offen offset:2048
  buffer_load_dwordx4 v[24:27], v11, s[28:31], s17 offen offset:2048
  s_waitcnt vmcnt(15) lgkmcnt(12)
  v_mfma_f32_16x16x32_bf16 v[92:95], v[60:63], v[28:31], v[92:95]
  s_waitcnt vmcnt(14)
  v_mfma_f32_16x16x32_bf16 v[108:111], v[60:63], v[32:35], v[108:111]
  ds_read_b64_tr_b16 v[88:89], v191 offset:24576
  ds_read_b64_tr_b16 v[90:91], v195 offset:24576
  s_waitcnt lgkmcnt(12)
  v_mfma_f32_16x16x32_bf16 v[96:99], v[64:67], v[28:31], v[96:99]
  v_mfma_f32_16x16x32_bf16 v[112:115], v[64:67], v[32:35], v[112:115]
  s_barrier
  v_add_u32 v188, v196, v188
  v_add_u32 v192, v196, v192
  v_subrev_u32 v192, s32, v192
  v_add_u32 v189, v196, v189
  v_add_u32 v193, v196, v193
  v_subrev_u32 v193, s32, v193
  v_add_u32 v190, v196, v190
  v_add_u32 v194, v196, v194
  v_subrev_u32 v194, s32, v194
  v_add_u32 v191, v196, v191
  v_add_u32 v195, v196, v195
  v_subrev_u32 v195, s32, v195
  ds_read_b64_tr_b16 v[60:61], v188 offset:32768
  ds_read_b64_tr_b16 v[62:63], v192 offset:32768
  s_add_u32 m0, s18, 65536
  s_add_u32 s16, s22, 98304
  buffer_load_dwordx4 v6, s[24:27], s16 offen lds
  buffer_load_dwordx4 v7, s[24:27], s16 offen offset:1024 lds
  s_waitcnt lgkmcnt(12)
  v_mfma_f32_16x16x32_bf16 v[100:103], v[68:71], v[28:31], v[100:103]
  v_mfma_f32_16x16x32_bf16 v[116:119], v[68:71], v[32:35], v[116:119]
  ds_read_b64_tr_b16 v[64:65], v189 offset:32768
  ds_read_b64_tr_b16 v[66:67], v193 offset:32768
  s_waitcnt lgkmcnt(12)
  v_mfma_f32_16x16x32_bf16 v[104:107], v[72:75], v[28:31], v[104:107]
  v_mfma_f32_16x16x32_bf16 v[120:123], v[72:75], v[32:35], v[120:123]
  ds_read_b64_tr_b16 v[68:69], v190 offset:32768
  ds_read_b64_tr_b16 v[70:71], v194 offset:32768
  s_add_u32 s17, s20, 8192
  buffer_load_dwordx4 v[28:31], v10, s[28:31], s17 offen offset:0
  buffer_load_dwordx4 v[32:35], v11, s[28:31], s17 offen offset:0
  s_waitcnt vmcnt(17) lgkmcnt(12)
  v_mfma_f32_16x16x32_bf16 v[92:95], v[76:79], v[36:39], v[92:95]
  s_waitcnt vmcnt(16)
  v_mfma_f32_16x16x32_bf16 v[108:111], v[76:79], v[40:43], v[108:111]
  ds_read_b64_tr_b16 v[72:73], v191 offset:32768
  ds_read_b64_tr_b16 v[74:75], v195 offset:32768
  s_waitcnt lgkmcnt(12)
  v_mfma_f32_16x16x32_bf16 v[96:99], v[80:83], v[36:39], v[96:99]
  v_mfma_f32_16x16x32_bf16 v[112:115], v[80:83], v[40:43], v[112:115]
  ds_read_b64_tr_b16 v[76:77], v188 offset:40960
  ds_read_b64_tr_b16 v[78:79], v192 offset:40960
  s_waitcnt lgkmcnt(12)
  v_mfma_f32_16x16x32_bf16 v[100:103], v[84:87], v[36:39], v[100:103]
  v_mfma_f32_16x16x32_bf16 v[116:119], v[84:87], v[40:43], v[116:119]
  ds_read_b64_tr_b16 v[80:81], v189 offset:40960
  ds_read_b64_tr_b16 v[82:83], v193 offset:40960
  s_waitcnt lgkmcnt(12)
  v_mfma_f32_16x16x32_bf16 v[104:107], v[88:91], v[36:39], v[104:107]
  v_mfma_f32_16x16x32_bf16 v[120:123], v[88:91], v[40:43], v[120:123]
  ds_read_b64_tr_b16 v[84:85], v190 offset:40960
  ds_read_b64_tr_b16 v[86:87], v194 offset:40960
  s_add_u32 s17, s20, 8192
  buffer_load_dwordx4 v[36:39], v10, s[28:31], s17 offen offset:2048
  buffer_load_dwordx4 v[40:43], v11, s[28:31], s17 offen offset:2048
  s_waitcnt vmcnt(15) lgkmcnt(12)
  v_mfma_f32_16x16x32_bf16 v[124:127], v[60:63], v[44:47], 0
  s_waitcnt vmcnt(14)
  v_mfma_f32_16x16x32_bf16 v[140:143], v[60:63], v[48:51], 0
  ds_read_b64_tr_b16 v[88:89], v191 offset:40960
  ds_read_b64_tr_b16 v[90:91], v195 offset:40960
  s_waitcnt lgkmcnt(12)
  v_mfma_f32_16x16x32_bf16 v[128:131], v[64:67], v[44:47], 0
  v_mfma_f32_16x16x32_bf16 v[144:147], v[64:67], v[48:51], 0
  s_barrier
  ds_read_b64_tr_b16 v[60:61], v188 offset:49152
  ds_read_b64_tr_b16 v[62:63], v192 offset:49152
  s_add_u32 m0, s18, 81920
  s_add_u32 s16, s22, 114688
  buffer_load_dwordx4 v6, s[24:27], s16 offen lds
  buffer_load_dwordx4 v7, s[24:27], s16 offen offset:1024 lds
  s_waitcnt lgkmcnt(12)
  v_mfma_f32_16x16x32_bf16 v[132:135], v[68:71], v[44:47], 0
  v_mfma_f32_16x16x32_bf16 v[148:151], v[68:71], v[48:51], 0
  ds_read_b64_tr_b16 v[64:65], v189 offset:49152
  ds_read_b64_tr_b16 v[66:67], v193 offset:49152
  s_waitcnt lgkmcnt(12)
  v_mfma_f32_16x16x32_bf16 v[136:139], v[72:75], v[44:47], 0
  v_mfma_f32_16x16x32_bf16 v[152:155], v[72:75], v[48:51], 0
  ds_read_b64_tr_b16 v[68:69], v190 offset:49152
  ds_read_b64_tr_b16 v[70:71], v194 offset:49152
  s_add_u32 s17, s20, 12288
  buffer_load_dwordx4 v[44:47], v10, s[28:31], s17 offen offset:0
  buffer_load_dwordx4 v[48:51], v11, s[28:31], s17 offen offset:0
  s_waitcnt vmcnt(17) lgkmcnt(12)
  v_mfma_f32_16x16x32_bf16 v[124:127], v[76:79], v[52:55], v[124:127]
  s_waitcnt vmcnt(16)
  v_mfma_f32_16x16x32_bf16 v[140:143], v[76:79], v[56:59], v[140:143]
  ds_read_b64_tr_b16 v[72:73], v191 offset:49152
  ds_read_b64_tr_b16 v[74:75], v195 offset:49152
  ds_write_b128 v218, v[100:103] offset:0
  ds_write_b128 v218, v[104:107] offset:1024
  ds_write_b128 v218, v[116:119] offset:2048
  ds_write_b128 v218, v[120:123] offset:3072
  s_waitcnt lgkmcnt(15)
  v_mfma_f32_16x16x32_bf16 v[128:131], v[80:83], v[52:55], v[128:131]
  v_mfma_f32_16x16x32_bf16 v[144:147], v[80:83], v[56:59], v[144:147]
  ds_read_b64_tr_b16 v[76:77], v188 offset:57344
  ds_read_b64_tr_b16 v[78:79], v192 offset:57344
  s_waitcnt lgkmcnt(15)
  v_mfma_f32_16x16x32_bf16 v[132:135], v[84:87], v[52:55], v[132:135]
  v_mfma_f32_16x16x32_bf16 v[148:151], v[84:87], v[56:59], v[148:151]
  ds_read_b64_tr_b16 v[80:81], v189 offset:57344
  ds_read_b64_tr_b16 v[82:83], v193 offset:57344
  s_waitcnt lgkmcnt(15)
  v_mfma_f32_16x16x32_bf16 v[136:139], v[88:91], v[52:55], v[136:139]
  v_mfma_f32_16x16x32_bf16 v[152:155], v[88:91], v[56:59], v[152:155]
  ds_read_b64_tr_b16 v[84:85], v190 offset:57344
  ds_read_b64_tr_b16 v[86:87], v194 offset:57344
  s_add_u32 s17, s20, 12288
  buffer_load_dwordx4 v[52:55], v10, s[28:31], s17 offen offset:2048
  buffer_load_dwordx4 v[56:59], v11, s[28:31], s17 offen offset:2048
  s_waitcnt vmcnt(15) lgkmcnt(15)
  v_mfma_f32_16x16x32_bf16 v[124:127], v[60:63], v[12:15], v[124:127]
  s_waitcnt vmcnt(14)
  v_mfma_f32_16x16x32_bf16 v[140:143], v[60:63], v[16:19], v[140:143]
  ds_read_b64_tr_b16 v[88:89], v191 offset:57344
  ds_read_b64_tr_b16 v[90:91], v195 offset:57344
  s_waitcnt lgkmcnt(15)
  v_mfma_f32_16x16x32_bf16 v[128:131], v[64:67], v[12:15], v[128:131]
  v_mfma_f32_16x16x32_bf16 v[144:147], v[64:67], v[16:19], v[144:147]
  s_barrier
  v_xor_b32 v188, 0x10000, v188
  v_xor_b32 v192, 0x10000, v192
  v_xor_b32 v189, 0x10000, v189
  v_xor_b32 v193, 0x10000, v193
  v_xor_b32 v190, 0x10000, v190
  v_xor_b32 v194, 0x10000, v194
  v_xor_b32 v191, 0x10000, v191
  v_xor_b32 v195, 0x10000, v195
  ds_read_b64_tr_b16 v[60:61], v188 offset:0
  ds_read_b64_tr_b16 v[62:63], v192 offset:0
  s_add_u32 m0, s18, 98304
  s_add_u32 s16, s22, 131072
  buffer_load_dwordx4 v6, s[24:27], s16 offen lds
  buffer_load_dwordx4 v7, s[24:27], s16 offen offset:1024 lds
  s_waitcnt lgkmcnt(15)
  v_mfma_f32_16x16x32_bf16 v[132:135], v[68:71], v[12:15], v[132:135]
  v_mfma_f32_16x16x32_bf16 v[148:151], v[68:71], v[16:19], v[148:151]
  ds_read_b64_tr_b16 v[64:65], v189 offset:0
  ds_read_b64_tr_b16 v[66:67], v193 offset:0
  s_waitcnt lgkmcnt(15)
  v_mfma_f32_16x16x32_bf16 v[136:139], v[72:75], v[12:15], v[136:139]
  v_mfma_f32_16x16x32_bf16 v[152:155], v[72:75], v[16:19], v[152:155]
  ds_read_b64_tr_b16 v[68:69], v190 offset:0
  ds_read_b64_tr_b16 v[70:71], v194 offset:0
  s_add_u32 s17, s20, 16384
  buffer_load_dwordx4 v[12:15], v10, s[28:31], s17 offen offset:0
  buffer_load_dwordx4 v[16:19], v11, s[28:31], s17 offen offset:0
  s_waitcnt vmcnt(17) lgkmcnt(12)
  v_mfma_f32_16x16x32_bf16 v[124:127], v[76:79], v[20:23], v[124:127]
  s_waitcnt vmcnt(16)
  v_mfma_f32_16x16x32_bf16 v[140:143], v[76:79], v[24:27], v[140:143]
  ds_read_b64_tr_b16 v[72:73], v191 offset:0
  ds_read_b64_tr_b16 v[74:75], v195 offset:0
  s_waitcnt lgkmcnt(12)
  v_mfma_f32_16x16x32_bf16 v[128:131], v[80:83], v[20:23], v[128:131]
  v_mfma_f32_16x16x32_bf16 v[144:147], v[80:83], v[24:27], v[144:147]
  ds_read_b64_tr_b16 v[76:77], v188 offset:8192
  ds_read_b64_tr_b16 v[78:79], v192 offset:8192
  s_waitcnt lgkmcnt(12)
  v_mfma_f32_16x16x32_bf16 v[132:135], v[84:87], v[20:23], v[132:135]
  v_mfma_f32_16x16x32_bf16 v[148:151], v[84:87], v[24:27], v[148:151]
  ds_read_b64_tr_b16 v[80:81], v189 offset:8192
  ds_read_b64_tr_b16 v[82:83], v193 offset:8192
  s_waitcnt lgkmcnt(12)
  v_mfma_f32_16x16x32_bf16 v[136:139], v[88:91], v[20:23], v[136:139]
  v_mfma_f32_16x16x32_bf16 v[152:155], v[88:91], v[24:27], v[152:155]
  ds_read_b64_tr_b16 v[84:85], v190 offset:8192
  ds_read_b64_tr_b16 v[86:87], v194 offset:8192
  s_add_u32 s17, s20, 16384
  buffer_load_dwordx4 v[20:23], v10, s[28:31], s17 offen offset:2048
  buffer_load_dwordx4 v[24:27], v11, s[28:31], s17 offen offset:2048
  s_waitcnt vmcnt(15) lgkmcnt(12)
  v_mfma_f32_16x16x32_bf16 v[124:127], v[60:63], v[28:31], v[124:127]
  s_waitcnt vmcnt(14)
  v_mfma_f32_16x16x32_bf16 v[140:143], v[60:63], v[32:35], v[140:143]
  ds_read_b64_tr_b16 v[88:89], v191 offset:8192
  ds_read_b64_tr_b16 v[90:91], v195 offset:8192
  s_waitcnt lgkmcnt(12)
  v_mfma_f32_16x16x32_bf16 v[128:131], v[64:67], v[28:31], v[128:131]
  v_mfma_f32_16x16x32_bf16 v[144:147], v[64:67], v[32:35], v[144:147]
  s_barrier
  ds_read_b64_tr_b16 v[60:61], v188 offset:16384
  ds_read_b64_tr_b16 v[62:63], v192 offset:16384
  s_waitcnt lgkmcnt(12)
  v_mfma_f32_16x16x32_bf16 v[132:135], v[68:71], v[28:31], v[132:135]
  v_mfma_f32_16x16x32_bf16 v[148:151], v[68:71], v[32:35], v[148:151]
  ds_read_b64_tr_b16 v[64:65], v189 offset:16384
  ds_read_b64_tr_b16 v[66:67], v193 offset:16384
  s_waitcnt lgkmcnt(12)
  v_mfma_f32_16x16x32_bf16 v[136:139], v[72:75], v[28:31], v[136:139]
  v_mfma_f32_16x16x32_bf16 v[152:155], v[72:75], v[32:35], v[152:155]
  ds_read_b64_tr_b16 v[68:69], v190 offset:16384
  ds_read_b64_tr_b16 v[70:71], v194 offset:16384
  s_add_u32 s17, s20, 20480
  buffer_load_dwordx4 v[32:35], v11, s[28:31], s17 offen offset:0
  s_waitcnt vmcnt(14) lgkmcnt(12)
  v_mfma_f32_16x16x32_bf16 v[124:127], v[76:79], v[36:39], v[124:127]
  s_waitcnt vmcnt(13)
  v_mfma_f32_16x16x32_bf16 v[140:143], v[76:79], v[40:43], v[140:143]
  ds_read_b64_tr_b16 v[72:73], v191 offset:16384
  ds_read_b64_tr_b16 v[74:75], v195 offset:16384
  ds_read_b128 v[156:159], v219 offset:0
  ds_read_b128 v[160:163], v219 offset:1024
  ds_read_b128 v[164:167], v219 offset:2048
  ds_read_b128 v[168:171], v219 offset:3072
  s_waitcnt lgkmcnt(15)
  v_mfma_f32_16x16x32_bf16 v[128:131], v[80:83], v[36:39], v[128:131]
  v_mfma_f32_16x16x32_bf16 v[144:147], v[80:83], v[40:43], v[144:147]
  ds_read_b64_tr_b16 v[76:77], v188 offset:24576
  ds_read_b64_tr_b16 v[78:79], v192 offset:24576
  s_waitcnt lgkmcnt(15)
  v_mfma_f32_16x16x32_bf16 v[132:135], v[84:87], v[36:39], v[132:135]
  v_mfma_f32_16x16x32_bf16 v[148:151], v[84:87], v[40:43], v[148:151]
  ds_read_b64_tr_b16 v[80:81], v189 offset:24576
  ds_read_b64_tr_b16 v[82:83], v193 offset:24576
  s_waitcnt lgkmcnt(15)
  v_mfma_f32_16x16x32_bf16 v[136:139], v[88:91], v[36:39], v[136:139]
  v_mfma_f32_16x16x32_bf16 v[152:155], v[88:91], v[40:43], v[152:155]
  ds_read_b64_tr_b16 v[84:85], v190 offset:24576
  ds_read_b64_tr_b16 v[86:87], v194 offset:24576
  s_add_u32 s17, s20, 20480
  buffer_load_dwordx4 v[40:43], v11, s[28:31], s17 offen offset:2048
  s_waitcnt vmcnt(11) lgkmcnt(15)
  v_mfma_f32_16x16x32_bf16 v[124:127], v[60:63], v[44:47], v[124:127]
  s_waitcnt vmcnt(10)
  v_mfma_f32_16x16x32_bf16 v[140:143], v[60:63], v[48:51], v[140:143]
  ds_read_b64_tr_b16 v[88:89], v191 offset:24576
  ds_read_b64_tr_b16 v[90:91], v195 offset:24576
  s_waitcnt lgkmcnt(11)
  v_add_f32 v92, v92, v156
  v_add_f32 v93, v93, v157
  v_add_f32 v94, v94, v158
  v_add_f32 v95, v95, v159
  s_waitcnt lgkmcnt(10)
  v_add_f32 v96, v96, v160
  v_add_f32 v97, v97, v161
  v_add_f32 v98, v98, v162
  v_add_f32 v99, v99, v163
  s_waitcnt lgkmcnt(9)
  v_add_f32 v108, v108, v164
  v_add_f32 v109, v109, v165
  v_add_f32 v110, v110, v166
  v_add_f32 v111, v111, v167
  s_waitcnt lgkmcnt(8)
  v_add_f32 v112, v112, v168
  v_add_f32 v113, v113, v169
  v_add_f32 v114, v114, v170
  v_add_f32 v115, v115, v171
  buffer_store_dwordx4 v[108:111], v216, s[52:55], s56 offen offset:2048 sc1
  buffer_store_dwordx4 v[112:115], v216, s[52:55], s56 offen offset:3072 sc1
  v_mfma_f32_16x16x32_bf16 v[128:131], v[64:67], v[44:47], v[128:131]
  v_mfma_f32_16x16x32_bf16 v[144:147], v[64:67], v[48:51], v[144:147]
  s_barrier
  ds_read_b64_tr_b16 v[60:61], v188 offset:32768
  ds_read_b64_tr_b16 v[62:63], v192 offset:32768
  v_mfma_f32_16x16x32_bf16 v[132:135], v[68:71], v[44:47], v[132:135]
  v_mfma_f32_16x16x32_bf16 v[148:151], v[68:71], v[48:51], v[148:151]
  ds_read_b64_tr_b16 v[64:65], v189 offset:32768
  ds_read_b64_tr_b16 v[66:67], v193 offset:32768
  v_mfma_f32_16x16x32_bf16 v[136:139], v[72:75], v[44:47], v[136:139]
  v_mfma_f32_16x16x32_bf16 v[152:155], v[72:75], v[48:51], v[152:155]
  ds_read_b64_tr_b16 v[68:69], v190 offset:32768
  ds_read_b64_tr_b16 v[70:71], v194 offset:32768
  s_add_u32 s17, s20, 24576
  buffer_load_dwordx4 v[48:51], v11, s[28:31], s17 offen offset:0
  s_waitcnt vmcnt(12) lgkmcnt(12)
  v_mfma_f32_16x16x32_bf16 v[124:127], v[76:79], v[52:55], v[124:127]
  s_waitcnt vmcnt(11)
  v_mfma_f32_16x16x32_bf16 v[140:143], v[76:79], v[56:59], v[140:143]
  ds_read_b64_tr_b16 v[72:73], v191 offset:32768
  ds_read_b64_tr_b16 v[74:75], v195 offset:32768
  s_waitcnt lgkmcnt(12)
  v_mfma_f32_16x16x32_bf16 v[128:131], v[80:83], v[52:55], v[128:131]
  v_mfma_f32_16x16x32_bf16 v[144:147], v[80:83], v[56:59], v[144:147]
  ds_read_b64_tr_b16 v[76:77], v188 offset:40960
  ds_read_b64_tr_b16 v[78:79], v192 offset:40960
  s_waitcnt lgkmcnt(12)
  v_mfma_f32_16x16x32_bf16 v[132:135], v[84:87], v[52:55], v[132:135]
  v_mfma_f32_16x16x32_bf16 v[148:151], v[84:87], v[56:59], v[148:151]
  ds_read_b64_tr_b16 v[80:81], v189 offset:40960
  ds_read_b64_tr_b16 v[82:83], v193 offset:40960
  s_waitcnt lgkmcnt(12)
  v_mfma_f32_16x16x32_bf16 v[136:139], v[88:91], v[52:55], v[136:139]
  v_mfma_f32_16x16x32_bf16 v[152:155], v[88:91], v[56:59], v[152:155]
  ds_read_b64_tr_b16 v[84:85], v190 offset:40960
  ds_read_b64_tr_b16 v[86:87], v194 offset:40960
  s_add_u32 s17, s20, 24576
  buffer_load_dwordx4 v[56:59], v11, s[28:31], s17 offen offset:2048
  s_waitcnt vmcnt(9) lgkmcnt(12)
  v_mfma_f32_16x16x32_bf16 v[124:127], v[60:63], v[12:15], v[124:127]
  s_waitcnt vmcnt(8)
  v_mfma_f32_16x16x32_bf16 v[140:143], v[60:63], v[16:19], v[140:143]
  ds_read_b64_tr_b16 v[88:89], v191 offset:40960
  ds_read_b64_tr_b16 v[90:91], v195 offset:40960
  s_waitcnt lgkmcnt(12)
  v_mfma_f32_16x16x32_bf16 v[128:131], v[64:67], v[12:15], v[128:131]
  v_mfma_f32_16x16x32_bf16 v[144:147], v[64:67], v[16:19], v[144:147]
  s_barrier
  ds_read_b64_tr_b16 v[60:61], v188 offset:49152
  ds_read_b64_tr_b16 v[62:63], v192 offset:49152
  s_waitcnt lgkmcnt(12)
  v_mfma_f32_16x16x32_bf16 v[132:135], v[68:71], v[12:15], v[132:135]
  v_mfma_f32_16x16x32_bf16 v[148:151], v[68:71], v[16:19], v[148:151]
  ds_read_b64_tr_b16 v[64:65], v189 offset:49152
  ds_read_b64_tr_b16 v[66:67], v193 offset:49152
  s_waitcnt lgkmcnt(12)
  v_mfma_f32_16x16x32_bf16 v[136:139], v[72:75], v[12:15], v[136:139]
  v_mfma_f32_16x16x32_bf16 v[152:155], v[72:75], v[16:19], v[152:155]
  ds_read_b64_tr_b16 v[68:69], v190 offset:49152
  ds_read_b64_tr_b16 v[70:71], v194 offset:49152
  s_add_u32 s17, s20, 28672
  buffer_load_dwordx4 v[16:19], v11, s[28:31], s17 offen offset:0
  s_waitcnt vmcnt(8) lgkmcnt(12)
  v_mfma_f32_16x16x32_bf16 v[124:127], v[76:79], v[20:23], v[124:127]
  s_waitcnt vmcnt(7)
  v_mfma_f32_16x16x32_bf16 v[140:143], v[76:79], v[24:27], v[140:143]
  ds_read_b64_tr_b16 v[72:73], v191 offset:49152
  ds_read_b64_tr_b16 v[74:75], v195 offset:49152
  s_waitcnt lgkmcnt(12)
  v_mfma_f32_16x16x32_bf16 v[128:131], v[80:83], v[20:23], v[128:131]
  v_mfma_f32_16x16x32_bf16 v[144:147], v[80:83], v[24:27], v[144:147]
  ds_read_b64_tr_b16 v[76:77], v188 offset:57344
  ds_read_b64_tr_b16 v[78:79], v192 offset:57344
  s_waitcnt lgkmcnt(12)
  v_mfma_f32_16x16x32_bf16 v[132:135], v[84:87], v[20:23], v[132:135]
  v_mfma_f32_16x16x32_bf16 v[148:151], v[84:87], v[24:27], v[148:151]
  ds_read_b64_tr_b16 v[80:81], v189 offset:57344
  ds_read_b64_tr_b16 v[82:83], v193 offset:57344
  s_waitcnt lgkmcnt(12)
  v_mfma_f32_16x16x32_bf16 v[136:139], v[88:91], v[20:23], v[136:139]
  v_mfma_f32_16x16x32_bf16 v[152:155], v[88:91], v[24:27], v[152:155]
  ds_read_b64_tr_b16 v[84:85], v190 offset:57344
  ds_read_b64_tr_b16 v[86:87], v194 offset:57344
  s_add_u32 s17, s20, 28672
  buffer_load_dwordx4 v[24:27], v11, s[28:31], s17 offen offset:2048
  s_waitcnt vmcnt(7) lgkmcnt(12)
  v_mfma_f32_16x16x32_bf16 v[140:143], v[60:63], v[32:35], v[140:143]
  ds_read_b64_tr_b16 v[88:89], v191 offset:57344
  ds_read_b64_tr_b16 v[90:91], v195 offset:57344
  s_waitcnt lgkmcnt(12)
  v_mfma_f32_16x16x32_bf16 v[144:147], v[64:67], v[32:35], v[144:147]
  s_barrier
  v_xor_b32 v188, 0x10000, v188
  v_xor_b32 v192, 0x10000, v192
  v_xor_b32 v189, 0x10000, v189
  v_xor_b32 v193, 0x10000, v193
  v_xor_b32 v190, 0x10000, v190
  v_xor_b32 v194, 0x10000, v194
  v_xor_b32 v191, 0x10000, v191
  v_xor_b32 v195, 0x10000, v195
  ds_read_b64_tr_b16 v[60:61], v188 offset:0
  ds_read_b64_tr_b16 v[62:63], v192 offset:0
  s_waitcnt lgkmcnt(12)
  v_mfma_f32_16x16x32_bf16 v[148:151], v[68:71], v[32:35], v[148:151]
  ds_read_b64_tr_b16 v[64:65], v189 offset:0
  ds_read_b64_tr_b16 v[66:67], v193 offset:0
  s_waitcnt lgkmcnt(12)
  v_mfma_f32_16x16x32_bf16 v[152:155], v[72:75], v[32:35], v[152:155]
  ds_read_b64_tr_b16 v[68:69], v190 offset:0
  ds_read_b64_tr_b16 v[70:71], v194 offset:0
  s_add_u32 s17, s20, 32768
  buffer_load_dwordx4 v[32:35], v11, s[28:31], s17 offen offset:0
  s_waitcnt vmcnt(7) lgkmcnt(12)
  v_mfma_f32_16x16x32_bf16 v[140:143], v[76:79], v[40:43], v[140:143]
  ds_read_b64_tr_b16 v[72:73], v191 offset:0
  ds_read_b64_tr_b16 v[74:75], v195 offset:0
  s_waitcnt lgkmcnt(12)
  v_mfma_f32_16x16x32_bf16 v[144:147], v[80:83], v[40:43], v[144:147]
  ds_read_b64_tr_b16 v[76:77], v188 offset:8192
  ds_read_b64_tr_b16 v[78:79], v192 offset:8192
  s_waitcnt lgkmcnt(12)
  v_mfma_f32_16x16x32_bf16 v[148:151], v[84:87], v[40:43], v[148:151]
  ds_read_b64_tr_b16 v[80:81], v189 offset:8192
  ds_read_b64_tr_b16 v[82:83], v193 offset:8192
  s_waitcnt lgkmcnt(12)
  v_mfma_f32_16x16x32_bf16 v[152:155], v[88:91], v[40:43], v[152:155]
  ds_read_b64_tr_b16 v[84:85], v190 offset:8192
  ds_read_b64_tr_b16 v[86:87], v194 offset:8192
  s_add_u32 s17, s20, 32768
  buffer_load_dwordx4 v[40:43], v11, s[28:31], s17 offen offset:2048
  s_waitcnt vmcnt(5) lgkmcnt(12)
  v_mfma_f32_16x16x32_bf16 v[140:143], v[60:63], v[48:51], v[140:143]
  ds_read_b64_tr_b16 v[88:89], v191 offset:8192
  ds_read_b64_tr_b16 v[90:91], v195 offset:8192
  s_add_u32 s17, s20, 20480
  buffer_load_dwordx4 v[156:159], v10, s[28:31], s17 offen offset:0
  s_waitcnt lgkmcnt(12)
  v_mfma_f32_16x16x32_bf16 v[144:147], v[64:67], v[48:51], v[144:147]
  s_barrier
  ds_read_b64_tr_b16 v[60:61], v188 offset:16384
  ds_read_b64_tr_b16 v[62:63], v192 offset:16384
  s_waitcnt lgkmcnt(12)
  v_mfma_f32_16x16x32_bf16 v[148:151], v[68:71], v[48:51], v[148:151]
  ds_read_b64_tr_b16 v[64:65], v189 offset:16384
  ds_read_b64_tr_b16 v[66:67], v193 offset:16384
  s_add_u32 s17, s20, 20480
  buffer_load_dwordx4 v[160:163], v10, s[28:31], s17 offen offset:2048
  s_waitcnt lgkmcnt(12)
  v_mfma_f32_16x16x32_bf16 v[152:155], v[72:75], v[48:51], v[152:155]
  ds_read_b64_tr_b16 v[68:69], v190 offset:16384
  ds_read_b64_tr_b16 v[70:71], v194 offset:16384
  s_waitcnt vmcnt(6) lgkmcnt(12)
  v_mfma_f32_16x16x32_bf16 v[140:143], v[76:79], v[56:59], v[140:143]
  ds_read_b64_tr_b16 v[72:73], v191 offset:16384
  ds_read_b64_tr_b16 v[74:75], v195 offset:16384
  s_add_u32 s17, s20, 24576
  buffer_load_dwordx4 v[164:167], v10, s[28:31], s17 offen offset:0
  s_waitcnt lgkmcnt(12)
  v_mfma_f32_16x16x32_bf16 v[144:147], v[80:83], v[56:59], v[144:147]
  ds_read_b64_tr_b16 v[76:77], v188 offset:24576
  ds_read_b64_tr_b16 v[78:79], v192 offset:24576
  s_waitcnt lgkmcnt(12)
  v_mfma_f32_16x16x32_bf16 v[148:151], v[84:87], v[56:59], v[148:151]
  ds_read_b64_tr_b16 v[80:81], v189 offset:24576
  ds_read_b64_tr_b16 v[82:83], v193 offset:24576
  s_add_u32 s17, s20, 24576
  buffer_load_dwordx4 v[168:171], v10, s[28:31], s17 offen offset:2048
  s_waitcnt lgkmcnt(12)
  v_mfma_f32_16x16x32_bf16 v[152:155], v[88:91], v[56:59], v[152:155]
  ds_read_b64_tr_b16 v[84:85], v190 offset:24576
  ds_read_b64_tr_b16 v[86:87], v194 offset:24576
  s_waitcnt vmcnt(7) lgkmcnt(12)
  v_mfma_f32_16x16x32_bf16 v[140:143], v[60:63], v[16:19], v[140:143]
  ds_read_b64_tr_b16 v[88:89], v191 offset:24576
  ds_read_b64_tr_b16 v[90:91], v195 offset:24576
  s_add_u32 s17, s20, 28672
  buffer_load_dwordx4 v[172:175], v10, s[28:31], s17 offen offset:0
  s_waitcnt lgkmcnt(12)
  v_mfma_f32_16x16x32_bf16 v[144:147], v[64:67], v[16:19], v[144:147]
  s_barrier
  ds_read_b64_tr_b16 v[60:61], v188 offset:32768
  ds_read_b64_tr_b16 v[62:63], v192 offset:32768
  s_waitcnt lgkmcnt(12)
  v_mfma_f32_16x16x32_bf16 v[148:151], v[68:71], v[16:19], v[148:151]
  ds_read_b64_tr_b16 v[64:65], v189 offset:32768
  ds_read_b64_tr_b16 v[66:67], v193 offset:32768
  s_add_u32 s17, s20, 28672
  buffer_load_dwordx4 v[176:179], v10, s[28:31], s17 offen offset:2048
  s_waitcnt lgkmcnt(12)
  v_mfma_f32_16x16x32_bf16 v[152:155], v[72:75], v[16:19], v[152:155]
  ds_read_b64_tr_b16 v[68:69], v190 offset:32768
  ds_read_b64_tr_b16 v[70:71], v194 offset:32768
  s_waitcnt vmcnt(8) lgkmcnt(12)
  v_mfma_f32_16x16x32_bf16 v[140:143], v[76:79], v[24:27], v[140:143]
  ds_read_b64_tr_b16 v[72:73], v191 offset:32768
  ds_read_b64_tr_b16 v[74:75], v195 offset:32768
  s_add_u32 s17, s20, 32768
  buffer_load_dwordx4 v[180:183], v10, s[28:31], s17 offen offset:0
  s_waitcnt lgkmcnt(12)
  v_mfma_f32_16x16x32_bf16 v[144:147], v[80:83], v[24:27], v[144:147]
  ds_read_b64_tr_b16 v[76:77], v188 offset:40960
  ds_read_b64_tr_b16 v[78:79], v192 offset:40960
  s_waitcnt lgkmcnt(12)
  v_mfma_f32_16x16x32_bf16 v[148:151], v[84:87], v[24:27], v[148:151]
  ds_read_b64_tr_b16 v[80:81], v189 offset:40960
  ds_read_b64_tr_b16 v[82:83], v193 offset:40960
  s_add_u32 s17, s20, 32768
  buffer_load_dwordx4 v[184:187], v10, s[28:31], s17 offen offset:2048
  s_waitcnt lgkmcnt(12)
  v_mfma_f32_16x16x32_bf16 v[152:155], v[88:91], v[24:27], v[152:155]
  ds_read_b64_tr_b16 v[84:85], v190 offset:40960
  ds_read_b64_tr_b16 v[86:87], v194 offset:40960
  s_waitcnt vmcnt(9) lgkmcnt(12)
  v_mfma_f32_16x16x32_bf16 v[140:143], v[60:63], v[32:35], v[140:143]
  ds_read_b64_tr_b16 v[88:89], v191 offset:40960
  ds_read_b64_tr_b16 v[90:91], v195 offset:40960
  s_waitcnt lgkmcnt(12)
  v_mfma_f32_16x16x32_bf16 v[144:147], v[64:67], v[32:35], v[144:147]
  v_xor_b32 v188, 0x10000, v188
  v_xor_b32 v192, 0x10000, v192
  v_xor_b32 v189, 0x10000, v189
  v_xor_b32 v193, 0x10000, v193
  v_xor_b32 v190, 0x10000, v190
  v_xor_b32 v194, 0x10000, v194
  v_xor_b32 v191, 0x10000, v191
  v_xor_b32 v195, 0x10000, v195
  ds_read_b64_tr_b16 v[60:61], v188 offset:49152
  ds_read_b64_tr_b16 v[62:63], v192 offset:49152
  s_waitcnt lgkmcnt(12)
  v_mfma_f32_16x16x32_bf16 v[148:151], v[68:71], v[32:35], v[148:151]
  ds_read_b64_tr_b16 v[64:65], v189 offset:49152
  ds_read_b64_tr_b16 v[66:67], v193 offset:49152
  s_waitcnt lgkmcnt(12)
  v_mfma_f32_16x16x32_bf16 v[152:155], v[72:75], v[32:35], v[152:155]
  ds_read_b64_tr_b16 v[68:69], v190 offset:49152
  ds_read_b64_tr_b16 v[70:71], v194 offset:49152
  s_waitcnt vmcnt(8) lgkmcnt(12)
  v_mfma_f32_16x16x32_bf16 v[140:143], v[76:79], v[40:43], v[140:143]
  ds_read_b64_tr_b16 v[72:73], v191 offset:49152
  ds_read_b64_tr_b16 v[74:75], v195 offset:49152
  s_waitcnt lgkmcnt(12)
  v_mfma_f32_16x16x32_bf16 v[144:147], v[80:83], v[40:43], v[144:147]
  ds_read_b64_tr_b16 v[76:77], v188 offset:57344
  ds_read_b64_tr_b16 v[78:79], v192 offset:57344
  s_waitcnt lgkmcnt(12)
  v_mfma_f32_16x16x32_bf16 v[148:151], v[84:87], v[40:43], v[148:151]
  ds_read_b64_tr_b16 v[80:81], v189 offset:57344
  ds_read_b64_tr_b16 v[82:83], v193 offset:57344
  s_waitcnt lgkmcnt(12)
  v_mfma_f32_16x16x32_bf16 v[152:155], v[88:91], v[40:43], v[152:155]
  ds_read_b64_tr_b16 v[84:85], v190 offset:57344
  ds_read_b64_tr_b16 v[86:87], v194 offset:57344
  buffer_load_dwordx4 v[208:211], v216, s[36:39], s33 offen
  buffer_load_dwordx4 v[212:215], v217, s[40:43], s48 offen
  ds_write_b128 v218, v[148:151] offset:0
  s_nop 2
  ds_write_b128 v218, v[152:155] offset:1024
  s_waitcnt lgkmcnt(0)
  s_barrier
  ds_read_b128 v[12:15], v219 offset:0
  ds_read_b128 v[16:19], v219 offset:1024
  s_waitcnt lgkmcnt(1)
  v_add_f32 v140, v140, v12
  v_add_f32 v141, v141, v13
  v_add_f32 v142, v142, v14
  v_add_f32 v143, v143, v15
  s_waitcnt lgkmcnt(0)
  v_add_f32 v144, v144, v16
  v_add_f32 v145, v145, v17
  v_add_f32 v146, v146, v18
  v_add_f32 v147, v147, v19
  buffer_store_dwordx4 v[140:143], v216, s[52:55], s56 offen offset:0 sc1
  buffer_store_dwordx4 v[144:147], v216, s[52:55], s56 offen offset:1024 sc1
  buffer_load_dwordx4 v[200:203], v216, s[52:55], s57 offen offset:2048 sc1
  buffer_load_dwordx4 v[204:207], v216, s[52:55], s57 offen offset:3072 sc1
  s_waitcnt vmcnt(13)
  v_mfma_f32_16x16x32_bf16 v[124:127], v[60:63], v[156:159], v[124:127]
  ds_read_b64_tr_b16 v[88:89], v191 offset:57344
  ds_read_b64_tr_b16 v[90:91], v195 offset:57344
  v_mfma_f32_16x16x32_bf16 v[128:131], v[64:67], v[156:159], v[128:131]
  v_xor_b32 v188, 0x10000, v188
  v_xor_b32 v192, 0x10000, v192
  v_xor_b32 v189, 0x10000, v189
  v_xor_b32 v193, 0x10000, v193
  v_xor_b32 v190, 0x10000, v190
  v_xor_b32 v194, 0x10000, v194
  v_xor_b32 v191, 0x10000, v191
  v_xor_b32 v195, 0x10000, v195
  ds_read_b64_tr_b16 v[60:61], v188 offset:0
  ds_read_b64_tr_b16 v[62:63], v192 offset:0
  v_mfma_f32_16x16x32_bf16 v[132:135], v[68:71], v[156:159], v[132:135]
  ds_read_b64_tr_b16 v[64:65], v189 offset:0
  ds_read_b64_tr_b16 v[66:67], v193 offset:0
  v_mfma_f32_16x16x32_bf16 v[136:139], v[72:75], v[156:159], v[136:139]
  ds_read_b64_tr_b16 v[68:69], v190 offset:0
  ds_read_b64_tr_b16 v[70:71], v194 offset:0
  s_waitcnt vmcnt(12)
  v_mfma_f32_16x16x32_bf16 v[124:127], v[76:79], v[160:163], v[124:127]
  ds_read_b64_tr_b16 v[72:73], v191 offset:0
  ds_read_b64_tr_b16 v[74:75], v195 offset:0
  v_mfma_f32_16x16x32_bf16 v[128:131], v[80:83], v[160:163], v[128:131]
  ds_read_b64_tr_b16 v[76:77], v188 offset:8192
  ds_read_b64_tr_b16 v[78:79], v192 offset:8192
  v_mfma_f32_16x16x32_bf16 v[132:135], v[84:87], v[160:163], v[132:135]
  ds_read_b64_tr_b16 v[80:81], v189 offset:8192
  ds_read_b64_tr_b16 v[82:83], v193 offset:8192
  s_waitcnt lgkmcnt(12)
  v_mfma_f32_16x16x32_bf16 v[136:139], v[88:91], v[160:163], v[136:139]
  ds_read_b64_tr_b16 v[84:85], v190 offset:8192
  ds_read_b64_tr_b16 v[86:87], v194 offset:8192
  s_waitcnt vmcnt(11) lgkmcnt(12)
  v_mfma_f32_16x16x32_bf16 v[124:127], v[60:63], v[164:167], v[124:127]
  ds_read_b64_tr_b16 v[88:89], v191 offset:8192
  ds_read_b64_tr_b16 v[90:91], v195 offset:8192
  s_waitcnt lgkmcnt(12)
  v_mfma_f32_16x16x32_bf16 v[128:131], v[64:67], v[164:167], v[128:131]
  ds_read_b64_tr_b16 v[60:61], v188 offset:16384
  ds_read_b64_tr_b16 v[62:63], v192 offset:16384
  s_waitcnt lgkmcnt(12)
  v_mfma_f32_16x16x32_bf16 v[132:135], v[68:71], v[164:167], v[132:135]
  ds_read_b64_tr_b16 v[64:65], v189 offset:16384
  ds_read_b64_tr_b16 v[66:67], v193 offset:16384
  s_waitcnt lgkmcnt(12)
  v_mfma_f32_16x16x32_bf16 v[136:139], v[72:75], v[164:167], v[136:139]
  ds_read_b64_tr_b16 v[68:69], v190 offset:16384
  ds_read_b64_tr_b16 v[70:71], v194 offset:16384
  s_waitcnt vmcnt(10) lgkmcnt(12)
  v_mfma_f32_16x16x32_bf16 v[124:127], v[76:79], v[168:171], v[124:127]
  ds_read_b64_tr_b16 v[72:73], v191 offset:16384
  ds_read_b64_tr_b16 v[74:75], v195 offset:16384
  s_waitcnt lgkmcnt(12)
  v_mfma_f32_16x16x32_bf16 v[128:131], v[80:83], v[168:171], v[128:131]
  ds_read_b64_tr_b16 v[76:77], v188 offset:24576
  ds_read_b64_tr_b16 v[78:79], v192 offset:24576
  s_waitcnt lgkmcnt(12)
  v_mfma_f32_16x16x32_bf16 v[132:135], v[84:87], v[168:171], v[132:135]
  ds_read_b64_tr_b16 v[80:81], v189 offset:24576
  ds_read_b64_tr_b16 v[82:83], v193 offset:24576
  s_waitcnt lgkmcnt(12)
  v_mfma_f32_16x16x32_bf16 v[136:139], v[88:91], v[168:171], v[136:139]
  ds_read_b64_tr_b16 v[84:85], v190 offset:24576
  ds_read_b64_tr_b16 v[86:87], v194 offset:24576
  s_waitcnt vmcnt(9) lgkmcnt(12)
  v_mfma_f32_16x16x32_bf16 v[124:127], v[60:63], v[172:175], v[124:127]
  ds_read_b64_tr_b16 v[88:89], v191 offset:24576
  ds_read_b64_tr_b16 v[90:91], v195 offset:24576
  s_waitcnt lgkmcnt(12)
  v_mfma_f32_16x16x32_bf16 v[128:131], v[64:67], v[172:175], v[128:131]
  ds_read_b64_tr_b16 v[60:61], v188 offset:32768
  ds_read_b64_tr_b16 v[62:63], v192 offset:32768
  s_waitcnt lgkmcnt(12)
  v_mfma_f32_16x16x32_bf16 v[132:135], v[68:71], v[172:175], v[132:135]
  ds_read_b64_tr_b16 v[64:65], v189 offset:32768
  ds_read_b64_tr_b16 v[66:67], v193 offset:32768
  s_waitcnt lgkmcnt(12)
  v_mfma_f32_16x16x32_bf16 v[136:139], v[72:75], v[172:175], v[136:139]
  ds_read_b64_tr_b16 v[68:69], v190 offset:32768
  ds_read_b64_tr_b16 v[70:71], v194 offset:32768
  s_waitcnt vmcnt(8) lgkmcnt(12)
  v_mfma_f32_16x16x32_bf16 v[124:127], v[76:79], v[176:179], v[124:127]
  ds_read_b64_tr_b16 v[72:73], v191 offset:32768
  ds_read_b64_tr_b16 v[74:75], v195 offset:32768
  s_waitcnt lgkmcnt(12)
  v_mfma_f32_16x16x32_bf16 v[128:131], v[80:83], v[176:179], v[128:131]
  ds_read_b64_tr_b16 v[76:77], v188 offset:40960
  ds_read_b64_tr_b16 v[78:79], v192 offset:40960
  s_waitcnt lgkmcnt(12)
  v_mfma_f32_16x16x32_bf16 v[132:135], v[84:87], v[176:179], v[132:135]
  ds_read_b64_tr_b16 v[80:81], v189 offset:40960
  ds_read_b64_tr_b16 v[82:83], v193 offset:40960
  s_waitcnt lgkmcnt(12)
  v_mfma_f32_16x16x32_bf16 v[136:139], v[88:91], v[176:179], v[136:139]
  ds_read_b64_tr_b16 v[84:85], v190 offset:40960
  ds_read_b64_tr_b16 v[86:87], v194 offset:40960
  s_waitcnt vmcnt(7) lgkmcnt(12)
  v_mfma_f32_16x16x32_bf16 v[124:127], v[60:63], v[180:183], v[124:127]
  ds_read_b64_tr_b16 v[88:89], v191 offset:40960
  ds_read_b64_tr_b16 v[90:91], v195 offset:40960
  s_waitcnt lgkmcnt(12)
  v_mfma_f32_16x16x32_bf16 v[128:131], v[64:67], v[180:183], v[128:131]
  s_waitcnt lgkmcnt(10)
  v_mfma_f32_16x16x32_bf16 v[132:135], v[68:71], v[180:183], v[132:135]
  s_waitcnt lgkmcnt(8)
  v_mfma_f32_16x16x32_bf16 v[136:139], v[72:75], v[180:183], v[136:139]
  s_waitcnt vmcnt(6) lgkmcnt(6)
  v_mfma_f32_16x16x32_bf16 v[124:127], v[76:79], v[184:187], v[124:127]
  s_waitcnt lgkmcnt(4)
  v_mfma_f32_16x16x32_bf16 v[128:131], v[80:83], v[184:187], v[128:131]
  s_waitcnt lgkmcnt(2)
  v_mfma_f32_16x16x32_bf16 v[132:135], v[84:87], v[184:187], v[132:135]
  s_waitcnt lgkmcnt(0)
  v_mfma_f32_16x16x32_bf16 v[136:139], v[88:91], v[184:187], v[136:139]
  s_mov_b32 s23, 16384
  s_branch fin_kernel_pchk3
fin_kernel_poll1:
  buffer_load_dwordx4 v[200:203], v216, s[52:55], s57 offen offset:2048 sc1
  buffer_load_dwordx4 v[204:207], v216, s[52:55], s57 offen offset:3072 sc1
fin_kernel_pchk3:
  s_waitcnt vmcnt(1)
  v_max3_u32 v220, v200, v201, v202
  s_waitcnt vmcnt(0)
  v_max3_u32 v220, v220, v203, v204
  v_max3_u32 v220, v220, v205, v206
  v_max_u32 v220, v220, v207
  v_cmp_eq_u32 vcc, -1, v220
  s_cmp_eq_u64 vcc, 0
  s_cbranch_scc1 fin_kernel_got2
  s_sub_u32 s23, s23, 1
  s_cmp_eq_u32 s23, 0
  s_cbranch_scc0 fin_kernel_poll1
fin_kernel_got2:
  buffer_load_dwordx4 v[12:15], v216, s[52:55], s57 offen offset:0 sc1
  buffer_load_dwordx4 v[16:19], v216, s[52:55], s57 offen offset:1024 sc1
  ds_write_b128 v218, v[132:135] offset:2048
  ds_write_b128 v218, v[136:139] offset:3072
  s_waitcnt lgkmcnt(0)
  s_barrier
  ds_read_b128 v[20:23], v219 offset:2048
  ds_read_b128 v[24:27], v219 offset:3072
  s_waitcnt lgkmcnt(1)
  v_add_f32 v124, v124, v20
  v_add_f32 v125, v125, v21
  v_add_f32 v126, v126, v22
  v_add_f32 v127, v127, v23
  s_waitcnt lgkmcnt(0)
  v_add_f32 v128, v128, v24
  v_add_f32 v129, v129, v25
  v_add_f32 v130, v130, v26
  v_add_f32 v131, v131, v27
  s_cmp_eq_u32 s12, 1
  s_cbranch_scc1 fin_kernel_q14
  v_add_f32 v124, v124, v92
  v_mov_b32 v92, v200
  v_add_f32 v125, v125, v93
  v_mov_b32 v93, v201
  v_add_f32 v126, v126, v94
  v_mov_b32 v94, v202
  v_add_f32 v127, v127, v95
  v_mov_b32 v95, v203
  v_add_f32 v128, v128, v96
  v_mov_b32 v96, v204
  v_add_f32 v129, v129, v97
  v_mov_b32 v97, v205
  v_add_f32 v130, v130, v98
  v_mov_b32 v98, v206
  v_add_f32 v131, v131, v99
  v_mov_b32 v99, v207
  s_branch fin_kernel_qe5
fin_kernel_q14:
  v_add_f32 v124, v124, v200
  v_add_f32 v125, v125, v201
  v_add_f32 v126, v126, v202
  v_add_f32 v127, v127, v203
  v_add_f32 v128, v128, v204
  v_add_f32 v129, v129, v205
  v_add_f32 v130, v130, v206
  v_add_f32 v131, v131, v207
fin_kernel_qe5:
  v_permlane16_swap_b32 v212, v214
  v_permlane16_swap_b32 v213, v215
  v_lshlrev_b32 v68, 16, v212
  v_and_b32 v69, 0xffff0000, v212
  v_lshlrev_b32 v70, 16, v213
  v_and_b32 v71, 0xffff0000, v213
  v_lshlrev_b32 v72, 16, v214
  v_and_b32 v73, 0xffff0000, v214
  v_lshlrev_b32 v74, 16, v215
  v_and_b32 v75, 0xffff0000, v215
  v_lshlrev_b32 v60, 16, v208
  v_and_b32 v61, 0xffff0000, v208
  v_lshlrev_b32 v62, 16, v209
  v_and_b32 v63, 0xffff0000, v209
  v_lshlrev_b32 v64, 16, v210
  v_and_b32 v65, 0xffff0000, v210
  v_lshlrev_b32 v66, 16, v211
  v_and_b32 v67, 0xffff0000, v211
  v_add_f32 v92, v92, v60
  v_add_f32 v93, v93, v61
  v_add_f32 v94, v94, v62
  v_add_f32 v95, v95, v63
  v_add_f32 v96, v96, v64
  v_add_f32 v97, v97, v65
  v_add_f32 v98, v98, v66
  v_add_f32 v99, v99, v67
  v_mul_f32 v60, 0xbfb8aa3b, v92
  v_mul_f32 v61, 0xbfb8aa3b, v93
  v_mul_f32 v62, 0xbfb8aa3b, v94
  v_mul_f32 v63, 0xbfb8aa3b, v95
  v_mul_f32 v64, 0xbfb8aa3b, v96
  v_mul_f32 v65, 0xbfb8aa3b, v97
  v_mul_f32 v66, 0xbfb8aa3b, v98
  v_mul_f32 v67, 0xbfb8aa3b, v99
  v_exp_f32 v60, v60
  v_exp_f32 v61, v61
  v_exp_f32 v62, v62
  v_exp_f32 v63, v63
  v_exp_f32 v64, v64
  v_exp_f32 v65, v65
  v_exp_f32 v66, v66
  v_exp_f32 v67, v67
  v_add_f32 v60, 1.0, v60
  v_add_f32 v61, 1.0, v61
  v_add_f32 v62, 1.0, v62
  v_add_f32 v63, 1.0, v63
  v_add_f32 v64, 1.0, v64
  v_add_f32 v65, 1.0, v65
  v_add_f32 v66, 1.0, v66
  v_add_f32 v67, 1.0, v67
  v_rcp_f32 v60, v60
  v_rcp_f32 v61, v61
  v_rcp_f32 v62, v62
  v_rcp_f32 v63, v63
  v_rcp_f32 v64, v64
  v_rcp_f32 v65, v65
  v_rcp_f32 v66, v66
  v_rcp_f32 v67, v67
  v_mul_f32 v92, v92, v60
  v_mul_f32 v93, v93, v61
  v_mul_f32 v94, v94, v62
  v_mul_f32 v95, v95, v63
  v_mul_f32 v96, v96, v64
  v_mul_f32 v97, v97, v65
  v_mul_f32 v98, v98, v66
  v_mul_f32 v99, v99, v67
  s_mov_b32 s23, 16384
  s_branch fin_kernel_pchk8
fin_kernel_poll6:
  buffer_load_dwordx4 v[12:15], v216, s[52:55], s57 offen offset:0 sc1
  buffer_load_dwordx4 v[16:19], v216, s[52:55], s57 offen offset:1024 sc1
fin_kernel_pchk8:
  s_waitcnt vmcnt(1)
  v_max3_u32 v220, v12, v13, v14
  s_waitcnt vmcnt(0)
  v_max3_u32 v220, v220, v15, v16
  v_max3_u32 v220, v220, v17, v18
  v_max_u32 v220, v220, v19
  v_cmp_eq_u32 vcc, -1, v220
  s_cmp_eq_u64 vcc, 0
  s_cbranch_scc1 fin_kernel_got7
  s_sub_u32 s23, s23, 1
  s_cmp_eq_u32 s23, 0
  s_cbranch_scc0 fin_kernel_poll6
fin_kernel_got7:
  v_add_f32 v124, v124, v12
  v_add_f32 v125, v125, v13
  v_add_f32 v126, v126, v14
  v_add_f32 v127, v127, v15
  v_add_f32 v128, v128, v16
  v_add_f32 v129, v129, v17
  v_add_f32 v130, v130, v18
  v_add_f32 v131, v131, v19
  v_fma_f32 v124, v124, v92, v68
  v_fma_f32 v125, v125, v93, v69
  v_fma_f32 v126, v126, v94, v70
  v_fma_f32 v127, v127, v95, v71
  v_fma_f32 v128, v128, v96, v72
  v_fma_f32 v129, v129, v97, v73
  v_fma_f32 v130, v130, v98, v74
  v_fma_f32 v131, v131, v99, v75
  v_cvt_pk_bf16_f32 v76, v124, v125
  v_cvt_pk_bf16_f32 v77, v126, v127
  v_cvt_pk_bf16_f32 v78, v128, v129
  v_cvt_pk_bf16_f32 v79, v130, v131
  s_nop 0
  v_permlane16_swap_b32 v76, v78
  v_permlane16_swap_b32 v77, v79
  buffer_store_dwordx4 v[76:79], v217, s[44:47], s48 offen
  s_waitcnt vmcnt(0)
fin_kernel_done:
  s_endpgm
.section .rodata,"a"
.p2align 6
.amdhsa_kernel kv_kernel
  .amdhsa_next_free_vgpr 256
  .amdhsa_next_free_sgpr 102
  .amdhsa_accum_offset 256
  .amdhsa_group_segment_fixed_size 0
  .amdhsa_kernarg_size 112
  .amdhsa_user_sgpr_count 2
  .amdhsa_user_sgpr_kernarg_segment_ptr 1
  .amdhsa_system_sgpr_workgroup_id_x 1
.end_amdhsa_kernel
.p2align 6
.amdhsa_kernel at_kernel
  .amdhsa_next_free_vgpr 256
  .amdhsa_next_free_sgpr 96
  .amdhsa_accum_offset 256
  .amdhsa_group_segment_fixed_size 0
  .amdhsa_kernarg_size 112
  .amdhsa_user_sgpr_count 2
  .amdhsa_user_sgpr_kernarg_segment_ptr 1
  .amdhsa_system_sgpr_workgroup_id_x 1
.end_amdhsa_kernel
.p2align 6
.amdhsa_kernel fin_kernel
  .amdhsa_next_free_vgpr 221
  .amdhsa_next_free_sgpr 96
  .amdhsa_accum_offset 224
  .amdhsa_group_segment_fixed_size 0
  .amdhsa_kernarg_size 112
  .amdhsa_user_sgpr_count 2
  .amdhsa_user_sgpr_kernarg_segment_ptr 1
  .amdhsa_system_sgpr_workgroup_id_x 1
.end_amdhsa_kernel
.p2align 6
```
